```python
import torch

def _softmax(x, axis=-1):
    return torch.softmax(x, dim=axis)
def _gelu(x):
    return torch.nn.functional.gelu(x, approximate="tanh")
def _silu(x):
    return torch.nn.functional.silu(x)
def _sigmoid(x):
    return torch.sigmoid(x)
def _layernorm(x, axis=-1, eps=1e-5):
    m = x.mean(dim=axis, keepdim=True)
    v = x.var(dim=axis, keepdim=True, unbiased=False)
    return (x - m) / torch.sqrt(v + eps)
def _scatter_add(tgt, idx, src, axis=0):
    return tgt.clone().index_add_(axis, idx, src)
def _segment_sum(src, seg, n):
    out = torch.zeros((n,) + src.shape[1:], dtype=src.dtype)
    return out.index_add_(0, seg, src)
def _pad(x, pw):
    flat = tuple(v for pair in reversed(pw) for v in pair)
    return torch.nn.functional.pad(x, flat)

kernel_name = 'gated_mix__linear_attn_block__linear_kernel_hedgehog__prompt'

def setup_inputs():

    _w = (lambda a: (lambda t: t.to(torch.bfloat16) if t.is_floating_point() else t)(torch.as_tensor(a)))
    def _A_setup():
        B, S, D = 1, 2048, 576
        return {
            "x": _w((lambda *s: torch.randn(*s, dtype=torch.bfloat16) * 0.05)(B, S, D)),
            "wqkv": _w((lambda *s: torch.randn(*s, dtype=torch.bfloat16) * 1.6)(D, 3 * D)),
            "wo": _w((lambda *s: torch.randn(*s, dtype=torch.bfloat16) * 0.1)(D, D)),
        }
    _A_in = _A_setup()

    def _B_setup():
        B, S, D, H = 1, 2048, 576, 32
        Dh = D // H
        return {
            "x": _w((lambda *s: torch.randn(*s, dtype=torch.bfloat16) * 0.05)(B, S, D)),
            "wqkv": _w((lambda *s: torch.randn(*s, dtype=torch.bfloat16) * 1.6)(D, 3 * D)),
            "w_phi": _w((lambda *s: torch.randn(*s, dtype=torch.bfloat16) * 1.6)(H, Dh, Dh) * (Dh ** -0.5)),
            "wo": _w((lambda *s: torch.randn(*s, dtype=torch.bfloat16) * 0.05)(D, D)),
        }
    _B_in = _B_setup()

    return {
        "A_x": _A_in["x"],
        "A_wqkv": _A_in["wqkv"],
        "A_wo": _A_in["wo"],
        "B_x": _B_in["x"],
        "B_wqkv": _B_in["wqkv"],
        "B_w_phi": _B_in["w_phi"],
        "B_wo": _B_in["wo"],
        "gate_w": _w((lambda *s: torch.randn(*s, dtype=torch.bfloat16) * 0.05)(576) * 16.0),
    }

def reference(A_x, A_wqkv, A_wo, B_x, B_wqkv, B_w_phi, B_wo, gate_w):
    def _A_ref(x, wqkv, wo):
        B, S, D = x.shape
        H = 32; Dh = D // H
        qkv = (lambda x, *d: x.permute(*d))((x @ wqkv).reshape(B, S, 3, H, Dh), 2, 0, 3, 1, 4)
        q, k, v = qkv[0], qkv[1], qkv[2]
        phi = lambda t: torch.where(t > 0, t + 1, torch.exp(t)) + 1e-6
        pq, pk = phi(q), phi(k)
        kv = torch.einsum("bhsd,bhse->bhde", pk, v)
        z = torch.einsum("bhsd->bhd", pk)
        num = torch.einsum("bhqd,bhde->bhqe", pq, kv)
        den = torch.einsum("bhqd,bhd->bhq", pq, z)[..., None] + 1e-6
        o = num / den
        return (lambda x, *d: x.permute(*d))(o, 0, 2, 1, 3).reshape(B, S, D) @ wo

    def _B_ref(x, wqkv, w_phi, wo):
        B, S, D = x.shape
        H = 32; Dh = D // H
        qkv = (lambda x, *d: x.permute(*d))((x @ wqkv).reshape(B, S, 3, H, Dh), 2, 0, 3, 1, 4)
        q, k, v = qkv[0], qkv[1], qkv[2]
        pq = torch.einsum("bhsd,hdf->bhsf", q, w_phi)
        pk = torch.einsum("bhsd,hdf->bhsf", k, w_phi)
        phi_q = torch.concatenate([_softmax(pq, axis=-1), _softmax(-pq, axis=-1)], axis=-1)
        phi_k = torch.concatenate([_softmax(pk, axis=-1), _softmax(-pk, axis=-1)], axis=-1)
        kv = torch.einsum("bhsf,bhsd->bhfd", phi_k, v)
        z  = torch.einsum("bhsf->bhf", phi_k)
        num = torch.einsum("bhqf,bhfd->bhqd", phi_q, kv)
        den = torch.einsum("bhqf,bhf->bhq", phi_q, z)[..., None] + 1e-6
        o = num / den
        return (lambda x, *d: x.permute(*d))(o, 0, 2, 1, 3).reshape(B, S, D) @ wo

    x = A_x
    g = _sigmoid((x * gate_w).sum(-1, keepdims=True))
    a = _A_ref(x, A_wqkv, A_wo)
    b = _B_ref(x, B_wqkv, B_w_phi, B_wo)
    return g * a + (1 - g) * b
```

```asm
; @launch kernel=k1_kernel grid=(256,1,1) block=(512,1,1) lds=141312
; @launch kernel=k2_kernel grid=(192,1,1) block=(512,1,1) lds=99328
.amdgcn_target "amdgcn-amd-amdhsa--gfx950"
.text
.globl k1_kernel
.p2align 8
.type k1_kernel,@function
k1_kernel:
  s_cmp_ge_u32 s2, 256
  s_cbranch_scc1 K1_END
  s_load_dwordx2 s[4:5], s[0:1], 0
  s_load_dwordx2 s[6:7], s[0:1], 8
  s_load_dwordx2 s[24:25], s[0:1], 32
  s_load_dwordx2 s[26:27], s[0:1], 40
  s_load_dwordx2 s[28:29], s[0:1], 56
  s_load_dwordx2 s[30:31], s[0:1], 72
  s_load_dwordx2 s[32:33], s[0:1], 80
  s_load_dwordx2 s[64:65], s[0:1], 16
  s_load_dwordx2 s[66:67], s[0:1], 48
  s_lshr_b32 s44, s2, 4
  s_and_b32 s45, s2, 15
  s_lshr_b32 s46, s45, 3
  s_and_b32 s47, s45, 7
  v_lshrrev_b32 v2, 6, v0
  s_nop 0
  v_readfirstlane_b32 s48, v2
  v_and_b32 v1, 63, v0
  s_mov_b32 s70, 1069066811
  s_mov_b32 s71, 1069066811
  s_mov_b32 s72, 0x358637bd
  s_mov_b32 s73, 0x358637bd
  s_mov_b32 s74, 0x40000000
  s_mov_b32 s75, 0x40000000
  s_mov_b32 s84, 3216550459
  s_mov_b32 s85, 3216550459
  s_mov_b32 s86, -1
  s_mov_b32 s87, 0
  s_waitcnt lgkmcnt(0)
  s_mov_b32 s8, s4
  s_mov_b32 s9, s5
  s_mov_b32 s10, 2359296
  s_mov_b32 s11, 0x00020000
  s_cmp_eq_u32 s46, 0
  s_cselect_b32 s3, s6, s24
  s_cselect_b32 s34, s7, s25
  s_mov_b32 s12, s3
  s_mov_b32 s13, s34
  s_mov_b32 s14, 1990656
  s_mov_b32 s15, 0x00020000
  s_mov_b32 s16, s32
  s_mov_b32 s17, s33
  s_mov_b32 s18, 268435456
  s_mov_b32 s19, 0x00020000
  s_mov_b32 s20, s30
  s_mov_b32 s21, s31
  s_mov_b32 s22, 256
  s_mov_b32 s23, 0x00020000
  s_mov_b32 s36, s26
  s_mov_b32 s37, s27
  s_mov_b32 s38, 20736
  s_mov_b32 s39, 0x00020000
  s_mov_b32 s40, s28
  s_mov_b32 s41, s29
  s_mov_b32 s42, 1152
  s_mov_b32 s43, 0x00020000
  s_mov_b32 s88, s64
  s_mov_b32 s89, s65
  s_mov_b32 s90, 663552
  s_mov_b32 s91, 0x00020000
  s_mov_b32 s92, s66
  s_mov_b32 s93, s67
  s_mov_b32 s94, 663552
  s_mov_b32 s95, 0x00020000
  s_and_b32 s49, s48, 3
  s_lshl_b32 s50, s47, 2
  s_add_u32 s49, s49, s50
  s_mul_i32 s49, s49, 648
  v_and_b32 v3, 31, v1
  v_lshrrev_b32 v4, 5, v1
  v_mul_u32_u24 v5, 288, v4
  v_lshl_add_u32 v5, v3, 1, v5
  v_mov_b32 v6, 0x40000000
  v_cmp_gt_u32 vcc, 18, v3
  s_nop 1
  v_cndmask_b32 v5, v6, v5, vcc
  v_lshlrev_b32 v7, 1, v3
  v_add_u32 v7, 576, v7
  v_cmp_eq_u32 s[50:51], 0, v4
  s_and_b64 vcc, vcc, s[50:51]
  v_cndmask_b32 v7, v6, v7, vcc
  buffer_load_ushort v226, v5, s[36:39], s49 offen offset:0
  buffer_load_ushort v234, v5, s[36:39], s49 offen offset:36
  buffer_load_ushort v227, v5, s[36:39], s49 offen offset:72
  buffer_load_ushort v235, v5, s[36:39], s49 offen offset:108
  buffer_load_ushort v228, v5, s[36:39], s49 offen offset:144
  buffer_load_ushort v236, v5, s[36:39], s49 offen offset:180
  buffer_load_ushort v229, v5, s[36:39], s49 offen offset:216
  buffer_load_ushort v237, v5, s[36:39], s49 offen offset:252
  buffer_load_ushort v230, v7, s[36:39], s49 offen
  buffer_load_ushort v238, v7, s[36:39], s49 offen offset:36
  v_mov_b32 v231, 0
  v_mov_b32 v232, 0
  v_mov_b32 v233, 0
  s_cmp_ge_u32 s48, 4
  s_nop 0
  s_cbranch_scc1 K1_NONCOMPUTE
  s_lshr_b32 s49, s48, 1
  s_and_b32 s50, s48, 1
  v_and_b32 v3, 15, v1
  v_lshrrev_b32 v4, 4, v1
  v_and_b32 v5, 7, v3
  v_xor_b32 v5, v4, v5
  v_lshlrev_b32 v5, 4, v5
  v_lshl_add_u32 v5, v3, 7, v5
  s_lshl_b32 s51, s49, 13
  v_add_u32 v5, s51, v5
  v_add_u32 v216, 0, v5
  v_xor_b32 v217, 64, v216
  v_add_u32 v218, 47104, v5
  v_xor_b32 v219, 64, v218
  v_add_u32 v220, 94208, v5
  v_xor_b32 v221, 64, v220
  v_lshrrev_b32 v5, 1, v4
  v_lshlrev_b32 v5, 4, v5
  v_and_b32 v6, 1, v4
  v_lshl_add_u32 v5, v6, 2, v5
  v_lshrrev_b32 v6, 2, v3
  v_add_u32 v5, v5, v6
  v_mul_u32_u24 v5, 480, v5
  v_and_b32 v6, 3, v3
  v_lshl_add_u32 v5, v6, 3, v5
  s_mul_i32 s51, s50, 224
  s_add_u32 s51, s51, 16384
  v_add_u32 v5, s51, v5
  v_add_u32 v222, 0, v5
  v_add_u32 v223, 47104, v5
  v_add_u32 v224, 94208, v5
  s_lshl_b32 s51, s49, 6
  v_add_u32 v5, s51, v3
  v_mul_u32_u24 v5, 464, v5
  s_mul_i32 s51, s50, 224
  v_lshl_add_u32 v6, v4, 3, s51
  v_add_u32 v225, v5, v6
  s_barrier
  ds_read_b128 v[128:131], v216 offset:0
  ds_read_b64_tr_b16 v[160:161], v222 offset:0
  ds_read_b64_tr_b16 v[162:163], v222 offset:3840
  ds_read_b128 v[132:135], v216 offset:2048
  ds_read_b128 v[136:139], v216 offset:4096
  ds_read_b128 v[140:143], v216 offset:6144
  ds_read_b64_tr_b16 v[164:165], v222 offset:32
  ds_read_b64_tr_b16 v[166:167], v222 offset:3872
  ds_read_b64_tr_b16 v[168:169], v222 offset:64
  ds_read_b64_tr_b16 v[170:171], v222 offset:3904
  ds_read_b64_tr_b16 v[172:173], v222 offset:96
  ds_read_b64_tr_b16 v[174:175], v222 offset:3936
  ds_read_b64_tr_b16 v[176:177], v222 offset:128
  ds_read_b64_tr_b16 v[178:179], v222 offset:3968
  ds_read_b64_tr_b16 v[180:181], v222 offset:160
  ds_read_b64_tr_b16 v[182:183], v222 offset:4000
  ds_read_b64_tr_b16 v[184:185], v222 offset:192
  ds_read_b64_tr_b16 v[186:187], v222 offset:4032
  v_mfma_f32_16x16x32_bf16 v[16:19], v[160:163], v[128:131], 0
  s_waitcnt lgkmcnt(14)
  v_mfma_f32_16x16x32_bf16 v[20:23], v[160:163], v[132:135], 0
  ds_read_b128 v[144:147], v217 offset:0
  s_waitcnt lgkmcnt(14)
  v_mfma_f32_16x16x32_bf16 v[24:27], v[160:163], v[136:139], 0
  ds_read_b64_tr_b16 v[188:189], v222 offset:15360
  s_waitcnt lgkmcnt(14)
  v_mfma_f32_16x16x32_bf16 v[28:31], v[160:163], v[140:143], 0
  ds_read_b64_tr_b16 v[190:191], v222 offset:19200
  s_waitcnt lgkmcnt(13)
  v_mfma_f32_16x16x32_bf16 v[32:35], v[164:167], v[128:131], 0
  ds_read_b128 v[148:151], v217 offset:2048
  v_mfma_f32_16x16x32_bf16 v[36:39], v[164:167], v[132:135], 0
  ds_read_b128 v[152:155], v217 offset:4096
  v_mfma_f32_16x16x32_bf16 v[40:43], v[164:167], v[136:139], 0
  ds_read_b128 v[156:159], v217 offset:6144
  v_mfma_f32_16x16x32_bf16 v[44:47], v[164:167], v[140:143], 0
  ds_read_b64_tr_b16 v[192:193], v222 offset:15392
  v_mfma_f32_16x16x32_bf16 v[48:51], v[168:171], v[128:131], 0
  ds_read_b64_tr_b16 v[194:195], v222 offset:19232
  v_mfma_f32_16x16x32_bf16 v[52:55], v[168:171], v[132:135], 0
  ds_read_b64_tr_b16 v[196:197], v222 offset:15424
  v_mfma_f32_16x16x32_bf16 v[56:59], v[168:171], v[136:139], 0
  ds_read_b64_tr_b16 v[198:199], v222 offset:19264
  v_mfma_f32_16x16x32_bf16 v[60:63], v[168:171], v[140:143], 0
  ds_read_b64_tr_b16 v[200:201], v222 offset:15456
  v_mfma_f32_16x16x32_bf16 v[64:67], v[172:175], v[128:131], 0
  ds_read_b64_tr_b16 v[202:203], v222 offset:19296
  v_mfma_f32_16x16x32_bf16 v[68:71], v[172:175], v[132:135], 0
  ds_read_b64_tr_b16 v[204:205], v222 offset:15488
  v_mfma_f32_16x16x32_bf16 v[72:75], v[172:175], v[136:139], 0
  ds_read_b64_tr_b16 v[206:207], v222 offset:19328
  v_mfma_f32_16x16x32_bf16 v[76:79], v[172:175], v[140:143], 0
  ds_read_b64_tr_b16 v[208:209], v222 offset:15520
  v_mfma_f32_16x16x32_bf16 v[80:83], v[176:179], v[128:131], 0
  ds_read_b64_tr_b16 v[210:211], v222 offset:19360
  v_mfma_f32_16x16x32_bf16 v[84:87], v[176:179], v[132:135], 0
  ds_read_b64_tr_b16 v[212:213], v222 offset:15552
  v_mfma_f32_16x16x32_bf16 v[88:91], v[176:179], v[136:139], 0
  ds_read_b64_tr_b16 v[214:215], v222 offset:19392
  v_mfma_f32_16x16x32_bf16 v[92:95], v[176:179], v[140:143], 0
  v_mfma_f32_16x16x32_bf16 v[96:99], v[180:183], v[128:131], 0
  v_mfma_f32_16x16x32_bf16 v[100:103], v[180:183], v[132:135], 0
  v_mfma_f32_16x16x32_bf16 v[104:107], v[180:183], v[136:139], 0
  v_mfma_f32_16x16x32_bf16 v[108:111], v[180:183], v[140:143], 0
  v_mfma_f32_16x16x32_bf16 v[112:115], v[184:187], v[128:131], 0
  v_mfma_f32_16x16x32_bf16 v[116:119], v[184:187], v[132:135], 0
  v_mfma_f32_16x16x32_bf16 v[120:123], v[184:187], v[136:139], 0
  v_mfma_f32_16x16x32_bf16 v[124:127], v[184:187], v[140:143], 0
  v_mfma_f32_16x16x32_bf16 v[16:19], v[188:191], v[144:147], v[16:19]
  s_waitcnt lgkmcnt(0)
  s_barrier
  v_mfma_f32_16x16x32_bf16 v[20:23], v[188:191], v[148:151], v[20:23]
  ds_read_b128 v[128:131], v218 offset:0
  v_mfma_f32_16x16x32_bf16 v[24:27], v[188:191], v[152:155], v[24:27]
  ds_read_b64_tr_b16 v[160:161], v223 offset:0
  v_mfma_f32_16x16x32_bf16 v[28:31], v[188:191], v[156:159], v[28:31]
  ds_read_b64_tr_b16 v[162:163], v223 offset:3840
  v_mfma_f32_16x16x32_bf16 v[32:35], v[192:195], v[144:147], v[32:35]
  ds_read_b128 v[132:135], v218 offset:2048
  v_mfma_f32_16x16x32_bf16 v[36:39], v[192:195], v[148:151], v[36:39]
  ds_read_b128 v[136:139], v218 offset:4096
  v_mfma_f32_16x16x32_bf16 v[40:43], v[192:195], v[152:155], v[40:43]
  ds_read_b128 v[140:143], v218 offset:6144
  v_mfma_f32_16x16x32_bf16 v[44:47], v[192:195], v[156:159], v[44:47]
  ds_read_b64_tr_b16 v[164:165], v223 offset:32
  v_mfma_f32_16x16x32_bf16 v[48:51], v[196:199], v[144:147], v[48:51]
  ds_read_b64_tr_b16 v[166:167], v223 offset:3872
  v_mfma_f32_16x16x32_bf16 v[52:55], v[196:199], v[148:151], v[52:55]
  ds_read_b64_tr_b16 v[168:169], v223 offset:64
  v_mfma_f32_16x16x32_bf16 v[56:59], v[196:199], v[152:155], v[56:59]
  ds_read_b64_tr_b16 v[170:171], v223 offset:3904
  v_mfma_f32_16x16x32_bf16 v[60:63], v[196:199], v[156:159], v[60:63]
  ds_read_b64_tr_b16 v[172:173], v223 offset:96
  v_mfma_f32_16x16x32_bf16 v[64:67], v[200:203], v[144:147], v[64:67]
  ds_read_b64_tr_b16 v[174:175], v223 offset:3936
  v_mfma_f32_16x16x32_bf16 v[68:71], v[200:203], v[148:151], v[68:71]
  ds_read_b64_tr_b16 v[176:177], v223 offset:128
  v_mfma_f32_16x16x32_bf16 v[72:75], v[200:203], v[152:155], v[72:75]
  ds_read_b64_tr_b16 v[178:179], v223 offset:3968
  v_mfma_f32_16x16x32_bf16 v[76:79], v[200:203], v[156:159], v[76:79]
  ds_read_b64_tr_b16 v[180:181], v223 offset:160
  v_mfma_f32_16x16x32_bf16 v[80:83], v[204:207], v[144:147], v[80:83]
  ds_read_b64_tr_b16 v[182:183], v223 offset:4000
  v_mfma_f32_16x16x32_bf16 v[84:87], v[204:207], v[148:151], v[84:87]
  ds_read_b64_tr_b16 v[184:185], v223 offset:192
  v_mfma_f32_16x16x32_bf16 v[88:91], v[204:207], v[152:155], v[88:91]
  ds_read_b64_tr_b16 v[186:187], v223 offset:4032
  v_mfma_f32_16x16x32_bf16 v[92:95], v[204:207], v[156:159], v[92:95]
  v_mfma_f32_16x16x32_bf16 v[96:99], v[208:211], v[144:147], v[96:99]
  v_mfma_f32_16x16x32_bf16 v[100:103], v[208:211], v[148:151], v[100:103]
  v_mfma_f32_16x16x32_bf16 v[104:107], v[208:211], v[152:155], v[104:107]
  v_mfma_f32_16x16x32_bf16 v[108:111], v[208:211], v[156:159], v[108:111]
  v_mfma_f32_16x16x32_bf16 v[112:115], v[212:215], v[144:147], v[112:115]
  v_mfma_f32_16x16x32_bf16 v[116:119], v[212:215], v[148:151], v[116:119]
  v_mfma_f32_16x16x32_bf16 v[120:123], v[212:215], v[152:155], v[120:123]
  v_mfma_f32_16x16x32_bf16 v[124:127], v[212:215], v[156:159], v[124:127]
  v_mfma_f32_16x16x32_bf16 v[16:19], v[160:163], v[128:131], v[16:19]
  s_waitcnt lgkmcnt(14)
  v_mfma_f32_16x16x32_bf16 v[20:23], v[160:163], v[132:135], v[20:23]
  ds_read_b128 v[144:147], v219 offset:0
  s_waitcnt lgkmcnt(14)
  v_mfma_f32_16x16x32_bf16 v[24:27], v[160:163], v[136:139], v[24:27]
  ds_read_b64_tr_b16 v[188:189], v223 offset:15360
  s_waitcnt lgkmcnt(14)
  v_mfma_f32_16x16x32_bf16 v[28:31], v[160:163], v[140:143], v[28:31]
  ds_read_b64_tr_b16 v[190:191], v223 offset:19200
  s_waitcnt lgkmcnt(13)
  v_mfma_f32_16x16x32_bf16 v[32:35], v[164:167], v[128:131], v[32:35]
  ds_read_b128 v[148:151], v219 offset:2048
  v_mfma_f32_16x16x32_bf16 v[36:39], v[164:167], v[132:135], v[36:39]
  ds_read_b128 v[152:155], v219 offset:4096
  v_mfma_f32_16x16x32_bf16 v[40:43], v[164:167], v[136:139], v[40:43]
  ds_read_b128 v[156:159], v219 offset:6144
  v_mfma_f32_16x16x32_bf16 v[44:47], v[164:167], v[140:143], v[44:47]
  ds_read_b64_tr_b16 v[192:193], v223 offset:15392
  v_mfma_f32_16x16x32_bf16 v[48:51], v[168:171], v[128:131], v[48:51]
  ds_read_b64_tr_b16 v[194:195], v223 offset:19232
  v_mfma_f32_16x16x32_bf16 v[52:55], v[168:171], v[132:135], v[52:55]
  ds_read_b64_tr_b16 v[196:197], v223 offset:15424
  v_mfma_f32_16x16x32_bf16 v[56:59], v[168:171], v[136:139], v[56:59]
  ds_read_b64_tr_b16 v[198:199], v223 offset:19264
  v_mfma_f32_16x16x32_bf16 v[60:63], v[168:171], v[140:143], v[60:63]
  ds_read_b64_tr_b16 v[200:201], v223 offset:15456
  v_mfma_f32_16x16x32_bf16 v[64:67], v[172:175], v[128:131], v[64:67]
  ds_read_b64_tr_b16 v[202:203], v223 offset:19296
  v_mfma_f32_16x16x32_bf16 v[68:71], v[172:175], v[132:135], v[68:71]
  ds_read_b64_tr_b16 v[204:205], v223 offset:15488
  v_mfma_f32_16x16x32_bf16 v[72:75], v[172:175], v[136:139], v[72:75]
  ds_read_b64_tr_b16 v[206:207], v223 offset:19328
  v_mfma_f32_16x16x32_bf16 v[76:79], v[172:175], v[140:143], v[76:79]
  ds_read_b64_tr_b16 v[208:209], v223 offset:15520
  v_mfma_f32_16x16x32_bf16 v[80:83], v[176:179], v[128:131], v[80:83]
  ds_read_b64_tr_b16 v[210:211], v223 offset:19360
  v_mfma_f32_16x16x32_bf16 v[84:87], v[176:179], v[132:135], v[84:87]
  ds_read_b64_tr_b16 v[212:213], v223 offset:15552
  v_mfma_f32_16x16x32_bf16 v[88:91], v[176:179], v[136:139], v[88:91]
  ds_read_b64_tr_b16 v[214:215], v223 offset:19392
  v_mfma_f32_16x16x32_bf16 v[92:95], v[176:179], v[140:143], v[92:95]
  v_mfma_f32_16x16x32_bf16 v[96:99], v[180:183], v[128:131], v[96:99]
  v_mfma_f32_16x16x32_bf16 v[100:103], v[180:183], v[132:135], v[100:103]
  v_mfma_f32_16x16x32_bf16 v[104:107], v[180:183], v[136:139], v[104:107]
  v_mfma_f32_16x16x32_bf16 v[108:111], v[180:183], v[140:143], v[108:111]
  v_mfma_f32_16x16x32_bf16 v[112:115], v[184:187], v[128:131], v[112:115]
  v_mfma_f32_16x16x32_bf16 v[116:119], v[184:187], v[132:135], v[116:119]
  v_mfma_f32_16x16x32_bf16 v[120:123], v[184:187], v[136:139], v[120:123]
  v_mfma_f32_16x16x32_bf16 v[124:127], v[184:187], v[140:143], v[124:127]
  v_mfma_f32_16x16x32_bf16 v[16:19], v[188:191], v[144:147], v[16:19]
  s_waitcnt lgkmcnt(0)
  s_barrier
  v_mfma_f32_16x16x32_bf16 v[20:23], v[188:191], v[148:151], v[20:23]
  ds_read_b128 v[128:131], v220 offset:0
  v_mfma_f32_16x16x32_bf16 v[24:27], v[188:191], v[152:155], v[24:27]
  ds_read_b64_tr_b16 v[160:161], v224 offset:0
  v_mfma_f32_16x16x32_bf16 v[28:31], v[188:191], v[156:159], v[28:31]
  ds_read_b64_tr_b16 v[162:163], v224 offset:3840
  v_mfma_f32_16x16x32_bf16 v[32:35], v[192:195], v[144:147], v[32:35]
  ds_read_b128 v[132:135], v220 offset:2048
  v_mfma_f32_16x16x32_bf16 v[36:39], v[192:195], v[148:151], v[36:39]
  ds_read_b128 v[136:139], v220 offset:4096
  v_mfma_f32_16x16x32_bf16 v[40:43], v[192:195], v[152:155], v[40:43]
  ds_read_b128 v[140:143], v220 offset:6144
  v_mfma_f32_16x16x32_bf16 v[44:47], v[192:195], v[156:159], v[44:47]
  ds_read_b64_tr_b16 v[164:165], v224 offset:32
  v_mfma_f32_16x16x32_bf16 v[48:51], v[196:199], v[144:147], v[48:51]
  ds_read_b64_tr_b16 v[166:167], v224 offset:3872
  v_mfma_f32_16x16x32_bf16 v[52:55], v[196:199], v[148:151], v[52:55]
  ds_read_b64_tr_b16 v[168:169], v224 offset:64
  v_mfma_f32_16x16x32_bf16 v[56:59], v[196:199], v[152:155], v[56:59]
  ds_read_b64_tr_b16 v[170:171], v224 offset:3904
  v_mfma_f32_16x16x32_bf16 v[60:63], v[196:199], v[156:159], v[60:63]
  ds_read_b64_tr_b16 v[172:173], v224 offset:96
  v_mfma_f32_16x16x32_bf16 v[64:67], v[200:203], v[144:147], v[64:67]
  ds_read_b64_tr_b16 v[174:175], v224 offset:3936
  v_mfma_f32_16x16x32_bf16 v[68:71], v[200:203], v[148:151], v[68:71]
  ds_read_b64_tr_b16 v[176:177], v224 offset:128
  v_mfma_f32_16x16x32_bf16 v[72:75], v[200:203], v[152:155], v[72:75]
  ds_read_b64_tr_b16 v[178:179], v224 offset:3968
  v_mfma_f32_16x16x32_bf16 v[76:79], v[200:203], v[156:159], v[76:79]
  ds_read_b64_tr_b16 v[180:181], v224 offset:160
  v_mfma_f32_16x16x32_bf16 v[80:83], v[204:207], v[144:147], v[80:83]
  ds_read_b64_tr_b16 v[182:183], v224 offset:4000
  v_mfma_f32_16x16x32_bf16 v[84:87], v[204:207], v[148:151], v[84:87]
  ds_read_b64_tr_b16 v[184:185], v224 offset:192
  v_mfma_f32_16x16x32_bf16 v[88:91], v[204:207], v[152:155], v[88:91]
  ds_read_b64_tr_b16 v[186:187], v224 offset:4032
  v_mfma_f32_16x16x32_bf16 v[92:95], v[204:207], v[156:159], v[92:95]
  v_mfma_f32_16x16x32_bf16 v[96:99], v[208:211], v[144:147], v[96:99]
  v_mfma_f32_16x16x32_bf16 v[100:103], v[208:211], v[148:151], v[100:103]
  v_mfma_f32_16x16x32_bf16 v[104:107], v[208:211], v[152:155], v[104:107]
  v_mfma_f32_16x16x32_bf16 v[108:111], v[208:211], v[156:159], v[108:111]
  v_mfma_f32_16x16x32_bf16 v[112:115], v[212:215], v[144:147], v[112:115]
  v_mfma_f32_16x16x32_bf16 v[116:119], v[212:215], v[148:151], v[116:119]
  v_mfma_f32_16x16x32_bf16 v[120:123], v[212:215], v[152:155], v[120:123]
  v_mfma_f32_16x16x32_bf16 v[124:127], v[212:215], v[156:159], v[124:127]
  v_mfma_f32_16x16x32_bf16 v[16:19], v[160:163], v[128:131], v[16:19]
  s_waitcnt lgkmcnt(14)
  v_mfma_f32_16x16x32_bf16 v[20:23], v[160:163], v[132:135], v[20:23]
  ds_read_b128 v[144:147], v221 offset:0
  s_waitcnt lgkmcnt(14)
  v_mfma_f32_16x16x32_bf16 v[24:27], v[160:163], v[136:139], v[24:27]
  ds_read_b64_tr_b16 v[188:189], v224 offset:15360
  s_waitcnt lgkmcnt(14)
  v_mfma_f32_16x16x32_bf16 v[28:31], v[160:163], v[140:143], v[28:31]
  ds_read_b64_tr_b16 v[190:191], v224 offset:19200
  s_waitcnt lgkmcnt(13)
  v_mfma_f32_16x16x32_bf16 v[32:35], v[164:167], v[128:131], v[32:35]
  ds_read_b128 v[148:151], v221 offset:2048
  v_mfma_f32_16x16x32_bf16 v[36:39], v[164:167], v[132:135], v[36:39]
  ds_read_b128 v[152:155], v221 offset:4096
  v_mfma_f32_16x16x32_bf16 v[40:43], v[164:167], v[136:139], v[40:43]
  ds_read_b128 v[156:159], v221 offset:6144
  v_mfma_f32_16x16x32_bf16 v[44:47], v[164:167], v[140:143], v[44:47]
  ds_read_b64_tr_b16 v[192:193], v224 offset:15392
  v_mfma_f32_16x16x32_bf16 v[48:51], v[168:171], v[128:131], v[48:51]
  ds_read_b64_tr_b16 v[194:195], v224 offset:19232
  v_mfma_f32_16x16x32_bf16 v[52:55], v[168:171], v[132:135], v[52:55]
  ds_read_b64_tr_b16 v[196:197], v224 offset:15424
  v_mfma_f32_16x16x32_bf16 v[56:59], v[168:171], v[136:139], v[56:59]
  ds_read_b64_tr_b16 v[198:199], v224 offset:19264
  v_mfma_f32_16x16x32_bf16 v[60:63], v[168:171], v[140:143], v[60:63]
  ds_read_b64_tr_b16 v[200:201], v224 offset:15456
  v_mfma_f32_16x16x32_bf16 v[64:67], v[172:175], v[128:131], v[64:67]
  ds_read_b64_tr_b16 v[202:203], v224 offset:19296
  v_mfma_f32_16x16x32_bf16 v[68:71], v[172:175], v[132:135], v[68:71]
  ds_read_b64_tr_b16 v[204:205], v224 offset:15488
  v_mfma_f32_16x16x32_bf16 v[72:75], v[172:175], v[136:139], v[72:75]
  ds_read_b64_tr_b16 v[206:207], v224 offset:19328
  v_mfma_f32_16x16x32_bf16 v[76:79], v[172:175], v[140:143], v[76:79]
  ds_read_b64_tr_b16 v[208:209], v224 offset:15520
  v_mfma_f32_16x16x32_bf16 v[80:83], v[176:179], v[128:131], v[80:83]
  ds_read_b64_tr_b16 v[210:211], v224 offset:19360
  v_mfma_f32_16x16x32_bf16 v[84:87], v[176:179], v[132:135], v[84:87]
  ds_read_b64_tr_b16 v[212:213], v224 offset:15552
  v_mfma_f32_16x16x32_bf16 v[88:91], v[176:179], v[136:139], v[88:91]
  ds_read_b64_tr_b16 v[214:215], v224 offset:19392
  v_mfma_f32_16x16x32_bf16 v[92:95], v[176:179], v[140:143], v[92:95]
  v_mfma_f32_16x16x32_bf16 v[96:99], v[180:183], v[128:131], v[96:99]
  v_mfma_f32_16x16x32_bf16 v[100:103], v[180:183], v[132:135], v[100:103]
  v_mfma_f32_16x16x32_bf16 v[104:107], v[180:183], v[136:139], v[104:107]
  v_mfma_f32_16x16x32_bf16 v[108:111], v[180:183], v[140:143], v[108:111]
  v_mfma_f32_16x16x32_bf16 v[112:115], v[184:187], v[128:131], v[112:115]
  v_mfma_f32_16x16x32_bf16 v[116:119], v[184:187], v[132:135], v[116:119]
  v_mfma_f32_16x16x32_bf16 v[120:123], v[184:187], v[136:139], v[120:123]
  v_mfma_f32_16x16x32_bf16 v[124:127], v[184:187], v[140:143], v[124:127]
  v_mfma_f32_16x16x32_bf16 v[16:19], v[188:191], v[144:147], v[16:19]
  s_waitcnt lgkmcnt(0)
  s_barrier
  v_mfma_f32_16x16x32_bf16 v[20:23], v[188:191], v[148:151], v[20:23]
  ds_read_b128 v[128:131], v216 offset:0
  v_mfma_f32_16x16x32_bf16 v[24:27], v[188:191], v[152:155], v[24:27]
  ds_read_b64_tr_b16 v[160:161], v222 offset:0
  v_mfma_f32_16x16x32_bf16 v[28:31], v[188:191], v[156:159], v[28:31]
  ds_read_b64_tr_b16 v[162:163], v222 offset:3840
  v_mfma_f32_16x16x32_bf16 v[32:35], v[192:195], v[144:147], v[32:35]
  ds_read_b128 v[132:135], v216 offset:2048
  v_mfma_f32_16x16x32_bf16 v[36:39], v[192:195], v[148:151], v[36:39]
  ds_read_b128 v[136:139], v216 offset:4096
  v_mfma_f32_16x16x32_bf16 v[40:43], v[192:195], v[152:155], v[40:43]
  ds_read_b128 v[140:143], v216 offset:6144
  v_mfma_f32_16x16x32_bf16 v[44:47], v[192:195], v[156:159], v[44:47]
  ds_read_b64_tr_b16 v[164:165], v222 offset:32
  v_mfma_f32_16x16x32_bf16 v[48:51], v[196:199], v[144:147], v[48:51]
  ds_read_b64_tr_b16 v[166:167], v222 offset:3872
  v_mfma_f32_16x16x32_bf16 v[52:55], v[196:199], v[148:151], v[52:55]
  ds_read_b64_tr_b16 v[168:169], v222 offset:64
  v_mfma_f32_16x16x32_bf16 v[56:59], v[196:199], v[152:155], v[56:59]
  ds_read_b64_tr_b16 v[170:171], v222 offset:3904
  v_mfma_f32_16x16x32_bf16 v[60:63], v[196:199], v[156:159], v[60:63]
  ds_read_b64_tr_b16 v[172:173], v222 offset:96
  v_mfma_f32_16x16x32_bf16 v[64:67], v[200:203], v[144:147], v[64:67]
  ds_read_b64_tr_b16 v[174:175], v222 offset:3936
  v_mfma_f32_16x16x32_bf16 v[68:71], v[200:203], v[148:151], v[68:71]
  ds_read_b64_tr_b16 v[176:177], v222 offset:128
  v_mfma_f32_16x16x32_bf16 v[72:75], v[200:203], v[152:155], v[72:75]
  ds_read_b64_tr_b16 v[178:179], v222 offset:3968
  v_mfma_f32_16x16x32_bf16 v[76:79], v[200:203], v[156:159], v[76:79]
  ds_read_b64_tr_b16 v[180:181], v222 offset:160
  v_mfma_f32_16x16x32_bf16 v[80:83], v[204:207], v[144:147], v[80:83]
  ds_read_b64_tr_b16 v[182:183], v222 offset:4000
  v_mfma_f32_16x16x32_bf16 v[84:87], v[204:207], v[148:151], v[84:87]
  ds_read_b64_tr_b16 v[184:185], v222 offset:192
  v_mfma_f32_16x16x32_bf16 v[88:91], v[204:207], v[152:155], v[88:91]
  ds_read_b64_tr_b16 v[186:187], v222 offset:4032
  v_mfma_f32_16x16x32_bf16 v[92:95], v[204:207], v[156:159], v[92:95]
  v_mfma_f32_16x16x32_bf16 v[96:99], v[208:211], v[144:147], v[96:99]
  v_mfma_f32_16x16x32_bf16 v[100:103], v[208:211], v[148:151], v[100:103]
  v_mfma_f32_16x16x32_bf16 v[104:107], v[208:211], v[152:155], v[104:107]
  v_mfma_f32_16x16x32_bf16 v[108:111], v[208:211], v[156:159], v[108:111]
  v_mfma_f32_16x16x32_bf16 v[112:115], v[212:215], v[144:147], v[112:115]
  v_mfma_f32_16x16x32_bf16 v[116:119], v[212:215], v[148:151], v[116:119]
  v_mfma_f32_16x16x32_bf16 v[120:123], v[212:215], v[152:155], v[120:123]
  v_mfma_f32_16x16x32_bf16 v[124:127], v[212:215], v[156:159], v[124:127]
  v_mfma_f32_16x16x32_bf16 v[16:19], v[160:163], v[128:131], v[16:19]
  s_waitcnt lgkmcnt(14)
  v_mfma_f32_16x16x32_bf16 v[20:23], v[160:163], v[132:135], v[20:23]
  ds_read_b128 v[144:147], v217 offset:0
  s_waitcnt lgkmcnt(14)
  v_mfma_f32_16x16x32_bf16 v[24:27], v[160:163], v[136:139], v[24:27]
  ds_read_b64_tr_b16 v[188:189], v222 offset:15360
  s_waitcnt lgkmcnt(14)
  v_mfma_f32_16x16x32_bf16 v[28:31], v[160:163], v[140:143], v[28:31]
  ds_read_b64_tr_b16 v[190:191], v222 offset:19200
  s_waitcnt lgkmcnt(13)
  v_mfma_f32_16x16x32_bf16 v[32:35], v[164:167], v[128:131], v[32:35]
  ds_read_b128 v[148:151], v217 offset:2048
  v_mfma_f32_16x16x32_bf16 v[36:39], v[164:167], v[132:135], v[36:39]
  ds_read_b128 v[152:155], v217 offset:4096
  v_mfma_f32_16x16x32_bf16 v[40:43], v[164:167], v[136:139], v[40:43]
  ds_read_b128 v[156:159], v217 offset:6144
  v_mfma_f32_16x16x32_bf16 v[44:47], v[164:167], v[140:143], v[44:47]
  ds_read_b64_tr_b16 v[192:193], v222 offset:15392
  v_mfma_f32_16x16x32_bf16 v[48:51], v[168:171], v[128:131], v[48:51]
  ds_read_b64_tr_b16 v[194:195], v222 offset:19232
  v_mfma_f32_16x16x32_bf16 v[52:55], v[168:171], v[132:135], v[52:55]
  ds_read_b64_tr_b16 v[196:197], v222 offset:15424
  v_mfma_f32_16x16x32_bf16 v[56:59], v[168:171], v[136:139], v[56:59]
  ds_read_b64_tr_b16 v[198:199], v222 offset:19264
  v_mfma_f32_16x16x32_bf16 v[60:63], v[168:171], v[140:143], v[60:63]
  ds_read_b64_tr_b16 v[200:201], v222 offset:15456
  v_mfma_f32_16x16x32_bf16 v[64:67], v[172:175], v[128:131], v[64:67]
  ds_read_b64_tr_b16 v[202:203], v222 offset:19296
  v_mfma_f32_16x16x32_bf16 v[68:71], v[172:175], v[132:135], v[68:71]
  ds_read_b64_tr_b16 v[204:205], v222 offset:15488
  v_mfma_f32_16x16x32_bf16 v[72:75], v[172:175], v[136:139], v[72:75]
  ds_read_b64_tr_b16 v[206:207], v222 offset:19328
  v_mfma_f32_16x16x32_bf16 v[76:79], v[172:175], v[140:143], v[76:79]
  ds_read_b64_tr_b16 v[208:209], v222 offset:15520
  v_mfma_f32_16x16x32_bf16 v[80:83], v[176:179], v[128:131], v[80:83]
  ds_read_b64_tr_b16 v[210:211], v222 offset:19360
  v_mfma_f32_16x16x32_bf16 v[84:87], v[176:179], v[132:135], v[84:87]
  ds_read_b64_tr_b16 v[212:213], v222 offset:15552
  v_mfma_f32_16x16x32_bf16 v[88:91], v[176:179], v[136:139], v[88:91]
  ds_read_b64_tr_b16 v[214:215], v222 offset:19392
  v_mfma_f32_16x16x32_bf16 v[92:95], v[176:179], v[140:143], v[92:95]
  v_mfma_f32_16x16x32_bf16 v[96:99], v[180:183], v[128:131], v[96:99]
  v_mfma_f32_16x16x32_bf16 v[100:103], v[180:183], v[132:135], v[100:103]
  v_mfma_f32_16x16x32_bf16 v[104:107], v[180:183], v[136:139], v[104:107]
  v_mfma_f32_16x16x32_bf16 v[108:111], v[180:183], v[140:143], v[108:111]
  v_mfma_f32_16x16x32_bf16 v[112:115], v[184:187], v[128:131], v[112:115]
  v_mfma_f32_16x16x32_bf16 v[116:119], v[184:187], v[132:135], v[116:119]
  v_mfma_f32_16x16x32_bf16 v[120:123], v[184:187], v[136:139], v[120:123]
  v_mfma_f32_16x16x32_bf16 v[124:127], v[184:187], v[140:143], v[124:127]
  v_mfma_f32_16x16x32_bf16 v[16:19], v[188:191], v[144:147], v[16:19]
  s_waitcnt lgkmcnt(0)
  s_barrier
  v_mfma_f32_16x16x32_bf16 v[20:23], v[188:191], v[148:151], v[20:23]
  ds_read_b128 v[128:131], v218 offset:0
  v_mfma_f32_16x16x32_bf16 v[24:27], v[188:191], v[152:155], v[24:27]
  ds_read_b64_tr_b16 v[160:161], v223 offset:0
  v_mfma_f32_16x16x32_bf16 v[28:31], v[188:191], v[156:159], v[28:31]
  ds_read_b64_tr_b16 v[162:163], v223 offset:3840
  v_mfma_f32_16x16x32_bf16 v[32:35], v[192:195], v[144:147], v[32:35]
  ds_read_b128 v[132:135], v218 offset:2048
  v_mfma_f32_16x16x32_bf16 v[36:39], v[192:195], v[148:151], v[36:39]
  ds_read_b128 v[136:139], v218 offset:4096
  v_mfma_f32_16x16x32_bf16 v[40:43], v[192:195], v[152:155], v[40:43]
  ds_read_b128 v[140:143], v218 offset:6144
  v_mfma_f32_16x16x32_bf16 v[44:47], v[192:195], v[156:159], v[44:47]
  ds_read_b64_tr_b16 v[164:165], v223 offset:32
  v_mfma_f32_16x16x32_bf16 v[48:51], v[196:199], v[144:147], v[48:51]
  ds_read_b64_tr_b16 v[166:167], v223 offset:3872
  v_mfma_f32_16x16x32_bf16 v[52:55], v[196:199], v[148:151], v[52:55]
  ds_read_b64_tr_b16 v[168:169], v223 offset:64
  v_mfma_f32_16x16x32_bf16 v[56:59], v[196:199], v[152:155], v[56:59]
  ds_read_b64_tr_b16 v[170:171], v223 offset:3904
  v_mfma_f32_16x16x32_bf16 v[60:63], v[196:199], v[156:159], v[60:63]
  ds_read_b64_tr_b16 v[172:173], v223 offset:96
  v_mfma_f32_16x16x32_bf16 v[64:67], v[200:203], v[144:147], v[64:67]
  ds_read_b64_tr_b16 v[174:175], v223 offset:3936
  v_mfma_f32_16x16x32_bf16 v[68:71], v[200:203], v[148:151], v[68:71]
  ds_read_b64_tr_b16 v[176:177], v223 offset:128
  v_mfma_f32_16x16x32_bf16 v[72:75], v[200:203], v[152:155], v[72:75]
  ds_read_b64_tr_b16 v[178:179], v223 offset:3968
  v_mfma_f32_16x16x32_bf16 v[76:79], v[200:203], v[156:159], v[76:79]
  ds_read_b64_tr_b16 v[180:181], v223 offset:160
  v_mfma_f32_16x16x32_bf16 v[80:83], v[204:207], v[144:147], v[80:83]
  ds_read_b64_tr_b16 v[182:183], v223 offset:4000
  v_mfma_f32_16x16x32_bf16 v[84:87], v[204:207], v[148:151], v[84:87]
  ds_read_b64_tr_b16 v[184:185], v223 offset:192
  v_mfma_f32_16x16x32_bf16 v[88:91], v[204:207], v[152:155], v[88:91]
  ds_read_b64_tr_b16 v[186:187], v223 offset:4032
  v_mfma_f32_16x16x32_bf16 v[92:95], v[204:207], v[156:159], v[92:95]
  v_mfma_f32_16x16x32_bf16 v[96:99], v[208:211], v[144:147], v[96:99]
  v_mfma_f32_16x16x32_bf16 v[100:103], v[208:211], v[148:151], v[100:103]
  v_mfma_f32_16x16x32_bf16 v[104:107], v[208:211], v[152:155], v[104:107]
  v_mfma_f32_16x16x32_bf16 v[108:111], v[208:211], v[156:159], v[108:111]
  v_mfma_f32_16x16x32_bf16 v[112:115], v[212:215], v[144:147], v[112:115]
  v_mfma_f32_16x16x32_bf16 v[116:119], v[212:215], v[148:151], v[116:119]
  v_mfma_f32_16x16x32_bf16 v[120:123], v[212:215], v[152:155], v[120:123]
  v_mfma_f32_16x16x32_bf16 v[124:127], v[212:215], v[156:159], v[124:127]
  v_mfma_f32_16x16x32_bf16 v[16:19], v[160:163], v[128:131], v[16:19]
  s_waitcnt lgkmcnt(14)
  v_mfma_f32_16x16x32_bf16 v[20:23], v[160:163], v[132:135], v[20:23]
  ds_read_b128 v[144:147], v219 offset:0
  s_waitcnt lgkmcnt(14)
  v_mfma_f32_16x16x32_bf16 v[24:27], v[160:163], v[136:139], v[24:27]
  ds_read_b64_tr_b16 v[188:189], v223 offset:15360
  s_waitcnt lgkmcnt(14)
  v_mfma_f32_16x16x32_bf16 v[28:31], v[160:163], v[140:143], v[28:31]
  ds_read_b64_tr_b16 v[190:191], v223 offset:19200
  s_waitcnt lgkmcnt(13)
  v_mfma_f32_16x16x32_bf16 v[32:35], v[164:167], v[128:131], v[32:35]
  ds_read_b128 v[148:151], v219 offset:2048
  v_mfma_f32_16x16x32_bf16 v[36:39], v[164:167], v[132:135], v[36:39]
  ds_read_b128 v[152:155], v219 offset:4096
  v_mfma_f32_16x16x32_bf16 v[40:43], v[164:167], v[136:139], v[40:43]
  ds_read_b128 v[156:159], v219 offset:6144
  v_mfma_f32_16x16x32_bf16 v[44:47], v[164:167], v[140:143], v[44:47]
  ds_read_b64_tr_b16 v[192:193], v223 offset:15392
  v_mfma_f32_16x16x32_bf16 v[48:51], v[168:171], v[128:131], v[48:51]
  ds_read_b64_tr_b16 v[194:195], v223 offset:19232
  v_mfma_f32_16x16x32_bf16 v[52:55], v[168:171], v[132:135], v[52:55]
  ds_read_b64_tr_b16 v[196:197], v223 offset:15424
  v_mfma_f32_16x16x32_bf16 v[56:59], v[168:171], v[136:139], v[56:59]
  ds_read_b64_tr_b16 v[198:199], v223 offset:19264
  v_mfma_f32_16x16x32_bf16 v[60:63], v[168:171], v[140:143], v[60:63]
  ds_read_b64_tr_b16 v[200:201], v223 offset:15456
  v_mfma_f32_16x16x32_bf16 v[64:67], v[172:175], v[128:131], v[64:67]
  ds_read_b64_tr_b16 v[202:203], v223 offset:19296
  v_mfma_f32_16x16x32_bf16 v[68:71], v[172:175], v[132:135], v[68:71]
  ds_read_b64_tr_b16 v[204:205], v223 offset:15488
  v_mfma_f32_16x16x32_bf16 v[72:75], v[172:175], v[136:139], v[72:75]
  ds_read_b64_tr_b16 v[206:207], v223 offset:19328
  v_mfma_f32_16x16x32_bf16 v[76:79], v[172:175], v[140:143], v[76:79]
  ds_read_b64_tr_b16 v[208:209], v223 offset:15520
  v_mfma_f32_16x16x32_bf16 v[80:83], v[176:179], v[128:131], v[80:83]
  ds_read_b64_tr_b16 v[210:211], v223 offset:19360
  v_mfma_f32_16x16x32_bf16 v[84:87], v[176:179], v[132:135], v[84:87]
  ds_read_b64_tr_b16 v[212:213], v223 offset:15552
  v_mfma_f32_16x16x32_bf16 v[88:91], v[176:179], v[136:139], v[88:91]
  ds_read_b64_tr_b16 v[214:215], v223 offset:19392
  v_mfma_f32_16x16x32_bf16 v[92:95], v[176:179], v[140:143], v[92:95]
  v_mfma_f32_16x16x32_bf16 v[96:99], v[180:183], v[128:131], v[96:99]
  v_mfma_f32_16x16x32_bf16 v[100:103], v[180:183], v[132:135], v[100:103]
  v_mfma_f32_16x16x32_bf16 v[104:107], v[180:183], v[136:139], v[104:107]
  v_mfma_f32_16x16x32_bf16 v[108:111], v[180:183], v[140:143], v[108:111]
  v_mfma_f32_16x16x32_bf16 v[112:115], v[184:187], v[128:131], v[112:115]
  v_mfma_f32_16x16x32_bf16 v[116:119], v[184:187], v[132:135], v[116:119]
  v_mfma_f32_16x16x32_bf16 v[120:123], v[184:187], v[136:139], v[120:123]
  v_mfma_f32_16x16x32_bf16 v[124:127], v[184:187], v[140:143], v[124:127]
  v_mfma_f32_16x16x32_bf16 v[16:19], v[188:191], v[144:147], v[16:19]
  s_waitcnt lgkmcnt(0)
  s_barrier
  v_mfma_f32_16x16x32_bf16 v[20:23], v[188:191], v[148:151], v[20:23]
  ds_read_b128 v[128:131], v220 offset:0
  v_mfma_f32_16x16x32_bf16 v[24:27], v[188:191], v[152:155], v[24:27]
  ds_read_b64_tr_b16 v[160:161], v224 offset:0
  v_mfma_f32_16x16x32_bf16 v[28:31], v[188:191], v[156:159], v[28:31]
  ds_read_b64_tr_b16 v[162:163], v224 offset:3840
  v_mfma_f32_16x16x32_bf16 v[32:35], v[192:195], v[144:147], v[32:35]
  ds_read_b128 v[132:135], v220 offset:2048
  v_mfma_f32_16x16x32_bf16 v[36:39], v[192:195], v[148:151], v[36:39]
  ds_read_b128 v[136:139], v220 offset:4096
  v_mfma_f32_16x16x32_bf16 v[40:43], v[192:195], v[152:155], v[40:43]
  ds_read_b128 v[140:143], v220 offset:6144
  v_mfma_f32_16x16x32_bf16 v[44:47], v[192:195], v[156:159], v[44:47]
  ds_read_b64_tr_b16 v[164:165], v224 offset:32
  v_mfma_f32_16x16x32_bf16 v[48:51], v[196:199], v[144:147], v[48:51]
  ds_read_b64_tr_b16 v[166:167], v224 offset:3872
  v_mfma_f32_16x16x32_bf16 v[52:55], v[196:199], v[148:151], v[52:55]
  ds_read_b64_tr_b16 v[168:169], v224 offset:64
  v_mfma_f32_16x16x32_bf16 v[56:59], v[196:199], v[152:155], v[56:59]
  ds_read_b64_tr_b16 v[170:171], v224 offset:3904
  v_mfma_f32_16x16x32_bf16 v[60:63], v[196:199], v[156:159], v[60:63]
  ds_read_b64_tr_b16 v[172:173], v224 offset:96
  v_mfma_f32_16x16x32_bf16 v[64:67], v[200:203], v[144:147], v[64:67]
  ds_read_b64_tr_b16 v[174:175], v224 offset:3936
  v_mfma_f32_16x16x32_bf16 v[68:71], v[200:203], v[148:151], v[68:71]
  ds_read_b64_tr_b16 v[176:177], v224 offset:128
  v_mfma_f32_16x16x32_bf16 v[72:75], v[200:203], v[152:155], v[72:75]
  ds_read_b64_tr_b16 v[178:179], v224 offset:3968
  v_mfma_f32_16x16x32_bf16 v[76:79], v[200:203], v[156:159], v[76:79]
  ds_read_b64_tr_b16 v[180:181], v224 offset:160
  v_mfma_f32_16x16x32_bf16 v[80:83], v[204:207], v[144:147], v[80:83]
  ds_read_b64_tr_b16 v[182:183], v224 offset:4000
  v_mfma_f32_16x16x32_bf16 v[84:87], v[204:207], v[148:151], v[84:87]
  ds_read_b64_tr_b16 v[184:185], v224 offset:192
  v_mfma_f32_16x16x32_bf16 v[88:91], v[204:207], v[152:155], v[88:91]
  ds_read_b64_tr_b16 v[186:187], v224 offset:4032
  v_mfma_f32_16x16x32_bf16 v[92:95], v[204:207], v[156:159], v[92:95]
  v_mfma_f32_16x16x32_bf16 v[96:99], v[208:211], v[144:147], v[96:99]
  v_mfma_f32_16x16x32_bf16 v[100:103], v[208:211], v[148:151], v[100:103]
  v_mfma_f32_16x16x32_bf16 v[104:107], v[208:211], v[152:155], v[104:107]
  v_mfma_f32_16x16x32_bf16 v[108:111], v[208:211], v[156:159], v[108:111]
  v_mfma_f32_16x16x32_bf16 v[112:115], v[212:215], v[144:147], v[112:115]
  v_mfma_f32_16x16x32_bf16 v[116:119], v[212:215], v[148:151], v[116:119]
  v_mfma_f32_16x16x32_bf16 v[120:123], v[212:215], v[152:155], v[120:123]
  v_mfma_f32_16x16x32_bf16 v[124:127], v[212:215], v[156:159], v[124:127]
  v_mfma_f32_16x16x32_bf16 v[16:19], v[160:163], v[128:131], v[16:19]
  s_waitcnt lgkmcnt(14)
  v_mfma_f32_16x16x32_bf16 v[20:23], v[160:163], v[132:135], v[20:23]
  ds_read_b128 v[144:147], v221 offset:0
  s_waitcnt lgkmcnt(14)
  v_mfma_f32_16x16x32_bf16 v[24:27], v[160:163], v[136:139], v[24:27]
  ds_read_b64_tr_b16 v[188:189], v224 offset:15360
  s_waitcnt lgkmcnt(14)
  v_mfma_f32_16x16x32_bf16 v[28:31], v[160:163], v[140:143], v[28:31]
  ds_read_b64_tr_b16 v[190:191], v224 offset:19200
  s_waitcnt lgkmcnt(13)
  v_mfma_f32_16x16x32_bf16 v[32:35], v[164:167], v[128:131], v[32:35]
  ds_read_b128 v[148:151], v221 offset:2048
  v_mfma_f32_16x16x32_bf16 v[36:39], v[164:167], v[132:135], v[36:39]
  ds_read_b128 v[152:155], v221 offset:4096
  v_mfma_f32_16x16x32_bf16 v[40:43], v[164:167], v[136:139], v[40:43]
  ds_read_b128 v[156:159], v221 offset:6144
  v_mfma_f32_16x16x32_bf16 v[44:47], v[164:167], v[140:143], v[44:47]
  ds_read_b64_tr_b16 v[192:193], v224 offset:15392
  v_mfma_f32_16x16x32_bf16 v[48:51], v[168:171], v[128:131], v[48:51]
  ds_read_b64_tr_b16 v[194:195], v224 offset:19232
  v_mfma_f32_16x16x32_bf16 v[52:55], v[168:171], v[132:135], v[52:55]
  ds_read_b64_tr_b16 v[196:197], v224 offset:15424
  v_mfma_f32_16x16x32_bf16 v[56:59], v[168:171], v[136:139], v[56:59]
  ds_read_b64_tr_b16 v[198:199], v224 offset:19264
  v_mfma_f32_16x16x32_bf16 v[60:63], v[168:171], v[140:143], v[60:63]
  ds_read_b64_tr_b16 v[200:201], v224 offset:15456
  v_mfma_f32_16x16x32_bf16 v[64:67], v[172:175], v[128:131], v[64:67]
  ds_read_b64_tr_b16 v[202:203], v224 offset:19296
  v_mfma_f32_16x16x32_bf16 v[68:71], v[172:175], v[132:135], v[68:71]
  ds_read_b64_tr_b16 v[204:205], v224 offset:15488
  v_mfma_f32_16x16x32_bf16 v[72:75], v[172:175], v[136:139], v[72:75]
  ds_read_b64_tr_b16 v[206:207], v224 offset:19328
  v_mfma_f32_16x16x32_bf16 v[76:79], v[172:175], v[140:143], v[76:79]
  ds_read_b64_tr_b16 v[208:209], v224 offset:15520
  v_mfma_f32_16x16x32_bf16 v[80:83], v[176:179], v[128:131], v[80:83]
  ds_read_b64_tr_b16 v[210:211], v224 offset:19360
  v_mfma_f32_16x16x32_bf16 v[84:87], v[176:179], v[132:135], v[84:87]
  ds_read_b64_tr_b16 v[212:213], v224 offset:15552
  v_mfma_f32_16x16x32_bf16 v[88:91], v[176:179], v[136:139], v[88:91]
  ds_read_b64_tr_b16 v[214:215], v224 offset:19392
  v_mfma_f32_16x16x32_bf16 v[92:95], v[176:179], v[140:143], v[92:95]
  v_mfma_f32_16x16x32_bf16 v[96:99], v[180:183], v[128:131], v[96:99]
  v_mfma_f32_16x16x32_bf16 v[100:103], v[180:183], v[132:135], v[100:103]
  v_mfma_f32_16x16x32_bf16 v[104:107], v[180:183], v[136:139], v[104:107]
  v_mfma_f32_16x16x32_bf16 v[108:111], v[180:183], v[140:143], v[108:111]
  v_mfma_f32_16x16x32_bf16 v[112:115], v[184:187], v[128:131], v[112:115]
  v_mfma_f32_16x16x32_bf16 v[116:119], v[184:187], v[132:135], v[116:119]
  v_mfma_f32_16x16x32_bf16 v[120:123], v[184:187], v[136:139], v[120:123]
  v_mfma_f32_16x16x32_bf16 v[124:127], v[184:187], v[140:143], v[124:127]
  v_mfma_f32_16x16x32_bf16 v[16:19], v[188:191], v[144:147], v[16:19]
  s_waitcnt lgkmcnt(0)
  s_barrier
  v_mfma_f32_16x16x32_bf16 v[20:23], v[188:191], v[148:151], v[20:23]
  ds_read_b128 v[128:131], v216 offset:0
  v_mfma_f32_16x16x32_bf16 v[24:27], v[188:191], v[152:155], v[24:27]
  ds_read_b64_tr_b16 v[160:161], v222 offset:0
  v_mfma_f32_16x16x32_bf16 v[28:31], v[188:191], v[156:159], v[28:31]
  ds_read_b64_tr_b16 v[162:163], v222 offset:3840
  v_mfma_f32_16x16x32_bf16 v[32:35], v[192:195], v[144:147], v[32:35]
  ds_read_b128 v[132:135], v216 offset:2048
  v_mfma_f32_16x16x32_bf16 v[36:39], v[192:195], v[148:151], v[36:39]
  ds_read_b128 v[136:139], v216 offset:4096
  v_mfma_f32_16x16x32_bf16 v[40:43], v[192:195], v[152:155], v[40:43]
  ds_read_b128 v[140:143], v216 offset:6144
  v_mfma_f32_16x16x32_bf16 v[44:47], v[192:195], v[156:159], v[44:47]
  ds_read_b64_tr_b16 v[164:165], v222 offset:32
  v_mfma_f32_16x16x32_bf16 v[48:51], v[196:199], v[144:147], v[48:51]
  ds_read_b64_tr_b16 v[166:167], v222 offset:3872
  v_mfma_f32_16x16x32_bf16 v[52:55], v[196:199], v[148:151], v[52:55]
  ds_read_b64_tr_b16 v[168:169], v222 offset:64
  v_mfma_f32_16x16x32_bf16 v[56:59], v[196:199], v[152:155], v[56:59]
  ds_read_b64_tr_b16 v[170:171], v222 offset:3904
  v_mfma_f32_16x16x32_bf16 v[60:63], v[196:199], v[156:159], v[60:63]
  ds_read_b64_tr_b16 v[172:173], v222 offset:96
  v_mfma_f32_16x16x32_bf16 v[64:67], v[200:203], v[144:147], v[64:67]
  ds_read_b64_tr_b16 v[174:175], v222 offset:3936
  v_mfma_f32_16x16x32_bf16 v[68:71], v[200:203], v[148:151], v[68:71]
  ds_read_b64_tr_b16 v[176:177], v222 offset:128
  v_mfma_f32_16x16x32_bf16 v[72:75], v[200:203], v[152:155], v[72:75]
  ds_read_b64_tr_b16 v[178:179], v222 offset:3968
  v_mfma_f32_16x16x32_bf16 v[76:79], v[200:203], v[156:159], v[76:79]
  ds_read_b64_tr_b16 v[180:181], v222 offset:160
  v_mfma_f32_16x16x32_bf16 v[80:83], v[204:207], v[144:147], v[80:83]
  ds_read_b64_tr_b16 v[182:183], v222 offset:4000
  v_mfma_f32_16x16x32_bf16 v[84:87], v[204:207], v[148:151], v[84:87]
  ds_read_b64_tr_b16 v[184:185], v222 offset:192
  v_mfma_f32_16x16x32_bf16 v[88:91], v[204:207], v[152:155], v[88:91]
  ds_read_b64_tr_b16 v[186:187], v222 offset:4032
  v_mfma_f32_16x16x32_bf16 v[92:95], v[204:207], v[156:159], v[92:95]
  v_mfma_f32_16x16x32_bf16 v[96:99], v[208:211], v[144:147], v[96:99]
  v_mfma_f32_16x16x32_bf16 v[100:103], v[208:211], v[148:151], v[100:103]
  v_mfma_f32_16x16x32_bf16 v[104:107], v[208:211], v[152:155], v[104:107]
  v_mfma_f32_16x16x32_bf16 v[108:111], v[208:211], v[156:159], v[108:111]
  v_mfma_f32_16x16x32_bf16 v[112:115], v[212:215], v[144:147], v[112:115]
  v_mfma_f32_16x16x32_bf16 v[116:119], v[212:215], v[148:151], v[116:119]
  v_mfma_f32_16x16x32_bf16 v[120:123], v[212:215], v[152:155], v[120:123]
  v_mfma_f32_16x16x32_bf16 v[124:127], v[212:215], v[156:159], v[124:127]
  v_mfma_f32_16x16x32_bf16 v[16:19], v[160:163], v[128:131], v[16:19]
  s_waitcnt lgkmcnt(14)
  v_mfma_f32_16x16x32_bf16 v[20:23], v[160:163], v[132:135], v[20:23]
  ds_read_b128 v[144:147], v217 offset:0
  s_waitcnt lgkmcnt(14)
  v_mfma_f32_16x16x32_bf16 v[24:27], v[160:163], v[136:139], v[24:27]
  ds_read_b64_tr_b16 v[188:189], v222 offset:15360
  s_waitcnt lgkmcnt(14)
  v_mfma_f32_16x16x32_bf16 v[28:31], v[160:163], v[140:143], v[28:31]
  ds_read_b64_tr_b16 v[190:191], v222 offset:19200
  s_waitcnt lgkmcnt(13)
  v_mfma_f32_16x16x32_bf16 v[32:35], v[164:167], v[128:131], v[32:35]
  ds_read_b128 v[148:151], v217 offset:2048
  v_mfma_f32_16x16x32_bf16 v[36:39], v[164:167], v[132:135], v[36:39]
  ds_read_b128 v[152:155], v217 offset:4096
  v_mfma_f32_16x16x32_bf16 v[40:43], v[164:167], v[136:139], v[40:43]
  ds_read_b128 v[156:159], v217 offset:6144
  v_mfma_f32_16x16x32_bf16 v[44:47], v[164:167], v[140:143], v[44:47]
  ds_read_b64_tr_b16 v[192:193], v222 offset:15392
  v_mfma_f32_16x16x32_bf16 v[48:51], v[168:171], v[128:131], v[48:51]
  ds_read_b64_tr_b16 v[194:195], v222 offset:19232
  v_mfma_f32_16x16x32_bf16 v[52:55], v[168:171], v[132:135], v[52:55]
  ds_read_b64_tr_b16 v[196:197], v222 offset:15424
  v_mfma_f32_16x16x32_bf16 v[56:59], v[168:171], v[136:139], v[56:59]
  ds_read_b64_tr_b16 v[198:199], v222 offset:19264
  v_mfma_f32_16x16x32_bf16 v[60:63], v[168:171], v[140:143], v[60:63]
  ds_read_b64_tr_b16 v[200:201], v222 offset:15456
  v_mfma_f32_16x16x32_bf16 v[64:67], v[172:175], v[128:131], v[64:67]
  ds_read_b64_tr_b16 v[202:203], v222 offset:19296
  v_mfma_f32_16x16x32_bf16 v[68:71], v[172:175], v[132:135], v[68:71]
  ds_read_b64_tr_b16 v[204:205], v222 offset:15488
  v_mfma_f32_16x16x32_bf16 v[72:75], v[172:175], v[136:139], v[72:75]
  ds_read_b64_tr_b16 v[206:207], v222 offset:19328
  v_mfma_f32_16x16x32_bf16 v[76:79], v[172:175], v[140:143], v[76:79]
  ds_read_b64_tr_b16 v[208:209], v222 offset:15520
  v_mfma_f32_16x16x32_bf16 v[80:83], v[176:179], v[128:131], v[80:83]
  ds_read_b64_tr_b16 v[210:211], v222 offset:19360
  v_mfma_f32_16x16x32_bf16 v[84:87], v[176:179], v[132:135], v[84:87]
  ds_read_b64_tr_b16 v[212:213], v222 offset:15552
  v_mfma_f32_16x16x32_bf16 v[88:91], v[176:179], v[136:139], v[88:91]
  ds_read_b64_tr_b16 v[214:215], v222 offset:19392
  v_mfma_f32_16x16x32_bf16 v[92:95], v[176:179], v[140:143], v[92:95]
  v_mfma_f32_16x16x32_bf16 v[96:99], v[180:183], v[128:131], v[96:99]
  v_mfma_f32_16x16x32_bf16 v[100:103], v[180:183], v[132:135], v[100:103]
  v_mfma_f32_16x16x32_bf16 v[104:107], v[180:183], v[136:139], v[104:107]
  v_mfma_f32_16x16x32_bf16 v[108:111], v[180:183], v[140:143], v[108:111]
  v_mfma_f32_16x16x32_bf16 v[112:115], v[184:187], v[128:131], v[112:115]
  v_mfma_f32_16x16x32_bf16 v[116:119], v[184:187], v[132:135], v[116:119]
  v_mfma_f32_16x16x32_bf16 v[120:123], v[184:187], v[136:139], v[120:123]
  v_mfma_f32_16x16x32_bf16 v[124:127], v[184:187], v[140:143], v[124:127]
  v_mfma_f32_16x16x32_bf16 v[16:19], v[188:191], v[144:147], v[16:19]
  s_waitcnt lgkmcnt(0)
  s_barrier
  v_mfma_f32_16x16x32_bf16 v[20:23], v[188:191], v[148:151], v[20:23]
  ds_read_b128 v[128:131], v218 offset:0
  v_mfma_f32_16x16x32_bf16 v[24:27], v[188:191], v[152:155], v[24:27]
  ds_read_b64_tr_b16 v[160:161], v223 offset:0
  v_mfma_f32_16x16x32_bf16 v[28:31], v[188:191], v[156:159], v[28:31]
  ds_read_b64_tr_b16 v[162:163], v223 offset:3840
  v_mfma_f32_16x16x32_bf16 v[32:35], v[192:195], v[144:147], v[32:35]
  ds_read_b128 v[132:135], v218 offset:2048
  v_mfma_f32_16x16x32_bf16 v[36:39], v[192:195], v[148:151], v[36:39]
  ds_read_b128 v[136:139], v218 offset:4096
  v_mfma_f32_16x16x32_bf16 v[40:43], v[192:195], v[152:155], v[40:43]
  ds_read_b128 v[140:143], v218 offset:6144
  v_mfma_f32_16x16x32_bf16 v[44:47], v[192:195], v[156:159], v[44:47]
  ds_read_b64_tr_b16 v[164:165], v223 offset:32
  v_mfma_f32_16x16x32_bf16 v[48:51], v[196:199], v[144:147], v[48:51]
  ds_read_b64_tr_b16 v[166:167], v223 offset:3872
  v_mfma_f32_16x16x32_bf16 v[52:55], v[196:199], v[148:151], v[52:55]
  ds_read_b64_tr_b16 v[168:169], v223 offset:64
  v_mfma_f32_16x16x32_bf16 v[56:59], v[196:199], v[152:155], v[56:59]
  ds_read_b64_tr_b16 v[170:171], v223 offset:3904
  v_mfma_f32_16x16x32_bf16 v[60:63], v[196:199], v[156:159], v[60:63]
  ds_read_b64_tr_b16 v[172:173], v223 offset:96
  v_mfma_f32_16x16x32_bf16 v[64:67], v[200:203], v[144:147], v[64:67]
  ds_read_b64_tr_b16 v[174:175], v223 offset:3936
  v_mfma_f32_16x16x32_bf16 v[68:71], v[200:203], v[148:151], v[68:71]
  ds_read_b64_tr_b16 v[176:177], v223 offset:128
  v_mfma_f32_16x16x32_bf16 v[72:75], v[200:203], v[152:155], v[72:75]
  ds_read_b64_tr_b16 v[178:179], v223 offset:3968
  v_mfma_f32_16x16x32_bf16 v[76:79], v[200:203], v[156:159], v[76:79]
  ds_read_b64_tr_b16 v[180:181], v223 offset:160
  v_mfma_f32_16x16x32_bf16 v[80:83], v[204:207], v[144:147], v[80:83]
  ds_read_b64_tr_b16 v[182:183], v223 offset:4000
  v_mfma_f32_16x16x32_bf16 v[84:87], v[204:207], v[148:151], v[84:87]
  ds_read_b64_tr_b16 v[184:185], v223 offset:192
  v_mfma_f32_16x16x32_bf16 v[88:91], v[204:207], v[152:155], v[88:91]
  ds_read_b64_tr_b16 v[186:187], v223 offset:4032
  v_mfma_f32_16x16x32_bf16 v[92:95], v[204:207], v[156:159], v[92:95]
  v_mfma_f32_16x16x32_bf16 v[96:99], v[208:211], v[144:147], v[96:99]
  v_mfma_f32_16x16x32_bf16 v[100:103], v[208:211], v[148:151], v[100:103]
  v_mfma_f32_16x16x32_bf16 v[104:107], v[208:211], v[152:155], v[104:107]
  v_mfma_f32_16x16x32_bf16 v[108:111], v[208:211], v[156:159], v[108:111]
  v_mfma_f32_16x16x32_bf16 v[112:115], v[212:215], v[144:147], v[112:115]
  v_mfma_f32_16x16x32_bf16 v[116:119], v[212:215], v[148:151], v[116:119]
  v_mfma_f32_16x16x32_bf16 v[120:123], v[212:215], v[152:155], v[120:123]
  v_mfma_f32_16x16x32_bf16 v[124:127], v[212:215], v[156:159], v[124:127]
  v_mfma_f32_16x16x32_bf16 v[16:19], v[160:163], v[128:131], v[16:19]
  s_waitcnt lgkmcnt(14)
  v_mfma_f32_16x16x32_bf16 v[20:23], v[160:163], v[132:135], v[20:23]
  ds_read_b128 v[144:147], v219 offset:0
  s_waitcnt lgkmcnt(14)
  v_mfma_f32_16x16x32_bf16 v[24:27], v[160:163], v[136:139], v[24:27]
  ds_read_b64_tr_b16 v[188:189], v223 offset:15360
  s_waitcnt lgkmcnt(14)
  v_mfma_f32_16x16x32_bf16 v[28:31], v[160:163], v[140:143], v[28:31]
  ds_read_b64_tr_b16 v[190:191], v223 offset:19200
  s_waitcnt lgkmcnt(13)
  v_mfma_f32_16x16x32_bf16 v[32:35], v[164:167], v[128:131], v[32:35]
  ds_read_b128 v[148:151], v219 offset:2048
  v_mfma_f32_16x16x32_bf16 v[36:39], v[164:167], v[132:135], v[36:39]
  ds_read_b128 v[152:155], v219 offset:4096
  v_mfma_f32_16x16x32_bf16 v[40:43], v[164:167], v[136:139], v[40:43]
  ds_read_b128 v[156:159], v219 offset:6144
  v_mfma_f32_16x16x32_bf16 v[44:47], v[164:167], v[140:143], v[44:47]
  ds_read_b64_tr_b16 v[192:193], v223 offset:15392
  v_mfma_f32_16x16x32_bf16 v[48:51], v[168:171], v[128:131], v[48:51]
  ds_read_b64_tr_b16 v[194:195], v223 offset:19232
  v_mfma_f32_16x16x32_bf16 v[52:55], v[168:171], v[132:135], v[52:55]
  ds_read_b64_tr_b16 v[196:197], v223 offset:15424
  v_mfma_f32_16x16x32_bf16 v[56:59], v[168:171], v[136:139], v[56:59]
  ds_read_b64_tr_b16 v[198:199], v223 offset:19264
  v_mfma_f32_16x16x32_bf16 v[60:63], v[168:171], v[140:143], v[60:63]
  ds_read_b64_tr_b16 v[200:201], v223 offset:15456
  v_mfma_f32_16x16x32_bf16 v[64:67], v[172:175], v[128:131], v[64:67]
  ds_read_b64_tr_b16 v[202:203], v223 offset:19296
  v_mfma_f32_16x16x32_bf16 v[68:71], v[172:175], v[132:135], v[68:71]
  ds_read_b64_tr_b16 v[204:205], v223 offset:15488
  v_mfma_f32_16x16x32_bf16 v[72:75], v[172:175], v[136:139], v[72:75]
  ds_read_b64_tr_b16 v[206:207], v223 offset:19328
  v_mfma_f32_16x16x32_bf16 v[76:79], v[172:175], v[140:143], v[76:79]
  ds_read_b64_tr_b16 v[208:209], v223 offset:15520
  v_mfma_f32_16x16x32_bf16 v[80:83], v[176:179], v[128:131], v[80:83]
  ds_read_b64_tr_b16 v[210:211], v223 offset:19360
  v_mfma_f32_16x16x32_bf16 v[84:87], v[176:179], v[132:135], v[84:87]
  ds_read_b64_tr_b16 v[212:213], v223 offset:15552
  v_mfma_f32_16x16x32_bf16 v[88:91], v[176:179], v[136:139], v[88:91]
  ds_read_b64_tr_b16 v[214:215], v223 offset:19392
  v_mfma_f32_16x16x32_bf16 v[92:95], v[176:179], v[140:143], v[92:95]
  v_mfma_f32_16x16x32_bf16 v[96:99], v[180:183], v[128:131], v[96:99]
  v_mfma_f32_16x16x32_bf16 v[100:103], v[180:183], v[132:135], v[100:103]
  v_mfma_f32_16x16x32_bf16 v[104:107], v[180:183], v[136:139], v[104:107]
  v_mfma_f32_16x16x32_bf16 v[108:111], v[180:183], v[140:143], v[108:111]
  v_mfma_f32_16x16x32_bf16 v[112:115], v[184:187], v[128:131], v[112:115]
  v_mfma_f32_16x16x32_bf16 v[116:119], v[184:187], v[132:135], v[116:119]
  v_mfma_f32_16x16x32_bf16 v[120:123], v[184:187], v[136:139], v[120:123]
  v_mfma_f32_16x16x32_bf16 v[124:127], v[184:187], v[140:143], v[124:127]
  v_mfma_f32_16x16x32_bf16 v[16:19], v[188:191], v[144:147], v[16:19]
  s_waitcnt lgkmcnt(0)
  s_barrier
  v_mfma_f32_16x16x32_bf16 v[20:23], v[188:191], v[148:151], v[20:23]
  ds_read_b128 v[128:131], v220 offset:0
  v_mfma_f32_16x16x32_bf16 v[24:27], v[188:191], v[152:155], v[24:27]
  ds_read_b64_tr_b16 v[160:161], v224 offset:0
  v_mfma_f32_16x16x32_bf16 v[28:31], v[188:191], v[156:159], v[28:31]
  ds_read_b64_tr_b16 v[162:163], v224 offset:3840
  v_mfma_f32_16x16x32_bf16 v[32:35], v[192:195], v[144:147], v[32:35]
  ds_read_b128 v[132:135], v220 offset:2048
  v_mfma_f32_16x16x32_bf16 v[36:39], v[192:195], v[148:151], v[36:39]
  ds_read_b128 v[136:139], v220 offset:4096
  v_mfma_f32_16x16x32_bf16 v[40:43], v[192:195], v[152:155], v[40:43]
  ds_read_b128 v[140:143], v220 offset:6144
  v_mfma_f32_16x16x32_bf16 v[44:47], v[192:195], v[156:159], v[44:47]
  ds_read_b64_tr_b16 v[164:165], v224 offset:32
  v_mfma_f32_16x16x32_bf16 v[48:51], v[196:199], v[144:147], v[48:51]
  ds_read_b64_tr_b16 v[166:167], v224 offset:3872
  v_mfma_f32_16x16x32_bf16 v[52:55], v[196:199], v[148:151], v[52:55]
  ds_read_b64_tr_b16 v[168:169], v224 offset:64
  v_mfma_f32_16x16x32_bf16 v[56:59], v[196:199], v[152:155], v[56:59]
  ds_read_b64_tr_b16 v[170:171], v224 offset:3904
  v_mfma_f32_16x16x32_bf16 v[60:63], v[196:199], v[156:159], v[60:63]
  ds_read_b64_tr_b16 v[172:173], v224 offset:96
  v_mfma_f32_16x16x32_bf16 v[64:67], v[200:203], v[144:147], v[64:67]
  ds_read_b64_tr_b16 v[174:175], v224 offset:3936
  v_mfma_f32_16x16x32_bf16 v[68:71], v[200:203], v[148:151], v[68:71]
  ds_read_b64_tr_b16 v[176:177], v224 offset:128
  v_mfma_f32_16x16x32_bf16 v[72:75], v[200:203], v[152:155], v[72:75]
  ds_read_b64_tr_b16 v[178:179], v224 offset:3968
  v_mfma_f32_16x16x32_bf16 v[76:79], v[200:203], v[156:159], v[76:79]
  ds_read_b64_tr_b16 v[180:181], v224 offset:160
  v_mfma_f32_16x16x32_bf16 v[80:83], v[204:207], v[144:147], v[80:83]
  ds_read_b64_tr_b16 v[182:183], v224 offset:4000
  v_mfma_f32_16x16x32_bf16 v[84:87], v[204:207], v[148:151], v[84:87]
  ds_read_b64_tr_b16 v[184:185], v224 offset:192
  v_mfma_f32_16x16x32_bf16 v[88:91], v[204:207], v[152:155], v[88:91]
  ds_read_b64_tr_b16 v[186:187], v224 offset:4032
  v_mfma_f32_16x16x32_bf16 v[92:95], v[204:207], v[156:159], v[92:95]
  v_mfma_f32_16x16x32_bf16 v[96:99], v[208:211], v[144:147], v[96:99]
  v_mfma_f32_16x16x32_bf16 v[100:103], v[208:211], v[148:151], v[100:103]
  v_mfma_f32_16x16x32_bf16 v[104:107], v[208:211], v[152:155], v[104:107]
  v_mfma_f32_16x16x32_bf16 v[108:111], v[208:211], v[156:159], v[108:111]
  v_mfma_f32_16x16x32_bf16 v[112:115], v[212:215], v[144:147], v[112:115]
  v_mfma_f32_16x16x32_bf16 v[116:119], v[212:215], v[148:151], v[116:119]
  v_mfma_f32_16x16x32_bf16 v[120:123], v[212:215], v[152:155], v[120:123]
  v_mfma_f32_16x16x32_bf16 v[124:127], v[212:215], v[156:159], v[124:127]
  v_mfma_f32_16x16x32_bf16 v[16:19], v[160:163], v[128:131], v[16:19]
  s_waitcnt lgkmcnt(14)
  v_mfma_f32_16x16x32_bf16 v[20:23], v[160:163], v[132:135], v[20:23]
  ds_read_b128 v[144:147], v221 offset:0
  s_waitcnt lgkmcnt(14)
  v_mfma_f32_16x16x32_bf16 v[24:27], v[160:163], v[136:139], v[24:27]
  ds_read_b64_tr_b16 v[188:189], v224 offset:15360
  s_waitcnt lgkmcnt(14)
  v_mfma_f32_16x16x32_bf16 v[28:31], v[160:163], v[140:143], v[28:31]
  ds_read_b64_tr_b16 v[190:191], v224 offset:19200
  s_waitcnt lgkmcnt(13)
  v_mfma_f32_16x16x32_bf16 v[32:35], v[164:167], v[128:131], v[32:35]
  ds_read_b128 v[148:151], v221 offset:2048
  v_mfma_f32_16x16x32_bf16 v[36:39], v[164:167], v[132:135], v[36:39]
  ds_read_b128 v[152:155], v221 offset:4096
  v_mfma_f32_16x16x32_bf16 v[40:43], v[164:167], v[136:139], v[40:43]
  ds_read_b128 v[156:159], v221 offset:6144
  v_mfma_f32_16x16x32_bf16 v[44:47], v[164:167], v[140:143], v[44:47]
  ds_read_b64_tr_b16 v[192:193], v224 offset:15392
  v_mfma_f32_16x16x32_bf16 v[48:51], v[168:171], v[128:131], v[48:51]
  ds_read_b64_tr_b16 v[194:195], v224 offset:19232
  v_mfma_f32_16x16x32_bf16 v[52:55], v[168:171], v[132:135], v[52:55]
  ds_read_b64_tr_b16 v[196:197], v224 offset:15424
  v_mfma_f32_16x16x32_bf16 v[56:59], v[168:171], v[136:139], v[56:59]
  ds_read_b64_tr_b16 v[198:199], v224 offset:19264
  v_mfma_f32_16x16x32_bf16 v[60:63], v[168:171], v[140:143], v[60:63]
  ds_read_b64_tr_b16 v[200:201], v224 offset:15456
  v_mfma_f32_16x16x32_bf16 v[64:67], v[172:175], v[128:131], v[64:67]
  ds_read_b64_tr_b16 v[202:203], v224 offset:19296
  v_mfma_f32_16x16x32_bf16 v[68:71], v[172:175], v[132:135], v[68:71]
  ds_read_b64_tr_b16 v[204:205], v224 offset:15488
  v_mfma_f32_16x16x32_bf16 v[72:75], v[172:175], v[136:139], v[72:75]
  ds_read_b64_tr_b16 v[206:207], v224 offset:19328
  v_mfma_f32_16x16x32_bf16 v[76:79], v[172:175], v[140:143], v[76:79]
  ds_read_b64_tr_b16 v[208:209], v224 offset:15520
  v_mfma_f32_16x16x32_bf16 v[80:83], v[176:179], v[128:131], v[80:83]
  ds_read_b64_tr_b16 v[210:211], v224 offset:19360
  v_mfma_f32_16x16x32_bf16 v[84:87], v[176:179], v[132:135], v[84:87]
  ds_read_b64_tr_b16 v[212:213], v224 offset:15552
  v_mfma_f32_16x16x32_bf16 v[88:91], v[176:179], v[136:139], v[88:91]
  ds_read_b64_tr_b16 v[214:215], v224 offset:19392
  v_mfma_f32_16x16x32_bf16 v[92:95], v[176:179], v[140:143], v[92:95]
  v_mfma_f32_16x16x32_bf16 v[96:99], v[180:183], v[128:131], v[96:99]
  v_mfma_f32_16x16x32_bf16 v[100:103], v[180:183], v[132:135], v[100:103]
  v_mfma_f32_16x16x32_bf16 v[104:107], v[180:183], v[136:139], v[104:107]
  v_mfma_f32_16x16x32_bf16 v[108:111], v[180:183], v[140:143], v[108:111]
  v_mfma_f32_16x16x32_bf16 v[112:115], v[184:187], v[128:131], v[112:115]
  v_mfma_f32_16x16x32_bf16 v[116:119], v[184:187], v[132:135], v[116:119]
  v_mfma_f32_16x16x32_bf16 v[120:123], v[184:187], v[136:139], v[120:123]
  v_mfma_f32_16x16x32_bf16 v[124:127], v[184:187], v[140:143], v[124:127]
  v_mfma_f32_16x16x32_bf16 v[16:19], v[188:191], v[144:147], v[16:19]
  s_waitcnt lgkmcnt(14)
  v_mfma_f32_16x16x32_bf16 v[20:23], v[188:191], v[148:151], v[20:23]
  s_waitcnt lgkmcnt(13)
  v_mfma_f32_16x16x32_bf16 v[24:27], v[188:191], v[152:155], v[24:27]
  s_waitcnt lgkmcnt(12)
  v_mfma_f32_16x16x32_bf16 v[28:31], v[188:191], v[156:159], v[28:31]
  s_waitcnt lgkmcnt(10)
  v_mfma_f32_16x16x32_bf16 v[32:35], v[192:195], v[144:147], v[32:35]
  v_mfma_f32_16x16x32_bf16 v[36:39], v[192:195], v[148:151], v[36:39]
  v_mfma_f32_16x16x32_bf16 v[40:43], v[192:195], v[152:155], v[40:43]
  v_mfma_f32_16x16x32_bf16 v[44:47], v[192:195], v[156:159], v[44:47]
  s_waitcnt lgkmcnt(8)
  v_mfma_f32_16x16x32_bf16 v[48:51], v[196:199], v[144:147], v[48:51]
  v_mfma_f32_16x16x32_bf16 v[52:55], v[196:199], v[148:151], v[52:55]
  v_mfma_f32_16x16x32_bf16 v[56:59], v[196:199], v[152:155], v[56:59]
  v_mfma_f32_16x16x32_bf16 v[60:63], v[196:199], v[156:159], v[60:63]
  s_waitcnt lgkmcnt(6)
  v_mfma_f32_16x16x32_bf16 v[64:67], v[200:203], v[144:147], v[64:67]
  v_mfma_f32_16x16x32_bf16 v[68:71], v[200:203], v[148:151], v[68:71]
  v_mfma_f32_16x16x32_bf16 v[72:75], v[200:203], v[152:155], v[72:75]
  v_mfma_f32_16x16x32_bf16 v[76:79], v[200:203], v[156:159], v[76:79]
  s_waitcnt lgkmcnt(4)
  v_mfma_f32_16x16x32_bf16 v[80:83], v[204:207], v[144:147], v[80:83]
  v_mfma_f32_16x16x32_bf16 v[84:87], v[204:207], v[148:151], v[84:87]
  v_mfma_f32_16x16x32_bf16 v[88:91], v[204:207], v[152:155], v[88:91]
  v_mfma_f32_16x16x32_bf16 v[92:95], v[204:207], v[156:159], v[92:95]
  s_waitcnt lgkmcnt(2)
  v_mfma_f32_16x16x32_bf16 v[96:99], v[208:211], v[144:147], v[96:99]
  v_mfma_f32_16x16x32_bf16 v[100:103], v[208:211], v[148:151], v[100:103]
  v_mfma_f32_16x16x32_bf16 v[104:107], v[208:211], v[152:155], v[104:107]
  v_mfma_f32_16x16x32_bf16 v[108:111], v[208:211], v[156:159], v[108:111]
  s_waitcnt lgkmcnt(0)
  v_mfma_f32_16x16x32_bf16 v[112:115], v[212:215], v[144:147], v[112:115]
  v_mfma_f32_16x16x32_bf16 v[116:119], v[212:215], v[148:151], v[116:119]
  v_mfma_f32_16x16x32_bf16 v[120:123], v[212:215], v[152:155], v[120:123]
  v_mfma_f32_16x16x32_bf16 v[124:127], v[212:215], v[156:159], v[124:127]
  v_cvt_pk_bf16_f32 v16, v16, v17
  v_cvt_pk_bf16_f32 v17, v18, v19
  ds_write_b64 v225, v[16:17] offset:0
  v_cvt_pk_bf16_f32 v32, v32, v33
  v_cvt_pk_bf16_f32 v33, v34, v35
  ds_write_b64 v225, v[32:33] offset:32
  v_cvt_pk_bf16_f32 v48, v48, v49
  v_cvt_pk_bf16_f32 v49, v50, v51
  ds_write_b64 v225, v[48:49] offset:64
  v_cvt_pk_bf16_f32 v64, v64, v65
  v_cvt_pk_bf16_f32 v65, v66, v67
  ds_write_b64 v225, v[64:65] offset:96
  v_cvt_pk_bf16_f32 v80, v80, v81
  v_cvt_pk_bf16_f32 v81, v82, v83
  ds_write_b64 v225, v[80:81] offset:128
  v_cvt_pk_bf16_f32 v96, v96, v97
  v_cvt_pk_bf16_f32 v97, v98, v99
  ds_write_b64 v225, v[96:97] offset:160
  v_cvt_pk_bf16_f32 v112, v112, v113
  v_cvt_pk_bf16_f32 v113, v114, v115
  ds_write_b64 v225, v[112:113] offset:192
  v_cvt_pk_bf16_f32 v20, v20, v21
  v_cvt_pk_bf16_f32 v21, v22, v23
  ds_write_b64 v225, v[20:21] offset:7424
  v_cvt_pk_bf16_f32 v36, v36, v37
  v_cvt_pk_bf16_f32 v37, v38, v39
  ds_write_b64 v225, v[36:37] offset:7456
  v_cvt_pk_bf16_f32 v52, v52, v53
  v_cvt_pk_bf16_f32 v53, v54, v55
  ds_write_b64 v225, v[52:53] offset:7488
  v_cvt_pk_bf16_f32 v68, v68, v69
  v_cvt_pk_bf16_f32 v69, v70, v71
  ds_write_b64 v225, v[68:69] offset:7520
  v_cvt_pk_bf16_f32 v84, v84, v85
  v_cvt_pk_bf16_f32 v85, v86, v87
  ds_write_b64 v225, v[84:85] offset:7552
  v_cvt_pk_bf16_f32 v100, v100, v101
  v_cvt_pk_bf16_f32 v101, v102, v103
  ds_write_b64 v225, v[100:101] offset:7584
  v_cvt_pk_bf16_f32 v116, v116, v117
  v_cvt_pk_bf16_f32 v117, v118, v119
  ds_write_b64 v225, v[116:117] offset:7616
  v_cvt_pk_bf16_f32 v24, v24, v25
  v_cvt_pk_bf16_f32 v25, v26, v27
  ds_write_b64 v225, v[24:25] offset:14848
  v_cvt_pk_bf16_f32 v40, v40, v41
  v_cvt_pk_bf16_f32 v41, v42, v43
  ds_write_b64 v225, v[40:41] offset:14880
  v_cvt_pk_bf16_f32 v56, v56, v57
  v_cvt_pk_bf16_f32 v57, v58, v59
  ds_write_b64 v225, v[56:57] offset:14912
  v_cvt_pk_bf16_f32 v72, v72, v73
  v_cvt_pk_bf16_f32 v73, v74, v75
  ds_write_b64 v225, v[72:73] offset:14944
  v_cvt_pk_bf16_f32 v88, v88, v89
  v_cvt_pk_bf16_f32 v89, v90, v91
  ds_write_b64 v225, v[88:89] offset:14976
  v_cvt_pk_bf16_f32 v104, v104, v105
  v_cvt_pk_bf16_f32 v105, v106, v107
  ds_write_b64 v225, v[104:105] offset:15008
  v_cvt_pk_bf16_f32 v120, v120, v121
  v_cvt_pk_bf16_f32 v121, v122, v123
  ds_write_b64 v225, v[120:121] offset:15040
  v_cvt_pk_bf16_f32 v28, v28, v29
  v_cvt_pk_bf16_f32 v29, v30, v31
  ds_write_b64 v225, v[28:29] offset:22272
  v_cvt_pk_bf16_f32 v44, v44, v45
  v_cvt_pk_bf16_f32 v45, v46, v47
  ds_write_b64 v225, v[44:45] offset:22304
  v_cvt_pk_bf16_f32 v60, v60, v61
  v_cvt_pk_bf16_f32 v61, v62, v63
  ds_write_b64 v225, v[60:61] offset:22336
  v_cvt_pk_bf16_f32 v76, v76, v77
  v_cvt_pk_bf16_f32 v77, v78, v79
  ds_write_b64 v225, v[76:77] offset:22368
  v_cvt_pk_bf16_f32 v92, v92, v93
  v_cvt_pk_bf16_f32 v93, v94, v95
  ds_write_b64 v225, v[92:93] offset:22400
  v_cvt_pk_bf16_f32 v108, v108, v109
  v_cvt_pk_bf16_f32 v109, v110, v111
  ds_write_b64 v225, v[108:109] offset:22432
  v_cvt_pk_bf16_f32 v124, v124, v125
  v_cvt_pk_bf16_f32 v125, v126, v127
  ds_write_b64 v225, v[124:125] offset:22464
  s_waitcnt vmcnt(0) lgkmcnt(0)
  s_branch K1_POST
K1_NONCOMPUTE:
  s_cmp_eq_u32 s48, 7
  s_cbranch_scc1 K1_AUX
  s_cmp_eq_u32 s48, 4
  s_cbranch_scc0 K1_WLOAD
  v_lshrrev_b32 v3, 3, v1
  v_and_b32 v4, 7, v1
  v_and_b32 v5, 7, v3
  v_xor_b32 v4, v4, v5
  v_lshlrev_b32 v4, 4, v4
  v_mul_u32_u24 v3, 1152, v3
  v_add_u32 v3, v3, v4
  s_mul_i32 s51, s44, 147456
  s_add_u32 s52, s51, 0
  s_mov_b32 m0, 0
  s_nop 0
  buffer_load_dwordx4 v3, s[8:11], s52 offen lds
  s_add_u32 s52, s51, 9216
  s_mov_b32 m0, 1024
  s_nop 0
  buffer_load_dwordx4 v3, s[8:11], s52 offen lds
  s_add_u32 s52, s51, 18432
  s_mov_b32 m0, 2048
  s_nop 0
  buffer_load_dwordx4 v3, s[8:11], s52 offen lds
  s_add_u32 s52, s51, 27648
  s_mov_b32 m0, 3072
  s_nop 0
  buffer_load_dwordx4 v3, s[8:11], s52 offen lds
  s_add_u32 s52, s51, 36864
  s_mov_b32 m0, 4096
  s_nop 0
  buffer_load_dwordx4 v3, s[8:11], s52 offen lds
  s_add_u32 s52, s51, 46080
  s_mov_b32 m0, 5120
  s_nop 0
  buffer_load_dwordx4 v3, s[8:11], s52 offen lds
  s_add_u32 s52, s51, 55296
  s_mov_b32 m0, 6144
  s_nop 0
  buffer_load_dwordx4 v3, s[8:11], s52 offen lds
  s_add_u32 s52, s51, 64512
  s_mov_b32 m0, 7168
  s_nop 0
  buffer_load_dwordx4 v3, s[8:11], s52 offen lds
  s_add_u32 s52, s51, 73728
  s_mov_b32 m0, 8192
  s_nop 0
  buffer_load_dwordx4 v3, s[8:11], s52 offen lds
  s_add_u32 s52, s51, 82944
  s_mov_b32 m0, 9216
  s_nop 0
  buffer_load_dwordx4 v3, s[8:11], s52 offen lds
  s_add_u32 s52, s51, 92160
  s_mov_b32 m0, 10240
  s_nop 0
  buffer_load_dwordx4 v3, s[8:11], s52 offen lds
  s_add_u32 s52, s51, 101376
  s_mov_b32 m0, 11264
  s_nop 0
  buffer_load_dwordx4 v3, s[8:11], s52 offen lds
  s_add_u32 s52, s51, 110592
  s_mov_b32 m0, 12288
  s_nop 0
  buffer_load_dwordx4 v3, s[8:11], s52 offen lds
  s_add_u32 s52, s51, 119808
  s_mov_b32 m0, 13312
  s_nop 0
  buffer_load_dwordx4 v3, s[8:11], s52 offen lds
  s_add_u32 s52, s51, 129024
  s_mov_b32 m0, 14336
  s_nop 0
  buffer_load_dwordx4 v3, s[8:11], s52 offen lds
  s_add_u32 s52, s51, 138240
  s_mov_b32 m0, 15360
  s_nop 0
  buffer_load_dwordx4 v3, s[8:11], s52 offen lds
  s_add_u32 s52, s51, 128
  s_mov_b32 m0, 47104
  s_nop 0
  buffer_load_dwordx4 v3, s[8:11], s52 offen lds
  s_add_u32 s52, s51, 9344
  s_mov_b32 m0, 48128
  s_nop 0
  buffer_load_dwordx4 v3, s[8:11], s52 offen lds
  s_add_u32 s52, s51, 18560
  s_mov_b32 m0, 49152
  s_nop 0
  buffer_load_dwordx4 v3, s[8:11], s52 offen lds
  s_add_u32 s52, s51, 27776
  s_mov_b32 m0, 50176
  s_nop 0
  buffer_load_dwordx4 v3, s[8:11], s52 offen lds
  s_add_u32 s52, s51, 36992
  s_mov_b32 m0, 51200
  s_nop 0
  buffer_load_dwordx4 v3, s[8:11], s52 offen lds
  s_add_u32 s52, s51, 46208
  s_mov_b32 m0, 52224
  s_nop 0
  buffer_load_dwordx4 v3, s[8:11], s52 offen lds
  s_add_u32 s52, s51, 55424
  s_mov_b32 m0, 53248
  s_nop 0
  buffer_load_dwordx4 v3, s[8:11], s52 offen lds
  s_add_u32 s52, s51, 64640
  s_mov_b32 m0, 54272
  s_nop 0
  buffer_load_dwordx4 v3, s[8:11], s52 offen lds
  s_add_u32 s52, s51, 73856
  s_mov_b32 m0, 55296
  s_nop 0
  buffer_load_dwordx4 v3, s[8:11], s52 offen lds
  s_add_u32 s52, s51, 83072
  s_mov_b32 m0, 56320
  s_nop 0
  buffer_load_dwordx4 v3, s[8:11], s52 offen lds
  s_add_u32 s52, s51, 92288
  s_mov_b32 m0, 57344
  s_nop 0
  buffer_load_dwordx4 v3, s[8:11], s52 offen lds
  s_add_u32 s52, s51, 101504
  s_mov_b32 m0, 58368
  s_nop 0
  buffer_load_dwordx4 v3, s[8:11], s52 offen lds
  s_add_u32 s52, s51, 110720
  s_mov_b32 m0, 59392
  s_nop 0
  buffer_load_dwordx4 v3, s[8:11], s52 offen lds
  s_add_u32 s52, s51, 119936
  s_mov_b32 m0, 60416
  s_nop 0
  buffer_load_dwordx4 v3, s[8:11], s52 offen lds
  s_add_u32 s52, s51, 129152
  s_mov_b32 m0, 61440
  s_nop 0
  buffer_load_dwordx4 v3, s[8:11], s52 offen lds
  s_add_u32 s52, s51, 138368
  s_mov_b32 m0, 62464
  s_nop 0
  buffer_load_dwordx4 v3, s[8:11], s52 offen lds
  s_waitcnt vmcnt(16)
  s_barrier
  s_add_u32 s52, s51, 256
  s_mov_b32 m0, 94208
  s_nop 0
  buffer_load_dwordx4 v3, s[8:11], s52 offen lds
  s_add_u32 s52, s51, 9472
  s_mov_b32 m0, 95232
  s_nop 0
  buffer_load_dwordx4 v3, s[8:11], s52 offen lds
  s_add_u32 s52, s51, 18688
  s_mov_b32 m0, 96256
  s_nop 0
  buffer_load_dwordx4 v3, s[8:11], s52 offen lds
  s_add_u32 s52, s51, 27904
  s_mov_b32 m0, 97280
  s_nop 0
  buffer_load_dwordx4 v3, s[8:11], s52 offen lds
  s_add_u32 s52, s51, 37120
  s_mov_b32 m0, 98304
  s_nop 0
  buffer_load_dwordx4 v3, s[8:11], s52 offen lds
  s_add_u32 s52, s51, 46336
  s_mov_b32 m0, 99328
  s_nop 0
  buffer_load_dwordx4 v3, s[8:11], s52 offen lds
  s_add_u32 s52, s51, 55552
  s_mov_b32 m0, 100352
  s_nop 0
  buffer_load_dwordx4 v3, s[8:11], s52 offen lds
  s_add_u32 s52, s51, 64768
  s_mov_b32 m0, 101376
  s_nop 0
  buffer_load_dwordx4 v3, s[8:11], s52 offen lds
  s_add_u32 s52, s51, 73984
  s_mov_b32 m0, 102400
  s_nop 0
  buffer_load_dwordx4 v3, s[8:11], s52 offen lds
  s_add_u32 s52, s51, 83200
  s_mov_b32 m0, 103424
  s_nop 0
  buffer_load_dwordx4 v3, s[8:11], s52 offen lds
  s_add_u32 s52, s51, 92416
  s_mov_b32 m0, 104448
  s_nop 0
  buffer_load_dwordx4 v3, s[8:11], s52 offen lds
  s_add_u32 s52, s51, 101632
  s_mov_b32 m0, 105472
  s_nop 0
  buffer_load_dwordx4 v3, s[8:11], s52 offen lds
  s_add_u32 s52, s51, 110848
  s_mov_b32 m0, 106496
  s_nop 0
  buffer_load_dwordx4 v3, s[8:11], s52 offen lds
  s_add_u32 s52, s51, 120064
  s_mov_b32 m0, 107520
  s_nop 0
  buffer_load_dwordx4 v3, s[8:11], s52 offen lds
  s_add_u32 s52, s51, 129280
  s_mov_b32 m0, 108544
  s_nop 0
  buffer_load_dwordx4 v3, s[8:11], s52 offen lds
  s_add_u32 s52, s51, 138496
  s_mov_b32 m0, 109568
  s_nop 0
  buffer_load_dwordx4 v3, s[8:11], s52 offen lds
  s_waitcnt vmcnt(16)
  s_barrier
  s_add_u32 s52, s51, 384
  s_mov_b32 m0, 0
  s_nop 0
  buffer_load_dwordx4 v3, s[8:11], s52 offen lds
  s_add_u32 s52, s51, 9600
  s_mov_b32 m0, 1024
  s_nop 0
  buffer_load_dwordx4 v3, s[8:11], s52 offen lds
  s_add_u32 s52, s51, 18816
  s_mov_b32 m0, 2048
  s_nop 0
  buffer_load_dwordx4 v3, s[8:11], s52 offen lds
  s_add_u32 s52, s51, 28032
  s_mov_b32 m0, 3072
  s_nop 0
  buffer_load_dwordx4 v3, s[8:11], s52 offen lds
  s_add_u32 s52, s51, 37248
  s_mov_b32 m0, 4096
  s_nop 0
  buffer_load_dwordx4 v3, s[8:11], s52 offen lds
  s_add_u32 s52, s51, 46464
  s_mov_b32 m0, 5120
  s_nop 0
  buffer_load_dwordx4 v3, s[8:11], s52 offen lds
  s_add_u32 s52, s51, 55680
  s_mov_b32 m0, 6144
  s_nop 0
  buffer_load_dwordx4 v3, s[8:11], s52 offen lds
  s_add_u32 s52, s51, 64896
  s_mov_b32 m0, 7168
  s_nop 0
  buffer_load_dwordx4 v3, s[8:11], s52 offen lds
  s_add_u32 s52, s51, 74112
  s_mov_b32 m0, 8192
  s_nop 0
  buffer_load_dwordx4 v3, s[8:11], s52 offen lds
  s_add_u32 s52, s51, 83328
  s_mov_b32 m0, 9216
  s_nop 0
  buffer_load_dwordx4 v3, s[8:11], s52 offen lds
  s_add_u32 s52, s51, 92544
  s_mov_b32 m0, 10240
  s_nop 0
  buffer_load_dwordx4 v3, s[8:11], s52 offen lds
  s_add_u32 s52, s51, 101760
  s_mov_b32 m0, 11264
  s_nop 0
  buffer_load_dwordx4 v3, s[8:11], s52 offen lds
  s_add_u32 s52, s51, 110976
  s_mov_b32 m0, 12288
  s_nop 0
  buffer_load_dwordx4 v3, s[8:11], s52 offen lds
  s_add_u32 s52, s51, 120192
  s_mov_b32 m0, 13312
  s_nop 0
  buffer_load_dwordx4 v3, s[8:11], s52 offen lds
  s_add_u32 s52, s51, 129408
  s_mov_b32 m0, 14336
  s_nop 0
  buffer_load_dwordx4 v3, s[8:11], s52 offen lds
  s_add_u32 s52, s51, 138624
  s_mov_b32 m0, 15360
  s_nop 0
  buffer_load_dwordx4 v3, s[8:11], s52 offen lds
  s_waitcnt vmcnt(16)
  s_barrier
  s_add_u32 s52, s51, 512
  s_mov_b32 m0, 47104
  s_nop 0
  buffer_load_dwordx4 v3, s[8:11], s52 offen lds
  s_add_u32 s52, s51, 9728
  s_mov_b32 m0, 48128
  s_nop 0
  buffer_load_dwordx4 v3, s[8:11], s52 offen lds
  s_add_u32 s52, s51, 18944
  s_mov_b32 m0, 49152
  s_nop 0
  buffer_load_dwordx4 v3, s[8:11], s52 offen lds
  s_add_u32 s52, s51, 28160
  s_mov_b32 m0, 50176
  s_nop 0
  buffer_load_dwordx4 v3, s[8:11], s52 offen lds
  s_add_u32 s52, s51, 37376
  s_mov_b32 m0, 51200
  s_nop 0
  buffer_load_dwordx4 v3, s[8:11], s52 offen lds
  s_add_u32 s52, s51, 46592
  s_mov_b32 m0, 52224
  s_nop 0
  buffer_load_dwordx4 v3, s[8:11], s52 offen lds
  s_add_u32 s52, s51, 55808
  s_mov_b32 m0, 53248
  s_nop 0
  buffer_load_dwordx4 v3, s[8:11], s52 offen lds
  s_add_u32 s52, s51, 65024
  s_mov_b32 m0, 54272
  s_nop 0
  buffer_load_dwordx4 v3, s[8:11], s52 offen lds
  s_add_u32 s52, s51, 74240
  s_mov_b32 m0, 55296
  s_nop 0
  buffer_load_dwordx4 v3, s[8:11], s52 offen lds
  s_add_u32 s52, s51, 83456
  s_mov_b32 m0, 56320
  s_nop 0
  buffer_load_dwordx4 v3, s[8:11], s52 offen lds
  s_add_u32 s52, s51, 92672
  s_mov_b32 m0, 57344
  s_nop 0
  buffer_load_dwordx4 v3, s[8:11], s52 offen lds
  s_add_u32 s52, s51, 101888
  s_mov_b32 m0, 58368
  s_nop 0
  buffer_load_dwordx4 v3, s[8:11], s52 offen lds
  s_add_u32 s52, s51, 111104
  s_mov_b32 m0, 59392
  s_nop 0
  buffer_load_dwordx4 v3, s[8:11], s52 offen lds
  s_add_u32 s52, s51, 120320
  s_mov_b32 m0, 60416
  s_nop 0
  buffer_load_dwordx4 v3, s[8:11], s52 offen lds
  s_add_u32 s52, s51, 129536
  s_mov_b32 m0, 61440
  s_nop 0
  buffer_load_dwordx4 v3, s[8:11], s52 offen lds
  s_add_u32 s52, s51, 138752
  s_mov_b32 m0, 62464
  s_nop 0
  buffer_load_dwordx4 v3, s[8:11], s52 offen lds
  s_waitcnt vmcnt(16)
  s_barrier
  s_add_u32 s52, s51, 640
  s_mov_b32 m0, 94208
  s_nop 0
  buffer_load_dwordx4 v3, s[8:11], s52 offen lds
  s_add_u32 s52, s51, 9856
  s_mov_b32 m0, 95232
  s_nop 0
  buffer_load_dwordx4 v3, s[8:11], s52 offen lds
  s_add_u32 s52, s51, 19072
  s_mov_b32 m0, 96256
  s_nop 0
  buffer_load_dwordx4 v3, s[8:11], s52 offen lds
  s_add_u32 s52, s51, 28288
  s_mov_b32 m0, 97280
  s_nop 0
  buffer_load_dwordx4 v3, s[8:11], s52 offen lds
  s_add_u32 s52, s51, 37504
  s_mov_b32 m0, 98304
  s_nop 0
  buffer_load_dwordx4 v3, s[8:11], s52 offen lds
  s_add_u32 s52, s51, 46720
  s_mov_b32 m0, 99328
  s_nop 0
  buffer_load_dwordx4 v3, s[8:11], s52 offen lds
  s_add_u32 s52, s51, 55936
  s_mov_b32 m0, 100352
  s_nop 0
  buffer_load_dwordx4 v3, s[8:11], s52 offen lds
  s_add_u32 s52, s51, 65152
  s_mov_b32 m0, 101376
  s_nop 0
  buffer_load_dwordx4 v3, s[8:11], s52 offen lds
  s_add_u32 s52, s51, 74368
  s_mov_b32 m0, 102400
  s_nop 0
  buffer_load_dwordx4 v3, s[8:11], s52 offen lds
  s_add_u32 s52, s51, 83584
  s_mov_b32 m0, 103424
  s_nop 0
  buffer_load_dwordx4 v3, s[8:11], s52 offen lds
  s_add_u32 s52, s51, 92800
  s_mov_b32 m0, 104448
  s_nop 0
  buffer_load_dwordx4 v3, s[8:11], s52 offen lds
  s_add_u32 s52, s51, 102016
  s_mov_b32 m0, 105472
  s_nop 0
  buffer_load_dwordx4 v3, s[8:11], s52 offen lds
  s_add_u32 s52, s51, 111232
  s_mov_b32 m0, 106496
  s_nop 0
  buffer_load_dwordx4 v3, s[8:11], s52 offen lds
  s_add_u32 s52, s51, 120448
  s_mov_b32 m0, 107520
  s_nop 0
  buffer_load_dwordx4 v3, s[8:11], s52 offen lds
  s_add_u32 s52, s51, 129664
  s_mov_b32 m0, 108544
  s_nop 0
  buffer_load_dwordx4 v3, s[8:11], s52 offen lds
  s_add_u32 s52, s51, 138880
  s_mov_b32 m0, 109568
  s_nop 0
  buffer_load_dwordx4 v3, s[8:11], s52 offen lds
  s_waitcnt vmcnt(16)
  s_barrier
  s_add_u32 s52, s51, 768
  s_mov_b32 m0, 0
  s_nop 0
  buffer_load_dwordx4 v3, s[8:11], s52 offen lds
  s_add_u32 s52, s51, 9984
  s_mov_b32 m0, 1024
  s_nop 0
  buffer_load_dwordx4 v3, s[8:11], s52 offen lds
  s_add_u32 s52, s51, 19200
  s_mov_b32 m0, 2048
  s_nop 0
  buffer_load_dwordx4 v3, s[8:11], s52 offen lds
  s_add_u32 s52, s51, 28416
  s_mov_b32 m0, 3072
  s_nop 0
  buffer_load_dwordx4 v3, s[8:11], s52 offen lds
  s_add_u32 s52, s51, 37632
  s_mov_b32 m0, 4096
  s_nop 0
  buffer_load_dwordx4 v3, s[8:11], s52 offen lds
  s_add_u32 s52, s51, 46848
  s_mov_b32 m0, 5120
  s_nop 0
  buffer_load_dwordx4 v3, s[8:11], s52 offen lds
  s_add_u32 s52, s51, 56064
  s_mov_b32 m0, 6144
  s_nop 0
  buffer_load_dwordx4 v3, s[8:11], s52 offen lds
  s_add_u32 s52, s51, 65280
  s_mov_b32 m0, 7168
  s_nop 0
  buffer_load_dwordx4 v3, s[8:11], s52 offen lds
  s_add_u32 s52, s51, 74496
  s_mov_b32 m0, 8192
  s_nop 0
  buffer_load_dwordx4 v3, s[8:11], s52 offen lds
  s_add_u32 s52, s51, 83712
  s_mov_b32 m0, 9216
  s_nop 0
  buffer_load_dwordx4 v3, s[8:11], s52 offen lds
  s_add_u32 s52, s51, 92928
  s_mov_b32 m0, 10240
  s_nop 0
  buffer_load_dwordx4 v3, s[8:11], s52 offen lds
  s_add_u32 s52, s51, 102144
  s_mov_b32 m0, 11264
  s_nop 0
  buffer_load_dwordx4 v3, s[8:11], s52 offen lds
  s_add_u32 s52, s51, 111360
  s_mov_b32 m0, 12288
  s_nop 0
  buffer_load_dwordx4 v3, s[8:11], s52 offen lds
  s_add_u32 s52, s51, 120576
  s_mov_b32 m0, 13312
  s_nop 0
  buffer_load_dwordx4 v3, s[8:11], s52 offen lds
  s_add_u32 s52, s51, 129792
  s_mov_b32 m0, 14336
  s_nop 0
  buffer_load_dwordx4 v3, s[8:11], s52 offen lds
  s_add_u32 s52, s51, 139008
  s_mov_b32 m0, 15360
  s_nop 0
  buffer_load_dwordx4 v3, s[8:11], s52 offen lds
  s_waitcnt vmcnt(16)
  s_barrier
  s_add_u32 s52, s51, 896
  s_mov_b32 m0, 47104
  s_nop 0
  buffer_load_dwordx4 v3, s[8:11], s52 offen lds
  s_add_u32 s52, s51, 10112
  s_mov_b32 m0, 48128
  s_nop 0
  buffer_load_dwordx4 v3, s[8:11], s52 offen lds
  s_add_u32 s52, s51, 19328
  s_mov_b32 m0, 49152
  s_nop 0
  buffer_load_dwordx4 v3, s[8:11], s52 offen lds
  s_add_u32 s52, s51, 28544
  s_mov_b32 m0, 50176
  s_nop 0
  buffer_load_dwordx4 v3, s[8:11], s52 offen lds
  s_add_u32 s52, s51, 37760
  s_mov_b32 m0, 51200
  s_nop 0
  buffer_load_dwordx4 v3, s[8:11], s52 offen lds
  s_add_u32 s52, s51, 46976
  s_mov_b32 m0, 52224
  s_nop 0
  buffer_load_dwordx4 v3, s[8:11], s52 offen lds
  s_add_u32 s52, s51, 56192
  s_mov_b32 m0, 53248
  s_nop 0
  buffer_load_dwordx4 v3, s[8:11], s52 offen lds
  s_add_u32 s52, s51, 65408
  s_mov_b32 m0, 54272
  s_nop 0
  buffer_load_dwordx4 v3, s[8:11], s52 offen lds
  s_add_u32 s52, s51, 74624
  s_mov_b32 m0, 55296
  s_nop 0
  buffer_load_dwordx4 v3, s[8:11], s52 offen lds
  s_add_u32 s52, s51, 83840
  s_mov_b32 m0, 56320
  s_nop 0
  buffer_load_dwordx4 v3, s[8:11], s52 offen lds
  s_add_u32 s52, s51, 93056
  s_mov_b32 m0, 57344
  s_nop 0
  buffer_load_dwordx4 v3, s[8:11], s52 offen lds
  s_add_u32 s52, s51, 102272
  s_mov_b32 m0, 58368
  s_nop 0
  buffer_load_dwordx4 v3, s[8:11], s52 offen lds
  s_add_u32 s52, s51, 111488
  s_mov_b32 m0, 59392
  s_nop 0
  buffer_load_dwordx4 v3, s[8:11], s52 offen lds
  s_add_u32 s52, s51, 120704
  s_mov_b32 m0, 60416
  s_nop 0
  buffer_load_dwordx4 v3, s[8:11], s52 offen lds
  s_add_u32 s52, s51, 129920
  s_mov_b32 m0, 61440
  s_nop 0
  buffer_load_dwordx4 v3, s[8:11], s52 offen lds
  s_add_u32 s52, s51, 139136
  s_mov_b32 m0, 62464
  s_nop 0
  buffer_load_dwordx4 v3, s[8:11], s52 offen lds
  s_waitcnt vmcnt(16)
  s_barrier
  s_add_u32 s52, s51, 1024
  s_mov_b32 m0, 94208
  s_nop 0
  buffer_load_dwordx4 v3, s[8:11], s52 offen lds
  s_add_u32 s52, s51, 10240
  s_mov_b32 m0, 95232
  s_nop 0
  buffer_load_dwordx4 v3, s[8:11], s52 offen lds
  s_add_u32 s52, s51, 19456
  s_mov_b32 m0, 96256
  s_nop 0
  buffer_load_dwordx4 v3, s[8:11], s52 offen lds
  s_add_u32 s52, s51, 28672
  s_mov_b32 m0, 97280
  s_nop 0
  buffer_load_dwordx4 v3, s[8:11], s52 offen lds
  s_add_u32 s52, s51, 37888
  s_mov_b32 m0, 98304
  s_nop 0
  buffer_load_dwordx4 v3, s[8:11], s52 offen lds
  s_add_u32 s52, s51, 47104
  s_mov_b32 m0, 99328
  s_nop 0
  buffer_load_dwordx4 v3, s[8:11], s52 offen lds
  s_add_u32 s52, s51, 56320
  s_mov_b32 m0, 100352
  s_nop 0
  buffer_load_dwordx4 v3, s[8:11], s52 offen lds
  s_add_u32 s52, s51, 65536
  s_mov_b32 m0, 101376
  s_nop 0
  buffer_load_dwordx4 v3, s[8:11], s52 offen lds
  s_add_u32 s52, s51, 74752
  s_mov_b32 m0, 102400
  s_nop 0
  buffer_load_dwordx4 v3, s[8:11], s52 offen lds
  s_add_u32 s52, s51, 83968
  s_mov_b32 m0, 103424
  s_nop 0
  buffer_load_dwordx4 v3, s[8:11], s52 offen lds
  s_add_u32 s52, s51, 93184
  s_mov_b32 m0, 104448
  s_nop 0
  buffer_load_dwordx4 v3, s[8:11], s52 offen lds
  s_add_u32 s52, s51, 102400
  s_mov_b32 m0, 105472
  s_nop 0
  buffer_load_dwordx4 v3, s[8:11], s52 offen lds
  s_add_u32 s52, s51, 111616
  s_mov_b32 m0, 106496
  s_nop 0
  buffer_load_dwordx4 v3, s[8:11], s52 offen lds
  s_add_u32 s52, s51, 120832
  s_mov_b32 m0, 107520
  s_nop 0
  buffer_load_dwordx4 v3, s[8:11], s52 offen lds
  s_add_u32 s52, s51, 130048
  s_mov_b32 m0, 108544
  s_nop 0
  buffer_load_dwordx4 v3, s[8:11], s52 offen lds
  s_add_u32 s52, s51, 139264
  s_mov_b32 m0, 109568
  s_nop 0
  buffer_load_dwordx4 v3, s[8:11], s52 offen lds
  s_waitcnt vmcnt(16)
  s_barrier
  s_waitcnt vmcnt(0)
  s_barrier
  s_branch K1_POST
K1_WLOAD:
  s_sub_u32 s53, s48, 5
  s_lshl_b32 s54, s53, 6
  v_add_u32 v3, 0, v1
  v_add_u32 v3, s54, v3
  v_mul_u32_u24 v4, 2185, v3
  v_lshrrev_b32 v4, 16, v4
  v_mul_u32_u24 v5, 30, v4
  v_sub_u32 v5, v3, v5
  v_mul_u32_u24 v6, 7282, v5
  v_lshrrev_b32 v6, 16, v6
  v_mul_u32_u24 v7, 9, v6
  v_sub_u32 v7, v5, v7
  v_and_b32 v8, 4, v4
  v_lshlrev_b32 v8, 1, v8
  v_and_b32 v9, 8, v4
  v_lshrrev_b32 v9, 1, v9
  v_and_b32 v10, 0xfffffff3, v4
  v_or3_b32 v10, v10, v8, v9
  v_mul_u32_u24 v10, 3456, v10
  v_mul_u32_u24 v6, 1152, v6
  v_lshl_add_u32 v7, v7, 4, v6
  v_add_u32 v10, v10, v7
  v_cmp_le_u32 vcc, 27, v5
  v_mov_b32 v11, 0x40000000
  s_nop 0
  v_cndmask_b32 v16, v10, v11, vcc
  v_add_u32 v3, 128, v1
  v_add_u32 v3, s54, v3
  v_mul_u32_u24 v4, 2185, v3
  v_lshrrev_b32 v4, 16, v4
  v_mul_u32_u24 v5, 30, v4
  v_sub_u32 v5, v3, v5
  v_mul_u32_u24 v6, 7282, v5
  v_lshrrev_b32 v6, 16, v6
  v_mul_u32_u24 v7, 9, v6
  v_sub_u32 v7, v5, v7
  v_and_b32 v8, 4, v4
  v_lshlrev_b32 v8, 1, v8
  v_and_b32 v9, 8, v4
  v_lshrrev_b32 v9, 1, v9
  v_and_b32 v10, 0xfffffff3, v4
  v_or3_b32 v10, v10, v8, v9
  v_mul_u32_u24 v10, 3456, v10
  v_mul_u32_u24 v6, 1152, v6
  v_lshl_add_u32 v7, v7, 4, v6
  v_add_u32 v10, v10, v7
  v_cmp_le_u32 vcc, 27, v5
  v_mov_b32 v11, 0x40000000
  s_nop 0
  v_cndmask_b32 v17, v10, v11, vcc
  v_add_u32 v3, 256, v1
  v_add_u32 v3, s54, v3
  v_mul_u32_u24 v4, 2185, v3
  v_lshrrev_b32 v4, 16, v4
  v_mul_u32_u24 v5, 30, v4
  v_sub_u32 v5, v3, v5
  v_mul_u32_u24 v6, 7282, v5
  v_lshrrev_b32 v6, 16, v6
  v_mul_u32_u24 v7, 9, v6
  v_sub_u32 v7, v5, v7
  v_and_b32 v8, 4, v4
  v_lshlrev_b32 v8, 1, v8
  v_and_b32 v9, 8, v4
  v_lshrrev_b32 v9, 1, v9
  v_and_b32 v10, 0xfffffff3, v4
  v_or3_b32 v10, v10, v8, v9
  v_mul_u32_u24 v10, 3456, v10
  v_mul_u32_u24 v6, 1152, v6
  v_lshl_add_u32 v7, v7, 4, v6
  v_add_u32 v10, v10, v7
  v_cmp_le_u32 vcc, 27, v5
  v_mov_b32 v11, 0x40000000
  s_nop 0
  v_cndmask_b32 v18, v10, v11, vcc
  v_add_u32 v3, 384, v1
  v_add_u32 v3, s54, v3
  v_mul_u32_u24 v4, 2185, v3
  v_lshrrev_b32 v4, 16, v4
  v_mul_u32_u24 v5, 30, v4
  v_sub_u32 v5, v3, v5
  v_mul_u32_u24 v6, 7282, v5
  v_lshrrev_b32 v6, 16, v6
  v_mul_u32_u24 v7, 9, v6
  v_sub_u32 v7, v5, v7
  v_and_b32 v8, 4, v4
  v_lshlrev_b32 v8, 1, v8
  v_and_b32 v9, 8, v4
  v_lshrrev_b32 v9, 1, v9
  v_and_b32 v10, 0xfffffff3, v4
  v_or3_b32 v10, v10, v8, v9
  v_mul_u32_u24 v10, 3456, v10
  v_mul_u32_u24 v6, 1152, v6
  v_lshl_add_u32 v7, v7, 4, v6
  v_add_u32 v10, v10, v7
  v_cmp_le_u32 vcc, 27, v5
  v_mov_b32 v11, 0x40000000
  s_nop 0
  v_cndmask_b32 v19, v10, v11, vcc
  v_add_u32 v3, 512, v1
  v_add_u32 v3, s54, v3
  v_mul_u32_u24 v4, 2185, v3
  v_lshrrev_b32 v4, 16, v4
  v_mul_u32_u24 v5, 30, v4
  v_sub_u32 v5, v3, v5
  v_mul_u32_u24 v6, 7282, v5
  v_lshrrev_b32 v6, 16, v6
  v_mul_u32_u24 v7, 9, v6
  v_sub_u32 v7, v5, v7
  v_and_b32 v8, 4, v4
  v_lshlrev_b32 v8, 1, v8
  v_and_b32 v9, 8, v4
  v_lshrrev_b32 v9, 1, v9
  v_and_b32 v10, 0xfffffff3, v4
  v_or3_b32 v10, v10, v8, v9
  v_mul_u32_u24 v10, 3456, v10
  v_mul_u32_u24 v6, 1152, v6
  v_lshl_add_u32 v7, v7, 4, v6
  v_add_u32 v10, v10, v7
  v_cmp_le_u32 vcc, 27, v5
  v_mov_b32 v11, 0x40000000
  s_nop 0
  v_cndmask_b32 v20, v10, v11, vcc
  v_add_u32 v3, 640, v1
  v_add_u32 v3, s54, v3
  v_mul_u32_u24 v4, 2185, v3
  v_lshrrev_b32 v4, 16, v4
  v_mul_u32_u24 v5, 30, v4
  v_sub_u32 v5, v3, v5
  v_mul_u32_u24 v6, 7282, v5
  v_lshrrev_b32 v6, 16, v6
  v_mul_u32_u24 v7, 9, v6
  v_sub_u32 v7, v5, v7
  v_and_b32 v8, 4, v4
  v_lshlrev_b32 v8, 1, v8
  v_and_b32 v9, 8, v4
  v_lshrrev_b32 v9, 1, v9
  v_and_b32 v10, 0xfffffff3, v4
  v_or3_b32 v10, v10, v8, v9
  v_mul_u32_u24 v10, 3456, v10
  v_mul_u32_u24 v6, 1152, v6
  v_lshl_add_u32 v7, v7, 4, v6
  v_add_u32 v10, v10, v7
  v_cmp_le_u32 vcc, 27, v5
  v_mov_b32 v11, 0x40000000
  s_nop 0
  v_cndmask_b32 v21, v10, v11, vcc
  v_add_u32 v3, 768, v1
  v_add_u32 v3, s54, v3
  v_mul_u32_u24 v4, 2185, v3
  v_lshrrev_b32 v4, 16, v4
  v_mul_u32_u24 v5, 30, v4
  v_sub_u32 v5, v3, v5
  v_mul_u32_u24 v6, 7282, v5
  v_lshrrev_b32 v6, 16, v6
  v_mul_u32_u24 v7, 9, v6
  v_sub_u32 v7, v5, v7
  v_and_b32 v8, 4, v4
  v_lshlrev_b32 v8, 1, v8
  v_and_b32 v9, 8, v4
  v_lshrrev_b32 v9, 1, v9
  v_and_b32 v10, 0xfffffff3, v4
  v_or3_b32 v10, v10, v8, v9
  v_mul_u32_u24 v10, 3456, v10
  v_mul_u32_u24 v6, 1152, v6
  v_lshl_add_u32 v7, v7, 4, v6
  v_add_u32 v10, v10, v7
  v_cmp_le_u32 vcc, 27, v5
  v_mov_b32 v11, 0x40000000
  s_nop 0
  v_cndmask_b32 v22, v10, v11, vcc
  v_add_u32 v3, 896, v1
  v_add_u32 v3, s54, v3
  v_mul_u32_u24 v4, 2185, v3
  v_lshrrev_b32 v4, 16, v4
  v_mul_u32_u24 v5, 30, v4
  v_sub_u32 v5, v3, v5
  v_mul_u32_u24 v6, 7282, v5
  v_lshrrev_b32 v6, 16, v6
  v_mul_u32_u24 v7, 9, v6
  v_sub_u32 v7, v5, v7
  v_and_b32 v8, 4, v4
  v_lshlrev_b32 v8, 1, v8
  v_and_b32 v9, 8, v4
  v_lshrrev_b32 v9, 1, v9
  v_and_b32 v10, 0xfffffff3, v4
  v_or3_b32 v10, v10, v8, v9
  v_mul_u32_u24 v10, 3456, v10
  v_mul_u32_u24 v6, 1152, v6
  v_lshl_add_u32 v7, v7, 4, v6
  v_add_u32 v10, v10, v7
  v_cmp_le_u32 vcc, 27, v5
  v_mov_b32 v11, 0x40000000
  s_nop 0
  v_cndmask_b32 v23, v10, v11, vcc
  v_add_u32 v3, 1024, v1
  v_add_u32 v3, s54, v3
  v_mul_u32_u24 v4, 2185, v3
  v_lshrrev_b32 v4, 16, v4
  v_mul_u32_u24 v5, 30, v4
  v_sub_u32 v5, v3, v5
  v_mul_u32_u24 v6, 7282, v5
  v_lshrrev_b32 v6, 16, v6
  v_mul_u32_u24 v7, 9, v6
  v_sub_u32 v7, v5, v7
  v_and_b32 v8, 4, v4
  v_lshlrev_b32 v8, 1, v8
  v_and_b32 v9, 8, v4
  v_lshrrev_b32 v9, 1, v9
  v_and_b32 v10, 0xfffffff3, v4
  v_or3_b32 v10, v10, v8, v9
  v_mul_u32_u24 v10, 3456, v10
  v_mul_u32_u24 v6, 1152, v6
  v_lshl_add_u32 v7, v7, 4, v6
  v_add_u32 v10, v10, v7
  v_cmp_le_u32 vcc, 27, v5
  v_mov_b32 v11, 0x40000000
  s_nop 0
  v_cndmask_b32 v24, v10, v11, vcc
  v_add_u32 v3, 1152, v1
  v_add_u32 v3, s54, v3
  v_mul_u32_u24 v4, 2185, v3
  v_lshrrev_b32 v4, 16, v4
  v_mul_u32_u24 v5, 30, v4
  v_sub_u32 v5, v3, v5
  v_mul_u32_u24 v6, 7282, v5
  v_lshrrev_b32 v6, 16, v6
  v_mul_u32_u24 v7, 9, v6
  v_sub_u32 v7, v5, v7
  v_and_b32 v8, 4, v4
  v_lshlrev_b32 v8, 1, v8
  v_and_b32 v9, 8, v4
  v_lshrrev_b32 v9, 1, v9
  v_and_b32 v10, 0xfffffff3, v4
  v_or3_b32 v10, v10, v8, v9
  v_mul_u32_u24 v10, 3456, v10
  v_mul_u32_u24 v6, 1152, v6
  v_lshl_add_u32 v7, v7, 4, v6
  v_add_u32 v10, v10, v7
  v_cmp_le_u32 vcc, 27, v5
  v_mov_b32 v11, 0x40000000
  s_nop 0
  v_cndmask_b32 v25, v10, v11, vcc
  v_add_u32 v3, 1280, v1
  v_add_u32 v3, s54, v3
  v_mul_u32_u24 v4, 2185, v3
  v_lshrrev_b32 v4, 16, v4
  v_mul_u32_u24 v5, 30, v4
  v_sub_u32 v5, v3, v5
  v_mul_u32_u24 v6, 7282, v5
  v_lshrrev_b32 v6, 16, v6
  v_mul_u32_u24 v7, 9, v6
  v_sub_u32 v7, v5, v7
  v_and_b32 v8, 4, v4
  v_lshlrev_b32 v8, 1, v8
  v_and_b32 v9, 8, v4
  v_lshrrev_b32 v9, 1, v9
  v_and_b32 v10, 0xfffffff3, v4
  v_or3_b32 v10, v10, v8, v9
  v_mul_u32_u24 v10, 3456, v10
  v_mul_u32_u24 v6, 1152, v6
  v_lshl_add_u32 v7, v7, 4, v6
  v_add_u32 v10, v10, v7
  v_cmp_le_u32 vcc, 27, v5
  v_mov_b32 v11, 0x40000000
  s_nop 0
  v_cndmask_b32 v26, v10, v11, vcc
  v_add_u32 v3, 1408, v1
  v_add_u32 v3, s54, v3
  v_mul_u32_u24 v4, 2185, v3
  v_lshrrev_b32 v4, 16, v4
  v_mul_u32_u24 v5, 30, v4
  v_sub_u32 v5, v3, v5
  v_mul_u32_u24 v6, 7282, v5
  v_lshrrev_b32 v6, 16, v6
  v_mul_u32_u24 v7, 9, v6
  v_sub_u32 v7, v5, v7
  v_and_b32 v8, 4, v4
  v_lshlrev_b32 v8, 1, v8
  v_and_b32 v9, 8, v4
  v_lshrrev_b32 v9, 1, v9
  v_and_b32 v10, 0xfffffff3, v4
  v_or3_b32 v10, v10, v8, v9
  v_mul_u32_u24 v10, 3456, v10
  v_mul_u32_u24 v6, 1152, v6
  v_lshl_add_u32 v7, v7, 4, v6
  v_add_u32 v10, v10, v7
  v_cmp_le_u32 vcc, 27, v5
  v_mov_b32 v11, 0x40000000
  s_nop 0
  v_cndmask_b32 v27, v10, v11, vcc
  v_add_u32 v3, 1536, v1
  v_add_u32 v3, s54, v3
  v_mul_u32_u24 v4, 2185, v3
  v_lshrrev_b32 v4, 16, v4
  v_mul_u32_u24 v5, 30, v4
  v_sub_u32 v5, v3, v5
  v_mul_u32_u24 v6, 7282, v5
  v_lshrrev_b32 v6, 16, v6
  v_mul_u32_u24 v7, 9, v6
  v_sub_u32 v7, v5, v7
  v_and_b32 v8, 4, v4
  v_lshlrev_b32 v8, 1, v8
  v_and_b32 v9, 8, v4
  v_lshrrev_b32 v9, 1, v9
  v_and_b32 v10, 0xfffffff3, v4
  v_or3_b32 v10, v10, v8, v9
  v_mul_u32_u24 v10, 3456, v10
  v_mul_u32_u24 v6, 1152, v6
  v_lshl_add_u32 v7, v7, 4, v6
  v_add_u32 v10, v10, v7
  v_cmp_le_u32 vcc, 27, v5
  v_mov_b32 v11, 0x40000000
  s_nop 0
  v_cndmask_b32 v28, v10, v11, vcc
  v_add_u32 v3, 1664, v1
  v_add_u32 v3, s54, v3
  v_mul_u32_u24 v4, 2185, v3
  v_lshrrev_b32 v4, 16, v4
  v_mul_u32_u24 v5, 30, v4
  v_sub_u32 v5, v3, v5
  v_mul_u32_u24 v6, 7282, v5
  v_lshrrev_b32 v6, 16, v6
  v_mul_u32_u24 v7, 9, v6
  v_sub_u32 v7, v5, v7
  v_and_b32 v8, 4, v4
  v_lshlrev_b32 v8, 1, v8
  v_and_b32 v9, 8, v4
  v_lshrrev_b32 v9, 1, v9
  v_and_b32 v10, 0xfffffff3, v4
  v_or3_b32 v10, v10, v8, v9
  v_mul_u32_u24 v10, 3456, v10
  v_mul_u32_u24 v6, 1152, v6
  v_lshl_add_u32 v7, v7, 4, v6
  v_add_u32 v10, v10, v7
  v_cmp_le_u32 vcc, 27, v5
  v_mov_b32 v11, 0x40000000
  s_nop 0
  v_cndmask_b32 v29, v10, v11, vcc
  v_add_u32 v3, 1792, v1
  v_add_u32 v3, s54, v3
  v_mul_u32_u24 v4, 2185, v3
  v_lshrrev_b32 v4, 16, v4
  v_mul_u32_u24 v5, 30, v4
  v_sub_u32 v5, v3, v5
  v_mul_u32_u24 v6, 7282, v5
  v_lshrrev_b32 v6, 16, v6
  v_mul_u32_u24 v7, 9, v6
  v_sub_u32 v7, v5, v7
  v_and_b32 v8, 4, v4
  v_lshlrev_b32 v8, 1, v8
  v_and_b32 v9, 8, v4
  v_lshrrev_b32 v9, 1, v9
  v_and_b32 v10, 0xfffffff3, v4
  v_or3_b32 v10, v10, v8, v9
  v_mul_u32_u24 v10, 3456, v10
  v_mul_u32_u24 v6, 1152, v6
  v_lshl_add_u32 v7, v7, 4, v6
  v_add_u32 v10, v10, v7
  v_cmp_le_u32 vcc, 27, v5
  v_mov_b32 v11, 0x40000000
  s_nop 0
  v_cndmask_b32 v30, v10, v11, vcc
  s_mul_i32 s51, s47, 144
  s_lshl_b32 s55, s53, 10
  s_add_u32 s52, s51, 0
  s_add_u32 m0, s55, 16384
  s_nop 0
  buffer_load_dwordx4 v16, s[12:15], s52 offen lds
  s_add_u32 m0, s55, 18432
  s_nop 0
  buffer_load_dwordx4 v17, s[12:15], s52 offen lds
  s_add_u32 m0, s55, 20480
  s_nop 0
  buffer_load_dwordx4 v18, s[12:15], s52 offen lds
  s_add_u32 m0, s55, 22528
  s_nop 0
  buffer_load_dwordx4 v19, s[12:15], s52 offen lds
  s_add_u32 m0, s55, 24576
  s_nop 0
  buffer_load_dwordx4 v20, s[12:15], s52 offen lds
  s_add_u32 m0, s55, 26624
  s_nop 0
  buffer_load_dwordx4 v21, s[12:15], s52 offen lds
  s_add_u32 m0, s55, 28672
  s_nop 0
  buffer_load_dwordx4 v22, s[12:15], s52 offen lds
  s_add_u32 m0, s55, 30720
  s_nop 0
  buffer_load_dwordx4 v23, s[12:15], s52 offen lds
  s_add_u32 m0, s55, 32768
  s_nop 0
  buffer_load_dwordx4 v24, s[12:15], s52 offen lds
  s_add_u32 m0, s55, 34816
  s_nop 0
  buffer_load_dwordx4 v25, s[12:15], s52 offen lds
  s_add_u32 m0, s55, 36864
  s_nop 0
  buffer_load_dwordx4 v26, s[12:15], s52 offen lds
  s_add_u32 m0, s55, 38912
  s_nop 0
  buffer_load_dwordx4 v27, s[12:15], s52 offen lds
  s_add_u32 m0, s55, 40960
  s_nop 0
  buffer_load_dwordx4 v28, s[12:15], s52 offen lds
  s_add_u32 m0, s55, 43008
  s_nop 0
  buffer_load_dwordx4 v29, s[12:15], s52 offen lds
  s_add_u32 m0, s55, 45056
  s_nop 0
  buffer_load_dwordx4 v30, s[12:15], s52 offen lds
  s_add_u32 s52, s51, 221184
  s_add_u32 m0, s55, 63488
  s_nop 0
  buffer_load_dwordx4 v16, s[12:15], s52 offen lds
  s_add_u32 m0, s55, 65536
  s_nop 0
  buffer_load_dwordx4 v17, s[12:15], s52 offen lds
  s_add_u32 m0, s55, 67584
  s_nop 0
  buffer_load_dwordx4 v18, s[12:15], s52 offen lds
  s_add_u32 m0, s55, 69632
  s_nop 0
  buffer_load_dwordx4 v19, s[12:15], s52 offen lds
  s_add_u32 m0, s55, 71680
  s_nop 0
  buffer_load_dwordx4 v20, s[12:15], s52 offen lds
  s_add_u32 m0, s55, 73728
  s_nop 0
  buffer_load_dwordx4 v21, s[12:15], s52 offen lds
  s_add_u32 m0, s55, 75776
  s_nop 0
  buffer_load_dwordx4 v22, s[12:15], s52 offen lds
  s_add_u32 m0, s55, 77824
  s_nop 0
  buffer_load_dwordx4 v23, s[12:15], s52 offen lds
  s_add_u32 m0, s55, 79872
  s_nop 0
  buffer_load_dwordx4 v24, s[12:15], s52 offen lds
  s_add_u32 m0, s55, 81920
  s_nop 0
  buffer_load_dwordx4 v25, s[12:15], s52 offen lds
  s_add_u32 m0, s55, 83968
  s_nop 0
  buffer_load_dwordx4 v26, s[12:15], s52 offen lds
  s_add_u32 m0, s55, 86016
  s_nop 0
  buffer_load_dwordx4 v27, s[12:15], s52 offen lds
  s_add_u32 m0, s55, 88064
  s_nop 0
  buffer_load_dwordx4 v28, s[12:15], s52 offen lds
  s_add_u32 m0, s55, 90112
  s_nop 0
  buffer_load_dwordx4 v29, s[12:15], s52 offen lds
  s_add_u32 m0, s55, 92160
  s_nop 0
  buffer_load_dwordx4 v30, s[12:15], s52 offen lds
  s_waitcnt vmcnt(15)
  s_barrier
  s_add_u32 s52, s51, 442368
  s_add_u32 m0, s55, 110592
  s_nop 0
  buffer_load_dwordx4 v16, s[12:15], s52 offen lds
  s_add_u32 m0, s55, 112640
  s_nop 0
  buffer_load_dwordx4 v17, s[12:15], s52 offen lds
  s_add_u32 m0, s55, 114688
  s_nop 0
  buffer_load_dwordx4 v18, s[12:15], s52 offen lds
  s_add_u32 m0, s55, 116736
  s_nop 0
  buffer_load_dwordx4 v19, s[12:15], s52 offen lds
  s_add_u32 m0, s55, 118784
  s_nop 0
  buffer_load_dwordx4 v20, s[12:15], s52 offen lds
  s_add_u32 m0, s55, 120832
  s_nop 0
  buffer_load_dwordx4 v21, s[12:15], s52 offen lds
  s_add_u32 m0, s55, 122880
  s_nop 0
  buffer_load_dwordx4 v22, s[12:15], s52 offen lds
  s_add_u32 m0, s55, 124928
  s_nop 0
  buffer_load_dwordx4 v23, s[12:15], s52 offen lds
  s_add_u32 m0, s55, 126976
  s_nop 0
  buffer_load_dwordx4 v24, s[12:15], s52 offen lds
  s_add_u32 m0, s55, 129024
  s_nop 0
  buffer_load_dwordx4 v25, s[12:15], s52 offen lds
  s_add_u32 m0, s55, 131072
  s_nop 0
  buffer_load_dwordx4 v26, s[12:15], s52 offen lds
  s_add_u32 m0, s55, 133120
  s_nop 0
  buffer_load_dwordx4 v27, s[12:15], s52 offen lds
  s_add_u32 m0, s55, 135168
  s_nop 0
  buffer_load_dwordx4 v28, s[12:15], s52 offen lds
  s_add_u32 m0, s55, 137216
  s_nop 0
  buffer_load_dwordx4 v29, s[12:15], s52 offen lds
  s_add_u32 m0, s55, 139264
  s_nop 0
  buffer_load_dwordx4 v30, s[12:15], s52 offen lds
  s_waitcnt vmcnt(15)
  s_barrier
  s_add_u32 s52, s51, 663552
  s_add_u32 m0, s55, 16384
  s_nop 0
  buffer_load_dwordx4 v16, s[12:15], s52 offen lds
  s_add_u32 m0, s55, 18432
  s_nop 0
  buffer_load_dwordx4 v17, s[12:15], s52 offen lds
  s_add_u32 m0, s55, 20480
  s_nop 0
  buffer_load_dwordx4 v18, s[12:15], s52 offen lds
  s_add_u32 m0, s55, 22528
  s_nop 0
  buffer_load_dwordx4 v19, s[12:15], s52 offen lds
  s_add_u32 m0, s55, 24576
  s_nop 0
  buffer_load_dwordx4 v20, s[12:15], s52 offen lds
  s_add_u32 m0, s55, 26624
  s_nop 0
  buffer_load_dwordx4 v21, s[12:15], s52 offen lds
  s_add_u32 m0, s55, 28672
  s_nop 0
  buffer_load_dwordx4 v22, s[12:15], s52 offen lds
  s_add_u32 m0, s55, 30720
  s_nop 0
  buffer_load_dwordx4 v23, s[12:15], s52 offen lds
  s_add_u32 m0, s55, 32768
  s_nop 0
  buffer_load_dwordx4 v24, s[12:15], s52 offen lds
  s_add_u32 m0, s55, 34816
  s_nop 0
  buffer_load_dwordx4 v25, s[12:15], s52 offen lds
  s_add_u32 m0, s55, 36864
  s_nop 0
  buffer_load_dwordx4 v26, s[12:15], s52 offen lds
  s_add_u32 m0, s55, 38912
  s_nop 0
  buffer_load_dwordx4 v27, s[12:15], s52 offen lds
  s_add_u32 m0, s55, 40960
  s_nop 0
  buffer_load_dwordx4 v28, s[12:15], s52 offen lds
  s_add_u32 m0, s55, 43008
  s_nop 0
  buffer_load_dwordx4 v29, s[12:15], s52 offen lds
  s_add_u32 m0, s55, 45056
  s_nop 0
  buffer_load_dwordx4 v30, s[12:15], s52 offen lds
  s_waitcnt vmcnt(15)
  s_barrier
  s_add_u32 s52, s51, 884736
  s_add_u32 m0, s55, 63488
  s_nop 0
  buffer_load_dwordx4 v16, s[12:15], s52 offen lds
  s_add_u32 m0, s55, 65536
  s_nop 0
  buffer_load_dwordx4 v17, s[12:15], s52 offen lds
  s_add_u32 m0, s55, 67584
  s_nop 0
  buffer_load_dwordx4 v18, s[12:15], s52 offen lds
  s_add_u32 m0, s55, 69632
  s_nop 0
  buffer_load_dwordx4 v19, s[12:15], s52 offen lds
  s_add_u32 m0, s55, 71680
  s_nop 0
  buffer_load_dwordx4 v20, s[12:15], s52 offen lds
  s_add_u32 m0, s55, 73728
  s_nop 0
  buffer_load_dwordx4 v21, s[12:15], s52 offen lds
  s_add_u32 m0, s55, 75776
  s_nop 0
  buffer_load_dwordx4 v22, s[12:15], s52 offen lds
  s_add_u32 m0, s55, 77824
  s_nop 0
  buffer_load_dwordx4 v23, s[12:15], s52 offen lds
  s_add_u32 m0, s55, 79872
  s_nop 0
  buffer_load_dwordx4 v24, s[12:15], s52 offen lds
  s_add_u32 m0, s55, 81920
  s_nop 0
  buffer_load_dwordx4 v25, s[12:15], s52 offen lds
  s_add_u32 m0, s55, 83968
  s_nop 0
  buffer_load_dwordx4 v26, s[12:15], s52 offen lds
  s_add_u32 m0, s55, 86016
  s_nop 0
  buffer_load_dwordx4 v27, s[12:15], s52 offen lds
  s_add_u32 m0, s55, 88064
  s_nop 0
  buffer_load_dwordx4 v28, s[12:15], s52 offen lds
  s_add_u32 m0, s55, 90112
  s_nop 0
  buffer_load_dwordx4 v29, s[12:15], s52 offen lds
  s_add_u32 m0, s55, 92160
  s_nop 0
  buffer_load_dwordx4 v30, s[12:15], s52 offen lds
  s_waitcnt vmcnt(15)
  s_barrier
  s_add_u32 s52, s51, 1105920
  s_add_u32 m0, s55, 110592
  s_nop 0
  buffer_load_dwordx4 v16, s[12:15], s52 offen lds
  s_add_u32 m0, s55, 112640
  s_nop 0
  buffer_load_dwordx4 v17, s[12:15], s52 offen lds
  s_add_u32 m0, s55, 114688
  s_nop 0
  buffer_load_dwordx4 v18, s[12:15], s52 offen lds
  s_add_u32 m0, s55, 116736
  s_nop 0
  buffer_load_dwordx4 v19, s[12:15], s52 offen lds
  s_add_u32 m0, s55, 118784
  s_nop 0
  buffer_load_dwordx4 v20, s[12:15], s52 offen lds
  s_add_u32 m0, s55, 120832
  s_nop 0
  buffer_load_dwordx4 v21, s[12:15], s52 offen lds
  s_add_u32 m0, s55, 122880
  s_nop 0
  buffer_load_dwordx4 v22, s[12:15], s52 offen lds
  s_add_u32 m0, s55, 124928
  s_nop 0
  buffer_load_dwordx4 v23, s[12:15], s52 offen lds
  s_add_u32 m0, s55, 126976
  s_nop 0
  buffer_load_dwordx4 v24, s[12:15], s52 offen lds
  s_add_u32 m0, s55, 129024
  s_nop 0
  buffer_load_dwordx4 v25, s[12:15], s52 offen lds
  s_add_u32 m0, s55, 131072
  s_nop 0
  buffer_load_dwordx4 v26, s[12:15], s52 offen lds
  s_add_u32 m0, s55, 133120
  s_nop 0
  buffer_load_dwordx4 v27, s[12:15], s52 offen lds
  s_add_u32 m0, s55, 135168
  s_nop 0
  buffer_load_dwordx4 v28, s[12:15], s52 offen lds
  s_add_u32 m0, s55, 137216
  s_nop 0
  buffer_load_dwordx4 v29, s[12:15], s52 offen lds
  s_add_u32 m0, s55, 139264
  s_nop 0
  buffer_load_dwordx4 v30, s[12:15], s52 offen lds
  s_waitcnt vmcnt(15)
  s_barrier
  s_add_u32 s52, s51, 1327104
  s_add_u32 m0, s55, 16384
  s_nop 0
  buffer_load_dwordx4 v16, s[12:15], s52 offen lds
  s_add_u32 m0, s55, 18432
  s_nop 0
  buffer_load_dwordx4 v17, s[12:15], s52 offen lds
  s_add_u32 m0, s55, 20480
  s_nop 0
  buffer_load_dwordx4 v18, s[12:15], s52 offen lds
  s_add_u32 m0, s55, 22528
  s_nop 0
  buffer_load_dwordx4 v19, s[12:15], s52 offen lds
  s_add_u32 m0, s55, 24576
  s_nop 0
  buffer_load_dwordx4 v20, s[12:15], s52 offen lds
  s_add_u32 m0, s55, 26624
  s_nop 0
  buffer_load_dwordx4 v21, s[12:15], s52 offen lds
  s_add_u32 m0, s55, 28672
  s_nop 0
  buffer_load_dwordx4 v22, s[12:15], s52 offen lds
  s_add_u32 m0, s55, 30720
  s_nop 0
  buffer_load_dwordx4 v23, s[12:15], s52 offen lds
  s_add_u32 m0, s55, 32768
  s_nop 0
  buffer_load_dwordx4 v24, s[12:15], s52 offen lds
  s_add_u32 m0, s55, 34816
  s_nop 0
  buffer_load_dwordx4 v25, s[12:15], s52 offen lds
  s_add_u32 m0, s55, 36864
  s_nop 0
  buffer_load_dwordx4 v26, s[12:15], s52 offen lds
  s_add_u32 m0, s55, 38912
  s_nop 0
  buffer_load_dwordx4 v27, s[12:15], s52 offen lds
  s_add_u32 m0, s55, 40960
  s_nop 0
  buffer_load_dwordx4 v28, s[12:15], s52 offen lds
  s_add_u32 m0, s55, 43008
  s_nop 0
  buffer_load_dwordx4 v29, s[12:15], s52 offen lds
  s_add_u32 m0, s55, 45056
  s_nop 0
  buffer_load_dwordx4 v30, s[12:15], s52 offen lds
  s_waitcnt vmcnt(15)
  s_barrier
  s_add_u32 s52, s51, 1548288
  s_add_u32 m0, s55, 63488
  s_nop 0
  buffer_load_dwordx4 v16, s[12:15], s52 offen lds
  s_add_u32 m0, s55, 65536
  s_nop 0
  buffer_load_dwordx4 v17, s[12:15], s52 offen lds
  s_add_u32 m0, s55, 67584
  s_nop 0
  buffer_load_dwordx4 v18, s[12:15], s52 offen lds
  s_add_u32 m0, s55, 69632
  s_nop 0
  buffer_load_dwordx4 v19, s[12:15], s52 offen lds
  s_add_u32 m0, s55, 71680
  s_nop 0
  buffer_load_dwordx4 v20, s[12:15], s52 offen lds
  s_add_u32 m0, s55, 73728
  s_nop 0
  buffer_load_dwordx4 v21, s[12:15], s52 offen lds
  s_add_u32 m0, s55, 75776
  s_nop 0
  buffer_load_dwordx4 v22, s[12:15], s52 offen lds
  s_add_u32 m0, s55, 77824
  s_nop 0
  buffer_load_dwordx4 v23, s[12:15], s52 offen lds
  s_add_u32 m0, s55, 79872
  s_nop 0
  buffer_load_dwordx4 v24, s[12:15], s52 offen lds
  s_add_u32 m0, s55, 81920
  s_nop 0
  buffer_load_dwordx4 v25, s[12:15], s52 offen lds
  s_add_u32 m0, s55, 83968
  s_nop 0
  buffer_load_dwordx4 v26, s[12:15], s52 offen lds
  s_add_u32 m0, s55, 86016
  s_nop 0
  buffer_load_dwordx4 v27, s[12:15], s52 offen lds
  s_add_u32 m0, s55, 88064
  s_nop 0
  buffer_load_dwordx4 v28, s[12:15], s52 offen lds
  s_add_u32 m0, s55, 90112
  s_nop 0
  buffer_load_dwordx4 v29, s[12:15], s52 offen lds
  s_add_u32 m0, s55, 92160
  s_nop 0
  buffer_load_dwordx4 v30, s[12:15], s52 offen lds
  s_waitcnt vmcnt(15)
  s_barrier
  s_add_u32 s52, s51, 1769472
  s_add_u32 m0, s55, 110592
  s_nop 0
  buffer_load_dwordx4 v16, s[12:15], s52 offen lds
  s_add_u32 m0, s55, 112640
  s_nop 0
  buffer_load_dwordx4 v17, s[12:15], s52 offen lds
  s_add_u32 m0, s55, 114688
  s_nop 0
  buffer_load_dwordx4 v18, s[12:15], s52 offen lds
  s_add_u32 m0, s55, 116736
  s_nop 0
  buffer_load_dwordx4 v19, s[12:15], s52 offen lds
  s_add_u32 m0, s55, 118784
  s_nop 0
  buffer_load_dwordx4 v20, s[12:15], s52 offen lds
  s_add_u32 m0, s55, 120832
  s_nop 0
  buffer_load_dwordx4 v21, s[12:15], s52 offen lds
  s_add_u32 m0, s55, 122880
  s_nop 0
  buffer_load_dwordx4 v22, s[12:15], s52 offen lds
  s_add_u32 m0, s55, 124928
  s_nop 0
  buffer_load_dwordx4 v23, s[12:15], s52 offen lds
  s_add_u32 m0, s55, 126976
  s_nop 0
  buffer_load_dwordx4 v24, s[12:15], s52 offen lds
  s_add_u32 m0, s55, 129024
  s_nop 0
  buffer_load_dwordx4 v25, s[12:15], s52 offen lds
  s_add_u32 m0, s55, 131072
  s_nop 0
  buffer_load_dwordx4 v26, s[12:15], s52 offen lds
  s_add_u32 m0, s55, 133120
  s_nop 0
  buffer_load_dwordx4 v27, s[12:15], s52 offen lds
  s_add_u32 m0, s55, 135168
  s_nop 0
  buffer_load_dwordx4 v28, s[12:15], s52 offen lds
  s_add_u32 m0, s55, 137216
  s_nop 0
  buffer_load_dwordx4 v29, s[12:15], s52 offen lds
  s_add_u32 m0, s55, 139264
  s_nop 0
  buffer_load_dwordx4 v30, s[12:15], s52 offen lds
  s_waitcnt vmcnt(15)
  s_barrier
  s_waitcnt vmcnt(0)
  s_barrier
  s_branch K1_POST
K1_AUX:
  s_mov_b64 exec, 1
  v_mov_b32 v2, 1
  s_lshl_b32 s49, s45, 2
  v_mov_b32 v3, s49
  buffer_atomic_add v2, v3, s[20:23], 0 offen sc0
  s_mov_b64 exec, -1
  v_lshrrev_b32 v4, 3, v1
  v_and_b32 v5, 7, v1
  v_mul_u32_u24 v6, 144, v5
  v_mul_u32_u24 v4, 1152, v4
  v_add_u32 v4, v4, v6
  s_lshl_b32 s50, s44, 7
  s_lshl_b32 s51, s45, 3
  s_add_u32 s50, s50, s51
  s_mul_i32 s51, s50, 1152
  buffer_load_dwordx4 v[16:19], v4, s[8:11], s51 offen offset:0
  buffer_load_dwordx4 v[20:23], v4, s[8:11], s51 offen offset:16
  buffer_load_dwordx4 v[24:27], v4, s[8:11], s51 offen offset:32
  buffer_load_dwordx4 v[28:31], v4, s[8:11], s51 offen offset:48
  buffer_load_dwordx4 v[32:35], v4, s[8:11], s51 offen offset:64
  buffer_load_dwordx4 v[36:39], v4, s[8:11], s51 offen offset:80
  buffer_load_dwordx4 v[40:43], v4, s[8:11], s51 offen offset:96
  buffer_load_dwordx4 v[44:47], v4, s[8:11], s51 offen offset:112
  buffer_load_dwordx4 v[48:51], v4, s[8:11], s51 offen offset:128
  buffer_load_dwordx4 v[52:55], v6, s[40:43], 0 offen offset:0
  buffer_load_dwordx4 v[56:59], v6, s[40:43], 0 offen offset:16
  buffer_load_dwordx4 v[60:63], v6, s[40:43], 0 offen offset:32
  buffer_load_dwordx4 v[64:67], v6, s[40:43], 0 offen offset:48
  buffer_load_dwordx4 v[68:71], v6, s[40:43], 0 offen offset:64
  buffer_load_dwordx4 v[72:75], v6, s[40:43], 0 offen offset:80
  buffer_load_dwordx4 v[76:79], v6, s[40:43], 0 offen offset:96
  buffer_load_dwordx4 v[80:83], v6, s[40:43], 0 offen offset:112
  buffer_load_dwordx4 v[84:87], v6, s[40:43], 0 offen offset:128
  v_lshrrev_b32 v14, 4, v1
  v_mul_u32_u24 v14, 9216, v14
  v_and_b32 v15, 15, v1
  v_lshl_add_u32 v14, v15, 1, v14
  v_add_u32 v15, 4608, v14
  s_mov_b32 s58, 7340032
  s_add_u32 s59, s2, 0
  s_mul_i32 s56, s59, 3641
  s_lshr_b32 s56, s56, 16
  s_mul_i32 s57, s56, 18
  s_sub_u32 s57, s59, s57
  s_mul_i32 s57, s57, 36864
  s_lshl_b32 s56, s56, 5
  s_add_u32 s56, s56, s57
  s_lshl_b32 s57, s59, 10
  s_add_u32 s57, s57, s58
  buffer_load_ushort v92, v14, s[88:91], s56 offen offset:0
  buffer_load_ushort v93, v14, s[88:91], s56 offen offset:1152
  buffer_load_ushort v94, v14, s[88:91], s56 offen offset:2304
  buffer_load_ushort v95, v14, s[88:91], s56 offen offset:3456
  buffer_load_ushort v96, v15, s[88:91], s56 offen offset:0
  buffer_load_ushort v97, v15, s[88:91], s56 offen offset:1152
  buffer_load_ushort v98, v15, s[88:91], s56 offen offset:2304
  buffer_load_ushort v99, v15, s[88:91], s56 offen offset:3456
  s_add_u32 s59, s2, 256
  s_mul_i32 s56, s59, 3641
  s_lshr_b32 s56, s56, 16
  s_mul_i32 s57, s56, 18
  s_sub_u32 s57, s59, s57
  s_mul_i32 s57, s57, 36864
  s_lshl_b32 s56, s56, 5
  s_add_u32 s56, s56, s57
  s_lshl_b32 s57, s59, 10
  s_add_u32 s57, s57, s58
  buffer_load_ushort v100, v14, s[88:91], s56 offen offset:0
  buffer_load_ushort v101, v14, s[88:91], s56 offen offset:1152
  buffer_load_ushort v102, v14, s[88:91], s56 offen offset:2304
  buffer_load_ushort v103, v14, s[88:91], s56 offen offset:3456
  buffer_load_ushort v104, v15, s[88:91], s56 offen offset:0
  buffer_load_ushort v105, v15, s[88:91], s56 offen offset:1152
  buffer_load_ushort v106, v15, s[88:91], s56 offen offset:2304
  buffer_load_ushort v107, v15, s[88:91], s56 offen offset:3456
  s_cmp_ge_u32 s2, 136
  s_cbranch_scc1 K1_WOL88
  s_add_u32 s59, s2, 512
  s_mul_i32 s56, s59, 3641
  s_lshr_b32 s56, s56, 16
  s_mul_i32 s57, s56, 18
  s_sub_u32 s57, s59, s57
  s_mul_i32 s57, s57, 36864
  s_lshl_b32 s56, s56, 5
  s_add_u32 s56, s56, s57
  s_lshl_b32 s57, s59, 10
  s_add_u32 s57, s57, s58
  buffer_load_ushort v108, v14, s[88:91], s56 offen offset:0
  buffer_load_ushort v109, v14, s[88:91], s56 offen offset:1152
  buffer_load_ushort v110, v14, s[88:91], s56 offen offset:2304
  buffer_load_ushort v111, v14, s[88:91], s56 offen offset:3456
  buffer_load_ushort v112, v15, s[88:91], s56 offen offset:0
  buffer_load_ushort v113, v15, s[88:91], s56 offen offset:1152
  buffer_load_ushort v114, v15, s[88:91], s56 offen offset:2304
  buffer_load_ushort v115, v15, s[88:91], s56 offen offset:3456
K1_WOL88:
  s_barrier
  s_barrier
  s_waitcnt vmcnt(0)
  v_readfirstlane_b32 s63, v2
  s_cmp_lg_u32 s63, 0
  s_nop 3
  s_cbranch_scc1 K1_AUX_NZ
  v_mov_b32 v8, 0
  v_mov_b32 v9, 0
  v_mov_b32 v10, 0
  v_mov_b32 v11, 0
  v_lshlrev_b32 v7, 4, v1
  s_mul_i32 s52, s47, 6144
  s_add_u32 s52, s52, 7077888
  s_mul_i32 s53, s47, 11264
  s_add_u32 s53, s53, 7143424
  buffer_store_dwordx4 v[8:11], v7, s[16:19], s52 offen offset:0 sc0 sc1
  buffer_store_dwordx4 v[8:11], v7, s[16:19], s52 offen offset:1024 sc0 sc1
  buffer_store_dwordx4 v[8:11], v7, s[16:19], s52 offen offset:2048 sc0 sc1
  buffer_store_dwordx4 v[8:11], v7, s[16:19], s52 offen offset:3072 sc0 sc1
  s_add_u32 s52, s52, 4096
  buffer_store_dwordx4 v[8:11], v7, s[16:19], s52 offen offset:0 sc0 sc1
  buffer_store_dwordx4 v[8:11], v7, s[16:19], s52 offen offset:1024 sc0 sc1
  s_cmp_eq_u32 s46, 0
  s_nop 0
  s_cbranch_scc1 K1_AUX_NZ
  buffer_store_dwordx4 v[8:11], v7, s[16:19], s53 offen offset:0 sc0 sc1
  buffer_store_dwordx4 v[8:11], v7, s[16:19], s53 offen offset:1024 sc0 sc1
  buffer_store_dwordx4 v[8:11], v7, s[16:19], s53 offen offset:2048 sc0 sc1
  buffer_store_dwordx4 v[8:11], v7, s[16:19], s53 offen offset:3072 sc0 sc1
  s_add_u32 s53, s53, 4096
  buffer_store_dwordx4 v[8:11], v7, s[16:19], s53 offen offset:0 sc0 sc1
  buffer_store_dwordx4 v[8:11], v7, s[16:19], s53 offen offset:1024 sc0 sc1
  buffer_store_dwordx4 v[8:11], v7, s[16:19], s53 offen offset:2048 sc0 sc1
  buffer_store_dwordx4 v[8:11], v7, s[16:19], s53 offen offset:3072 sc0 sc1
  s_add_u32 s53, s53, 4096
  buffer_store_dwordx4 v[8:11], v7, s[16:19], s53 offen offset:0 sc0 sc1
  buffer_store_dwordx4 v[8:11], v7, s[16:19], s53 offen offset:1024 sc0 sc1
  buffer_store_dwordx4 v[8:11], v7, s[16:19], s53 offen offset:2048 sc0 sc1
  s_nop 1
K1_AUX_NZ:
  v_lshlrev_b32 v13, 4, v1
  s_add_u32 s59, s2, 0
  s_mul_i32 s56, s59, 3641
  s_lshr_b32 s56, s56, 16
  s_mul_i32 s57, s56, 18
  s_sub_u32 s57, s59, s57
  s_mul_i32 s57, s57, 36864
  s_lshl_b32 s56, s56, 5
  s_add_u32 s56, s56, s57
  s_lshl_b32 s57, s59, 10
  s_add_u32 s57, s57, s58
  v_lshl_or_b32 v92, v93, 16, v92
  v_lshl_or_b32 v93, v95, 16, v94
  v_lshl_or_b32 v94, v97, 16, v96
  v_lshl_or_b32 v95, v99, 16, v98
  buffer_store_dwordx4 v[92:95], v13, s[16:19], s57 offen
  s_add_u32 s59, s2, 256
  s_mul_i32 s56, s59, 3641
  s_lshr_b32 s56, s56, 16
  s_mul_i32 s57, s56, 18
  s_sub_u32 s57, s59, s57
  s_mul_i32 s57, s57, 36864
  s_lshl_b32 s56, s56, 5
  s_add_u32 s56, s56, s57
  s_lshl_b32 s57, s59, 10
  s_add_u32 s57, s57, s58
  v_lshl_or_b32 v100, v101, 16, v100
  v_lshl_or_b32 v101, v103, 16, v102
  v_lshl_or_b32 v102, v105, 16, v104
  v_lshl_or_b32 v103, v107, 16, v106
  buffer_store_dwordx4 v[100:103], v13, s[16:19], s57 offen
  s_cmp_ge_u32 s2, 136
  s_nop 0
  s_cbranch_scc1 K1_WOS88
  s_add_u32 s59, s2, 512
  s_mul_i32 s56, s59, 3641
  s_lshr_b32 s56, s56, 16
  s_mul_i32 s57, s56, 18
  s_sub_u32 s57, s59, s57
  s_mul_i32 s57, s57, 36864
  s_lshl_b32 s56, s56, 5
  s_add_u32 s56, s56, s57
  s_lshl_b32 s57, s59, 10
  s_add_u32 s57, s57, s58
  v_lshl_or_b32 v108, v109, 16, v108
  v_lshl_or_b32 v109, v111, 16, v110
  v_lshl_or_b32 v110, v113, 16, v112
  v_lshl_or_b32 v111, v115, 16, v114
  buffer_store_dwordx4 v[108:111], v13, s[16:19], s57 offen
  s_nop 1
K1_WOS88:
  s_mov_b32 s58, 8003584
  s_add_u32 s59, s2, 0
  s_mul_i32 s56, s59, 3641
  s_lshr_b32 s56, s56, 16
  s_mul_i32 s57, s56, 18
  s_sub_u32 s57, s59, s57
  s_mul_i32 s57, s57, 36864
  s_lshl_b32 s56, s56, 5
  s_add_u32 s56, s56, s57
  s_lshl_b32 s57, s59, 10
  s_add_u32 s57, s57, s58
  buffer_load_ushort v92, v14, s[92:95], s56 offen offset:0
  buffer_load_ushort v93, v14, s[92:95], s56 offen offset:1152
  buffer_load_ushort v94, v14, s[92:95], s56 offen offset:2304
  buffer_load_ushort v95, v14, s[92:95], s56 offen offset:3456
  buffer_load_ushort v96, v15, s[92:95], s56 offen offset:0
  buffer_load_ushort v97, v15, s[92:95], s56 offen offset:1152
  buffer_load_ushort v98, v15, s[92:95], s56 offen offset:2304
  buffer_load_ushort v99, v15, s[92:95], s56 offen offset:3456
  s_add_u32 s59, s2, 256
  s_mul_i32 s56, s59, 3641
  s_lshr_b32 s56, s56, 16
  s_mul_i32 s57, s56, 18
  s_sub_u32 s57, s59, s57
  s_mul_i32 s57, s57, 36864
  s_lshl_b32 s56, s56, 5
  s_add_u32 s56, s56, s57
  s_lshl_b32 s57, s59, 10
  s_add_u32 s57, s57, s58
  buffer_load_ushort v100, v14, s[92:95], s56 offen offset:0
  buffer_load_ushort v101, v14, s[92:95], s56 offen offset:1152
  buffer_load_ushort v102, v14, s[92:95], s56 offen offset:2304
  buffer_load_ushort v103, v14, s[92:95], s56 offen offset:3456
  buffer_load_ushort v104, v15, s[92:95], s56 offen offset:0
  buffer_load_ushort v105, v15, s[92:95], s56 offen offset:1152
  buffer_load_ushort v106, v15, s[92:95], s56 offen offset:2304
  buffer_load_ushort v107, v15, s[92:95], s56 offen offset:3456
  s_cmp_ge_u32 s2, 136
  s_cbranch_scc1 K1_WOL92
  s_add_u32 s59, s2, 512
  s_mul_i32 s56, s59, 3641
  s_lshr_b32 s56, s56, 16
  s_mul_i32 s57, s56, 18
  s_sub_u32 s57, s59, s57
  s_mul_i32 s57, s57, 36864
  s_lshl_b32 s56, s56, 5
  s_add_u32 s56, s56, s57
  s_lshl_b32 s57, s59, 10
  s_add_u32 s57, s57, s58
  buffer_load_ushort v108, v14, s[92:95], s56 offen offset:0
  buffer_load_ushort v109, v14, s[92:95], s56 offen offset:1152
  buffer_load_ushort v110, v14, s[92:95], s56 offen offset:2304
  buffer_load_ushort v111, v14, s[92:95], s56 offen offset:3456
  buffer_load_ushort v112, v15, s[92:95], s56 offen offset:0
  buffer_load_ushort v113, v15, s[92:95], s56 offen offset:1152
  buffer_load_ushort v114, v15, s[92:95], s56 offen offset:2304
  buffer_load_ushort v115, v15, s[92:95], s56 offen offset:3456
K1_WOL92:
  s_barrier
  v_mov_b32 v12, 0
  v_mov_b32 v13, 0
  v_lshlrev_b32 v88, 16, v16
  v_and_b32 v89, 0xffff0000, v16
  v_lshlrev_b32 v90, 16, v52
  v_and_b32 v91, 0xffff0000, v52
  v_pk_mul_f32 v[88:89], v[88:89], v[90:91]
  v_cvt_pk_bf16_f32 v90, v88, v89
  v_lshlrev_b32 v88, 16, v90
  v_and_b32 v89, 0xffff0000, v90
  v_pk_add_f32 v[12:13], v[12:13], v[88:89]
  v_lshlrev_b32 v88, 16, v17
  v_and_b32 v89, 0xffff0000, v17
  v_lshlrev_b32 v90, 16, v53
  v_and_b32 v91, 0xffff0000, v53
  v_pk_mul_f32 v[88:89], v[88:89], v[90:91]
  v_cvt_pk_bf16_f32 v90, v88, v89
  v_lshlrev_b32 v88, 16, v90
  v_and_b32 v89, 0xffff0000, v90
  v_pk_add_f32 v[12:13], v[12:13], v[88:89]
  v_lshlrev_b32 v88, 16, v18
  v_and_b32 v89, 0xffff0000, v18
  v_lshlrev_b32 v90, 16, v54
  v_and_b32 v91, 0xffff0000, v54
  v_pk_mul_f32 v[88:89], v[88:89], v[90:91]
  v_cvt_pk_bf16_f32 v90, v88, v89
  v_lshlrev_b32 v88, 16, v90
  v_and_b32 v89, 0xffff0000, v90
  v_pk_add_f32 v[12:13], v[12:13], v[88:89]
  v_lshlrev_b32 v88, 16, v19
  v_and_b32 v89, 0xffff0000, v19
  v_lshlrev_b32 v90, 16, v55
  v_and_b32 v91, 0xffff0000, v55
  v_pk_mul_f32 v[88:89], v[88:89], v[90:91]
  v_cvt_pk_bf16_f32 v90, v88, v89
  v_lshlrev_b32 v88, 16, v90
  v_and_b32 v89, 0xffff0000, v90
  v_pk_add_f32 v[12:13], v[12:13], v[88:89]
  v_lshlrev_b32 v88, 16, v20
  v_and_b32 v89, 0xffff0000, v20
  v_lshlrev_b32 v90, 16, v56
  v_and_b32 v91, 0xffff0000, v56
  v_pk_mul_f32 v[88:89], v[88:89], v[90:91]
  v_cvt_pk_bf16_f32 v90, v88, v89
  v_lshlrev_b32 v88, 16, v90
  v_and_b32 v89, 0xffff0000, v90
  v_pk_add_f32 v[12:13], v[12:13], v[88:89]
  v_lshlrev_b32 v88, 16, v21
  v_and_b32 v89, 0xffff0000, v21
  v_lshlrev_b32 v90, 16, v57
  v_and_b32 v91, 0xffff0000, v57
  v_pk_mul_f32 v[88:89], v[88:89], v[90:91]
  v_cvt_pk_bf16_f32 v90, v88, v89
  v_lshlrev_b32 v88, 16, v90
  v_and_b32 v89, 0xffff0000, v90
  v_pk_add_f32 v[12:13], v[12:13], v[88:89]
  v_lshlrev_b32 v88, 16, v22
  v_and_b32 v89, 0xffff0000, v22
  v_lshlrev_b32 v90, 16, v58
  v_and_b32 v91, 0xffff0000, v58
  v_pk_mul_f32 v[88:89], v[88:89], v[90:91]
  v_cvt_pk_bf16_f32 v90, v88, v89
  v_lshlrev_b32 v88, 16, v90
  v_and_b32 v89, 0xffff0000, v90
  v_pk_add_f32 v[12:13], v[12:13], v[88:89]
  v_lshlrev_b32 v88, 16, v23
  v_and_b32 v89, 0xffff0000, v23
  v_lshlrev_b32 v90, 16, v59
  v_and_b32 v91, 0xffff0000, v59
  v_pk_mul_f32 v[88:89], v[88:89], v[90:91]
  v_cvt_pk_bf16_f32 v90, v88, v89
  v_lshlrev_b32 v88, 16, v90
  v_and_b32 v89, 0xffff0000, v90
  v_pk_add_f32 v[12:13], v[12:13], v[88:89]
  v_lshlrev_b32 v88, 16, v24
  v_and_b32 v89, 0xffff0000, v24
  v_lshlrev_b32 v90, 16, v60
  v_and_b32 v91, 0xffff0000, v60
  v_pk_mul_f32 v[88:89], v[88:89], v[90:91]
  v_cvt_pk_bf16_f32 v90, v88, v89
  v_lshlrev_b32 v88, 16, v90
  v_and_b32 v89, 0xffff0000, v90
  v_pk_add_f32 v[12:13], v[12:13], v[88:89]
  v_lshlrev_b32 v88, 16, v25
  v_and_b32 v89, 0xffff0000, v25
  v_lshlrev_b32 v90, 16, v61
  v_and_b32 v91, 0xffff0000, v61
  v_pk_mul_f32 v[88:89], v[88:89], v[90:91]
  v_cvt_pk_bf16_f32 v90, v88, v89
  v_lshlrev_b32 v88, 16, v90
  v_and_b32 v89, 0xffff0000, v90
  v_pk_add_f32 v[12:13], v[12:13], v[88:89]
  v_lshlrev_b32 v88, 16, v26
  v_and_b32 v89, 0xffff0000, v26
  v_lshlrev_b32 v90, 16, v62
  v_and_b32 v91, 0xffff0000, v62
  v_pk_mul_f32 v[88:89], v[88:89], v[90:91]
  v_cvt_pk_bf16_f32 v90, v88, v89
  v_lshlrev_b32 v88, 16, v90
  v_and_b32 v89, 0xffff0000, v90
  v_pk_add_f32 v[12:13], v[12:13], v[88:89]
  v_lshlrev_b32 v88, 16, v27
  v_and_b32 v89, 0xffff0000, v27
  v_lshlrev_b32 v90, 16, v63
  v_and_b32 v91, 0xffff0000, v63
  v_pk_mul_f32 v[88:89], v[88:89], v[90:91]
  v_cvt_pk_bf16_f32 v90, v88, v89
  v_lshlrev_b32 v88, 16, v90
  v_and_b32 v89, 0xffff0000, v90
  v_pk_add_f32 v[12:13], v[12:13], v[88:89]
  s_barrier
  v_lshlrev_b32 v88, 16, v28
  v_and_b32 v89, 0xffff0000, v28
  v_lshlrev_b32 v90, 16, v64
  v_and_b32 v91, 0xffff0000, v64
  v_pk_mul_f32 v[88:89], v[88:89], v[90:91]
  v_cvt_pk_bf16_f32 v90, v88, v89
  v_lshlrev_b32 v88, 16, v90
  v_and_b32 v89, 0xffff0000, v90
  v_pk_add_f32 v[12:13], v[12:13], v[88:89]
  v_lshlrev_b32 v88, 16, v29
  v_and_b32 v89, 0xffff0000, v29
  v_lshlrev_b32 v90, 16, v65
  v_and_b32 v91, 0xffff0000, v65
  v_pk_mul_f32 v[88:89], v[88:89], v[90:91]
  v_cvt_pk_bf16_f32 v90, v88, v89
  v_lshlrev_b32 v88, 16, v90
  v_and_b32 v89, 0xffff0000, v90
  v_pk_add_f32 v[12:13], v[12:13], v[88:89]
  v_lshlrev_b32 v88, 16, v30
  v_and_b32 v89, 0xffff0000, v30
  v_lshlrev_b32 v90, 16, v66
  v_and_b32 v91, 0xffff0000, v66
  v_pk_mul_f32 v[88:89], v[88:89], v[90:91]
  v_cvt_pk_bf16_f32 v90, v88, v89
  v_lshlrev_b32 v88, 16, v90
  v_and_b32 v89, 0xffff0000, v90
  v_pk_add_f32 v[12:13], v[12:13], v[88:89]
  v_lshlrev_b32 v88, 16, v31
  v_and_b32 v89, 0xffff0000, v31
  v_lshlrev_b32 v90, 16, v67
  v_and_b32 v91, 0xffff0000, v67
  v_pk_mul_f32 v[88:89], v[88:89], v[90:91]
  v_cvt_pk_bf16_f32 v90, v88, v89
  v_lshlrev_b32 v88, 16, v90
  v_and_b32 v89, 0xffff0000, v90
  v_pk_add_f32 v[12:13], v[12:13], v[88:89]
  v_lshlrev_b32 v88, 16, v32
  v_and_b32 v89, 0xffff0000, v32
  v_lshlrev_b32 v90, 16, v68
  v_and_b32 v91, 0xffff0000, v68
  v_pk_mul_f32 v[88:89], v[88:89], v[90:91]
  v_cvt_pk_bf16_f32 v90, v88, v89
  v_lshlrev_b32 v88, 16, v90
  v_and_b32 v89, 0xffff0000, v90
  v_pk_add_f32 v[12:13], v[12:13], v[88:89]
  v_lshlrev_b32 v88, 16, v33
  v_and_b32 v89, 0xffff0000, v33
  v_lshlrev_b32 v90, 16, v69
  v_and_b32 v91, 0xffff0000, v69
  v_pk_mul_f32 v[88:89], v[88:89], v[90:91]
  v_cvt_pk_bf16_f32 v90, v88, v89
  v_lshlrev_b32 v88, 16, v90
  v_and_b32 v89, 0xffff0000, v90
  v_pk_add_f32 v[12:13], v[12:13], v[88:89]
  v_lshlrev_b32 v88, 16, v34
  v_and_b32 v89, 0xffff0000, v34
  v_lshlrev_b32 v90, 16, v70
  v_and_b32 v91, 0xffff0000, v70
  v_pk_mul_f32 v[88:89], v[88:89], v[90:91]
  v_cvt_pk_bf16_f32 v90, v88, v89
  v_lshlrev_b32 v88, 16, v90
  v_and_b32 v89, 0xffff0000, v90
  v_pk_add_f32 v[12:13], v[12:13], v[88:89]
  v_lshlrev_b32 v88, 16, v35
  v_and_b32 v89, 0xffff0000, v35
  v_lshlrev_b32 v90, 16, v71
  v_and_b32 v91, 0xffff0000, v71
  v_pk_mul_f32 v[88:89], v[88:89], v[90:91]
  v_cvt_pk_bf16_f32 v90, v88, v89
  v_lshlrev_b32 v88, 16, v90
  v_and_b32 v89, 0xffff0000, v90
  v_pk_add_f32 v[12:13], v[12:13], v[88:89]
  v_lshlrev_b32 v88, 16, v36
  v_and_b32 v89, 0xffff0000, v36
  v_lshlrev_b32 v90, 16, v72
  v_and_b32 v91, 0xffff0000, v72
  v_pk_mul_f32 v[88:89], v[88:89], v[90:91]
  v_cvt_pk_bf16_f32 v90, v88, v89
  v_lshlrev_b32 v88, 16, v90
  v_and_b32 v89, 0xffff0000, v90
  v_pk_add_f32 v[12:13], v[12:13], v[88:89]
  v_lshlrev_b32 v88, 16, v37
  v_and_b32 v89, 0xffff0000, v37
  v_lshlrev_b32 v90, 16, v73
  v_and_b32 v91, 0xffff0000, v73
  v_pk_mul_f32 v[88:89], v[88:89], v[90:91]
  v_cvt_pk_bf16_f32 v90, v88, v89
  v_lshlrev_b32 v88, 16, v90
  v_and_b32 v89, 0xffff0000, v90
  v_pk_add_f32 v[12:13], v[12:13], v[88:89]
  v_lshlrev_b32 v88, 16, v38
  v_and_b32 v89, 0xffff0000, v38
  v_lshlrev_b32 v90, 16, v74
  v_and_b32 v91, 0xffff0000, v74
  v_pk_mul_f32 v[88:89], v[88:89], v[90:91]
  v_cvt_pk_bf16_f32 v90, v88, v89
  v_lshlrev_b32 v88, 16, v90
  v_and_b32 v89, 0xffff0000, v90
  v_pk_add_f32 v[12:13], v[12:13], v[88:89]
  v_lshlrev_b32 v88, 16, v39
  v_and_b32 v89, 0xffff0000, v39
  v_lshlrev_b32 v90, 16, v75
  v_and_b32 v91, 0xffff0000, v75
  v_pk_mul_f32 v[88:89], v[88:89], v[90:91]
  v_cvt_pk_bf16_f32 v90, v88, v89
  v_lshlrev_b32 v88, 16, v90
  v_and_b32 v89, 0xffff0000, v90
  v_pk_add_f32 v[12:13], v[12:13], v[88:89]
  s_barrier
  v_lshlrev_b32 v88, 16, v40
  v_and_b32 v89, 0xffff0000, v40
  v_lshlrev_b32 v90, 16, v76
  v_and_b32 v91, 0xffff0000, v76
  v_pk_mul_f32 v[88:89], v[88:89], v[90:91]
  v_cvt_pk_bf16_f32 v90, v88, v89
  v_lshlrev_b32 v88, 16, v90
  v_and_b32 v89, 0xffff0000, v90
  v_pk_add_f32 v[12:13], v[12:13], v[88:89]
  v_lshlrev_b32 v88, 16, v41
  v_and_b32 v89, 0xffff0000, v41
  v_lshlrev_b32 v90, 16, v77
  v_and_b32 v91, 0xffff0000, v77
  v_pk_mul_f32 v[88:89], v[88:89], v[90:91]
  v_cvt_pk_bf16_f32 v90, v88, v89
  v_lshlrev_b32 v88, 16, v90
  v_and_b32 v89, 0xffff0000, v90
  v_pk_add_f32 v[12:13], v[12:13], v[88:89]
  v_lshlrev_b32 v88, 16, v42
  v_and_b32 v89, 0xffff0000, v42
  v_lshlrev_b32 v90, 16, v78
  v_and_b32 v91, 0xffff0000, v78
  v_pk_mul_f32 v[88:89], v[88:89], v[90:91]
  v_cvt_pk_bf16_f32 v90, v88, v89
  v_lshlrev_b32 v88, 16, v90
  v_and_b32 v89, 0xffff0000, v90
  v_pk_add_f32 v[12:13], v[12:13], v[88:89]
  v_lshlrev_b32 v88, 16, v43
  v_and_b32 v89, 0xffff0000, v43
  v_lshlrev_b32 v90, 16, v79
  v_and_b32 v91, 0xffff0000, v79
  v_pk_mul_f32 v[88:89], v[88:89], v[90:91]
  v_cvt_pk_bf16_f32 v90, v88, v89
  v_lshlrev_b32 v88, 16, v90
  v_and_b32 v89, 0xffff0000, v90
  v_pk_add_f32 v[12:13], v[12:13], v[88:89]
  v_lshlrev_b32 v88, 16, v44
  v_and_b32 v89, 0xffff0000, v44
  v_lshlrev_b32 v90, 16, v80
  v_and_b32 v91, 0xffff0000, v80
  v_pk_mul_f32 v[88:89], v[88:89], v[90:91]
  v_cvt_pk_bf16_f32 v90, v88, v89
  v_lshlrev_b32 v88, 16, v90
  v_and_b32 v89, 0xffff0000, v90
  v_pk_add_f32 v[12:13], v[12:13], v[88:89]
  v_lshlrev_b32 v88, 16, v45
  v_and_b32 v89, 0xffff0000, v45
  v_lshlrev_b32 v90, 16, v81
  v_and_b32 v91, 0xffff0000, v81
  v_pk_mul_f32 v[88:89], v[88:89], v[90:91]
  v_cvt_pk_bf16_f32 v90, v88, v89
  v_lshlrev_b32 v88, 16, v90
  v_and_b32 v89, 0xffff0000, v90
  v_pk_add_f32 v[12:13], v[12:13], v[88:89]
  v_lshlrev_b32 v88, 16, v46
  v_and_b32 v89, 0xffff0000, v46
  v_lshlrev_b32 v90, 16, v82
  v_and_b32 v91, 0xffff0000, v82
  v_pk_mul_f32 v[88:89], v[88:89], v[90:91]
  v_cvt_pk_bf16_f32 v90, v88, v89
  v_lshlrev_b32 v88, 16, v90
  v_and_b32 v89, 0xffff0000, v90
  v_pk_add_f32 v[12:13], v[12:13], v[88:89]
  v_lshlrev_b32 v88, 16, v47
  v_and_b32 v89, 0xffff0000, v47
  v_lshlrev_b32 v90, 16, v83
  v_and_b32 v91, 0xffff0000, v83
  v_pk_mul_f32 v[88:89], v[88:89], v[90:91]
  v_cvt_pk_bf16_f32 v90, v88, v89
  v_lshlrev_b32 v88, 16, v90
  v_and_b32 v89, 0xffff0000, v90
  v_pk_add_f32 v[12:13], v[12:13], v[88:89]
  v_lshlrev_b32 v88, 16, v48
  v_and_b32 v89, 0xffff0000, v48
  v_lshlrev_b32 v90, 16, v84
  v_and_b32 v91, 0xffff0000, v84
  v_pk_mul_f32 v[88:89], v[88:89], v[90:91]
  v_cvt_pk_bf16_f32 v90, v88, v89
  v_lshlrev_b32 v88, 16, v90
  v_and_b32 v89, 0xffff0000, v90
  v_pk_add_f32 v[12:13], v[12:13], v[88:89]
  v_lshlrev_b32 v88, 16, v49
  v_and_b32 v89, 0xffff0000, v49
  v_lshlrev_b32 v90, 16, v85
  v_and_b32 v91, 0xffff0000, v85
  v_pk_mul_f32 v[88:89], v[88:89], v[90:91]
  v_cvt_pk_bf16_f32 v90, v88, v89
  v_lshlrev_b32 v88, 16, v90
  v_and_b32 v89, 0xffff0000, v90
  v_pk_add_f32 v[12:13], v[12:13], v[88:89]
  v_lshlrev_b32 v88, 16, v50
  v_and_b32 v89, 0xffff0000, v50
  v_lshlrev_b32 v90, 16, v86
  v_and_b32 v91, 0xffff0000, v86
  v_pk_mul_f32 v[88:89], v[88:89], v[90:91]
  v_cvt_pk_bf16_f32 v90, v88, v89
  v_lshlrev_b32 v88, 16, v90
  v_and_b32 v89, 0xffff0000, v90
  v_pk_add_f32 v[12:13], v[12:13], v[88:89]
  v_lshlrev_b32 v88, 16, v51
  v_and_b32 v89, 0xffff0000, v51
  v_lshlrev_b32 v90, 16, v87
  v_and_b32 v91, 0xffff0000, v87
  v_pk_mul_f32 v[88:89], v[88:89], v[90:91]
  v_cvt_pk_bf16_f32 v90, v88, v89
  v_lshlrev_b32 v88, 16, v90
  v_and_b32 v89, 0xffff0000, v90
  v_pk_add_f32 v[12:13], v[12:13], v[88:89]
  v_add_f32 v12, v12, v13
  s_nop 1
  v_add_f32_dpp v12, v12, v12 quad_perm:[1,0,3,2] row_mask:0xf bank_mask:0xf
  s_nop 1
  v_add_f32_dpp v12, v12, v12 quad_perm:[2,3,0,1] row_mask:0xf bank_mask:0xf
  s_nop 1
  v_add_f32_dpp v12, v12, v12 row_half_mirror row_mask:0xf bank_mask:0xf
  v_cvt_pk_bf16_f32 v12, v12, v12
  v_lshlrev_b32 v12, 16, v12
  v_mul_f32 v12, s84, v12
  v_exp_f32 v12, v12
  s_nop 0
  v_add_f32 v12, 1.0, v12
  v_rcp_f32 v12, v12
  s_nop 0
  v_cvt_pk_bf16_f32 v12, v12, v12
  v_lshlrev_b32 v12, 16, v12
  v_lshrrev_b32 v4, 3, v1
  v_lshlrev_b32 v4, 2, v4
  s_lshl_b32 s51, s50, 2
  s_add_u32 s51, s51, 7274496
  s_mov_b32 s52, 0x01010101
  s_mov_b32 s53, 0x01010101
  s_mov_b64 exec, s[52:53]
  buffer_store_dword v12, v4, s[16:19], s51 offen
  s_mov_b64 exec, -1
  s_barrier
  s_cmp_lg_u32 s63, 0
  s_cbranch_scc1 K1_AUX_NF
  s_waitcnt vmcnt(0)
  s_lshl_b32 s49, s45, 2
  s_add_u32 s49, s49, 64
  s_mov_b64 exec, 1
  v_mov_b32 v2, 1
  buffer_store_dword v2, off, s[20:23], s49 sc0 sc1
  s_mov_b64 exec, -1
K1_AUX_NF:
  s_waitcnt vmcnt(0)
  v_lshlrev_b32 v13, 4, v1
  s_add_u32 s59, s2, 0
  s_mul_i32 s56, s59, 3641
  s_lshr_b32 s56, s56, 16
  s_mul_i32 s57, s56, 18
  s_sub_u32 s57, s59, s57
  s_mul_i32 s57, s57, 36864
  s_lshl_b32 s56, s56, 5
  s_add_u32 s56, s56, s57
  s_lshl_b32 s57, s59, 10
  s_add_u32 s57, s57, s58
  v_lshl_or_b32 v92, v93, 16, v92
  v_lshl_or_b32 v93, v95, 16, v94
  v_lshl_or_b32 v94, v97, 16, v96
  v_lshl_or_b32 v95, v99, 16, v98
  buffer_store_dwordx4 v[92:95], v13, s[16:19], s57 offen
  s_add_u32 s59, s2, 256
  s_mul_i32 s56, s59, 3641
  s_lshr_b32 s56, s56, 16
  s_mul_i32 s57, s56, 18
  s_sub_u32 s57, s59, s57
  s_mul_i32 s57, s57, 36864
  s_lshl_b32 s56, s56, 5
  s_add_u32 s56, s56, s57
  s_lshl_b32 s57, s59, 10
  s_add_u32 s57, s57, s58
  v_lshl_or_b32 v100, v101, 16, v100
  v_lshl_or_b32 v101, v103, 16, v102
  v_lshl_or_b32 v102, v105, 16, v104
  v_lshl_or_b32 v103, v107, 16, v106
  buffer_store_dwordx4 v[100:103], v13, s[16:19], s57 offen
  s_cmp_ge_u32 s2, 136
  s_nop 0
  s_cbranch_scc1 K1_WOS92
  s_add_u32 s59, s2, 512
  s_mul_i32 s56, s59, 3641
  s_lshr_b32 s56, s56, 16
  s_mul_i32 s57, s56, 18
  s_sub_u32 s57, s59, s57
  s_mul_i32 s57, s57, 36864
  s_lshl_b32 s56, s56, 5
  s_add_u32 s56, s56, s57
  s_lshl_b32 s57, s59, 10
  s_add_u32 s57, s57, s58
  v_lshl_or_b32 v108, v109, 16, v108
  v_lshl_or_b32 v109, v111, 16, v110
  v_lshl_or_b32 v110, v113, 16, v112
  v_lshl_or_b32 v111, v115, 16, v114
  buffer_store_dwordx4 v[108:111], v13, s[16:19], s57 offen
  s_nop 1
K1_WOS92:
  s_barrier
  s_barrier
  s_barrier
  s_waitcnt vmcnt(0)
  s_branch K1_POST
K1_POST:
  s_barrier
  s_lshl_b32 s61, s45, 2
  s_add_u32 s61, s61, 64
  buffer_load_dword v62, off, s[20:23], s61 sc0 sc1
  v_mov_b32 v63, 0x3f803f80
  v_and_b32 v8, 31, v1
  v_lshrrev_b32 v9, 5, v1
  v_and_b32 v10, 15, v1
  v_lshrrev_b32 v11, 4, v1
  v_lshrrev_b32 v12, 1, v11
  v_lshlrev_b32 v12, 3, v12
  v_lshrrev_b32 v13, 2, v10
  v_add_u32 v12, v12, v13
  v_and_b32 v13, 1, v11
  v_lshlrev_b32 v13, 5, v13
  v_and_b32 v14, 3, v10
  v_lshl_add_u32 v13, v14, 3, v13
  s_and_b32 s49, s48, 3
  s_and_b32 s60, s49, 1
  s_lshl_b32 s60, s60, 1
  s_lshl_b32 s50, s47, 2
  s_add_u32 s50, s50, s49
  s_cmp_eq_u32 s46, 1
  s_cbranch_scc1 K1_POST_B
  s_cmp_ge_u32 s48, 4
  s_cbranch_scc1 K1_PA_Q
  v_mul_u32_u24 v2, 464, v1
  s_mul_i32 s51, s49, 36
  s_add_u32 s51, s51, 144
  v_add_u32 v2, s51, v2
  ds_read_b128 v[16:19], v2 offset:0
  ds_read_b128 v[20:23], v2 offset:16
  ds_read_b32 v24, v2 offset:32
  ds_read_b128 v[28:31], v2 offset:29696
  ds_read_b128 v[32:35], v2 offset:29712
  ds_read_b32 v36, v2 offset:29728
  s_waitcnt lgkmcnt(5)
  v_pk_max_i16 v44, v16, 0
  v_pk_max_i16 v50, v17, 0
  v_pk_min_i16 v45, v16, 0
  v_pk_min_i16 v51, v17, 0
  v_lshlrev_b32 v40, 16, v45
  v_lshlrev_b32 v46, 16, v51
  v_and_b32 v41, 0xffff0000, v45
  v_and_b32 v47, 0xffff0000, v51
  v_pk_mul_f32 v[40:41], v[40:41], s[70:71]
  v_pk_mul_f32 v[46:47], v[46:47], s[70:71]
  v_exp_f32 v40, v40
  v_exp_f32 v46, v46
  v_exp_f32 v41, v41
  v_exp_f32 v47, v47
  v_lshlrev_b32 v42, 16, v44
  v_lshlrev_b32 v48, 16, v50
  v_and_b32 v43, 0xffff0000, v44
  v_and_b32 v49, 0xffff0000, v50
  v_pk_add_f32 v[40:41], v[40:41], v[42:43]
  v_pk_add_f32 v[46:47], v[46:47], v[48:49]
  v_cvt_pk_bf16_f32 v44, v40, v41
  v_cvt_pk_bf16_f32 v50, v46, v47
  v_lshlrev_b32 v40, 16, v44
  v_lshlrev_b32 v46, 16, v50
  v_and_b32 v41, 0xffff0000, v44
  v_and_b32 v47, 0xffff0000, v50
  v_pk_add_f32 v[40:41], v[40:41], s[72:73]
  v_pk_add_f32 v[46:47], v[46:47], s[72:73]
  v_cvt_pk_bf16_f32 v16, v40, v41
  v_cvt_pk_bf16_f32 v17, v46, v47
  v_pk_max_i16 v44, v18, 0
  v_pk_max_i16 v50, v19, 0
  v_pk_min_i16 v45, v18, 0
  v_pk_min_i16 v51, v19, 0
  v_lshlrev_b32 v40, 16, v45
  v_lshlrev_b32 v46, 16, v51
  v_and_b32 v41, 0xffff0000, v45
  v_and_b32 v47, 0xffff0000, v51
  v_pk_mul_f32 v[40:41], v[40:41], s[70:71]
  v_pk_mul_f32 v[46:47], v[46:47], s[70:71]
  v_exp_f32 v40, v40
  v_exp_f32 v46, v46
  v_exp_f32 v41, v41
  v_exp_f32 v47, v47
  v_lshlrev_b32 v42, 16, v44
  v_lshlrev_b32 v48, 16, v50
  v_and_b32 v43, 0xffff0000, v44
  v_and_b32 v49, 0xffff0000, v50
  v_pk_add_f32 v[40:41], v[40:41], v[42:43]
  v_pk_add_f32 v[46:47], v[46:47], v[48:49]
  v_cvt_pk_bf16_f32 v44, v40, v41
  v_cvt_pk_bf16_f32 v50, v46, v47
  v_lshlrev_b32 v40, 16, v44
  v_lshlrev_b32 v46, 16, v50
  v_and_b32 v41, 0xffff0000, v44
  v_and_b32 v47, 0xffff0000, v50
  v_pk_add_f32 v[40:41], v[40:41], s[72:73]
  v_pk_add_f32 v[46:47], v[46:47], s[72:73]
  v_cvt_pk_bf16_f32 v18, v40, v41
  v_cvt_pk_bf16_f32 v19, v46, v47
  s_waitcnt lgkmcnt(4)
  v_pk_max_i16 v44, v20, 0
  v_pk_max_i16 v50, v21, 0
  v_pk_min_i16 v45, v20, 0
  v_pk_min_i16 v51, v21, 0
  v_lshlrev_b32 v40, 16, v45
  v_lshlrev_b32 v46, 16, v51
  v_and_b32 v41, 0xffff0000, v45
  v_and_b32 v47, 0xffff0000, v51
  v_pk_mul_f32 v[40:41], v[40:41], s[70:71]
  v_pk_mul_f32 v[46:47], v[46:47], s[70:71]
  v_exp_f32 v40, v40
  v_exp_f32 v46, v46
  v_exp_f32 v41, v41
  v_exp_f32 v47, v47
  v_lshlrev_b32 v42, 16, v44
  v_lshlrev_b32 v48, 16, v50
  v_and_b32 v43, 0xffff0000, v44
  v_and_b32 v49, 0xffff0000, v50
  v_pk_add_f32 v[40:41], v[40:41], v[42:43]
  v_pk_add_f32 v[46:47], v[46:47], v[48:49]
  v_cvt_pk_bf16_f32 v44, v40, v41
  v_cvt_pk_bf16_f32 v50, v46, v47
  v_lshlrev_b32 v40, 16, v44
  v_lshlrev_b32 v46, 16, v50
  v_and_b32 v41, 0xffff0000, v44
  v_and_b32 v47, 0xffff0000, v50
  v_pk_add_f32 v[40:41], v[40:41], s[72:73]
  v_pk_add_f32 v[46:47], v[46:47], s[72:73]
  v_cvt_pk_bf16_f32 v20, v40, v41
  v_cvt_pk_bf16_f32 v21, v46, v47
  v_pk_max_i16 v44, v22, 0
  v_pk_max_i16 v50, v23, 0
  v_pk_min_i16 v45, v22, 0
  v_pk_min_i16 v51, v23, 0
  v_lshlrev_b32 v40, 16, v45
  v_lshlrev_b32 v46, 16, v51
  v_and_b32 v41, 0xffff0000, v45
  v_and_b32 v47, 0xffff0000, v51
  v_pk_mul_f32 v[40:41], v[40:41], s[70:71]
  v_pk_mul_f32 v[46:47], v[46:47], s[70:71]
  v_exp_f32 v40, v40
  v_exp_f32 v46, v46
  v_exp_f32 v41, v41
  v_exp_f32 v47, v47
  v_lshlrev_b32 v42, 16, v44
  v_lshlrev_b32 v48, 16, v50
  v_and_b32 v43, 0xffff0000, v44
  v_and_b32 v49, 0xffff0000, v50
  v_pk_add_f32 v[40:41], v[40:41], v[42:43]
  v_pk_add_f32 v[46:47], v[46:47], v[48:49]
  v_cvt_pk_bf16_f32 v44, v40, v41
  v_cvt_pk_bf16_f32 v50, v46, v47
  v_lshlrev_b32 v40, 16, v44
  v_lshlrev_b32 v46, 16, v50
  v_and_b32 v41, 0xffff0000, v44
  v_and_b32 v47, 0xffff0000, v50
  v_pk_add_f32 v[40:41], v[40:41], s[72:73]
  v_pk_add_f32 v[46:47], v[46:47], s[72:73]
  v_cvt_pk_bf16_f32 v22, v40, v41
  v_cvt_pk_bf16_f32 v23, v46, v47
  s_waitcnt lgkmcnt(3)
  v_pk_max_i16 v44, v24, 0
  s_waitcnt lgkmcnt(2)
  v_pk_max_i16 v50, v28, 0
  v_pk_min_i16 v45, v24, 0
  v_pk_min_i16 v51, v28, 0
  v_lshlrev_b32 v40, 16, v45
  v_lshlrev_b32 v46, 16, v51
  v_and_b32 v41, 0xffff0000, v45
  v_and_b32 v47, 0xffff0000, v51
  v_pk_mul_f32 v[40:41], v[40:41], s[70:71]
  v_pk_mul_f32 v[46:47], v[46:47], s[70:71]
  v_exp_f32 v40, v40
  v_exp_f32 v46, v46
  v_exp_f32 v41, v41
  v_exp_f32 v47, v47
  v_lshlrev_b32 v42, 16, v44
  v_lshlrev_b32 v48, 16, v50
  v_and_b32 v43, 0xffff0000, v44
  v_and_b32 v49, 0xffff0000, v50
  v_pk_add_f32 v[40:41], v[40:41], v[42:43]
  v_pk_add_f32 v[46:47], v[46:47], v[48:49]
  v_cvt_pk_bf16_f32 v44, v40, v41
  v_cvt_pk_bf16_f32 v50, v46, v47
  v_lshlrev_b32 v40, 16, v44
  v_lshlrev_b32 v46, 16, v50
  v_and_b32 v41, 0xffff0000, v44
  v_and_b32 v47, 0xffff0000, v50
  v_pk_add_f32 v[40:41], v[40:41], s[72:73]
  v_pk_add_f32 v[46:47], v[46:47], s[72:73]
  v_cvt_pk_bf16_f32 v24, v40, v41
  v_cvt_pk_bf16_f32 v28, v46, v47
  v_pk_max_i16 v44, v29, 0
  v_pk_max_i16 v50, v30, 0
  v_pk_min_i16 v45, v29, 0
  v_pk_min_i16 v51, v30, 0
  v_lshlrev_b32 v40, 16, v45
  v_lshlrev_b32 v46, 16, v51
  v_and_b32 v41, 0xffff0000, v45
  v_and_b32 v47, 0xffff0000, v51
  v_pk_mul_f32 v[40:41], v[40:41], s[70:71]
  v_pk_mul_f32 v[46:47], v[46:47], s[70:71]
  v_exp_f32 v40, v40
  v_exp_f32 v46, v46
  v_exp_f32 v41, v41
  v_exp_f32 v47, v47
  v_lshlrev_b32 v42, 16, v44
  v_lshlrev_b32 v48, 16, v50
  v_and_b32 v43, 0xffff0000, v44
  v_and_b32 v49, 0xffff0000, v50
  v_pk_add_f32 v[40:41], v[40:41], v[42:43]
  v_pk_add_f32 v[46:47], v[46:47], v[48:49]
  v_cvt_pk_bf16_f32 v44, v40, v41
  v_cvt_pk_bf16_f32 v50, v46, v47
  v_lshlrev_b32 v40, 16, v44
  v_lshlrev_b32 v46, 16, v50
  v_and_b32 v41, 0xffff0000, v44
  v_and_b32 v47, 0xffff0000, v50
  v_pk_add_f32 v[40:41], v[40:41], s[72:73]
  v_pk_add_f32 v[46:47], v[46:47], s[72:73]
  v_cvt_pk_bf16_f32 v29, v40, v41
  v_cvt_pk_bf16_f32 v30, v46, v47
  v_pk_max_i16 v44, v31, 0
  s_waitcnt lgkmcnt(1)
  v_pk_max_i16 v50, v32, 0
  v_pk_min_i16 v45, v31, 0
  v_pk_min_i16 v51, v32, 0
  v_lshlrev_b32 v40, 16, v45
  v_lshlrev_b32 v46, 16, v51
  v_and_b32 v41, 0xffff0000, v45
  v_and_b32 v47, 0xffff0000, v51
  v_pk_mul_f32 v[40:41], v[40:41], s[70:71]
  v_pk_mul_f32 v[46:47], v[46:47], s[70:71]
  v_exp_f32 v40, v40
  v_exp_f32 v46, v46
  v_exp_f32 v41, v41
  v_exp_f32 v47, v47
  v_lshlrev_b32 v42, 16, v44
  v_lshlrev_b32 v48, 16, v50
  v_and_b32 v43, 0xffff0000, v44
  v_and_b32 v49, 0xffff0000, v50
  v_pk_add_f32 v[40:41], v[40:41], v[42:43]
  v_pk_add_f32 v[46:47], v[46:47], v[48:49]
  v_cvt_pk_bf16_f32 v44, v40, v41
  v_cvt_pk_bf16_f32 v50, v46, v47
  v_lshlrev_b32 v40, 16, v44
  v_lshlrev_b32 v46, 16, v50
  v_and_b32 v41, 0xffff0000, v44
  v_and_b32 v47, 0xffff0000, v50
  v_pk_add_f32 v[40:41], v[40:41], s[72:73]
  v_pk_add_f32 v[46:47], v[46:47], s[72:73]
  v_cvt_pk_bf16_f32 v31, v40, v41
  v_cvt_pk_bf16_f32 v32, v46, v47
  v_pk_max_i16 v44, v33, 0
  v_pk_max_i16 v50, v34, 0
  v_pk_min_i16 v45, v33, 0
  v_pk_min_i16 v51, v34, 0
  v_lshlrev_b32 v40, 16, v45
  v_lshlrev_b32 v46, 16, v51
  v_and_b32 v41, 0xffff0000, v45
  v_and_b32 v47, 0xffff0000, v51
  v_pk_mul_f32 v[40:41], v[40:41], s[70:71]
  v_pk_mul_f32 v[46:47], v[46:47], s[70:71]
  v_exp_f32 v40, v40
  v_exp_f32 v46, v46
  v_exp_f32 v41, v41
  v_exp_f32 v47, v47
  v_lshlrev_b32 v42, 16, v44
  v_lshlrev_b32 v48, 16, v50
  v_and_b32 v43, 0xffff0000, v44
  v_and_b32 v49, 0xffff0000, v50
  v_pk_add_f32 v[40:41], v[40:41], v[42:43]
  v_pk_add_f32 v[46:47], v[46:47], v[48:49]
  v_cvt_pk_bf16_f32 v44, v40, v41
  v_cvt_pk_bf16_f32 v50, v46, v47
  v_lshlrev_b32 v40, 16, v44
  v_lshlrev_b32 v46, 16, v50
  v_and_b32 v41, 0xffff0000, v44
  v_and_b32 v47, 0xffff0000, v50
  v_pk_add_f32 v[40:41], v[40:41], s[72:73]
  v_pk_add_f32 v[46:47], v[46:47], s[72:73]
  v_cvt_pk_bf16_f32 v33, v40, v41
  v_cvt_pk_bf16_f32 v34, v46, v47
  v_pk_max_i16 v44, v35, 0
  s_waitcnt lgkmcnt(0)
  v_pk_max_i16 v50, v36, 0
  v_pk_min_i16 v45, v35, 0
  v_pk_min_i16 v51, v36, 0
  v_lshlrev_b32 v40, 16, v45
  v_lshlrev_b32 v46, 16, v51
  v_and_b32 v41, 0xffff0000, v45
  v_and_b32 v47, 0xffff0000, v51
  v_pk_mul_f32 v[40:41], v[40:41], s[70:71]
  v_pk_mul_f32 v[46:47], v[46:47], s[70:71]
  v_exp_f32 v40, v40
  v_exp_f32 v46, v46
  v_exp_f32 v41, v41
  v_exp_f32 v47, v47
  v_lshlrev_b32 v42, 16, v44
  v_lshlrev_b32 v48, 16, v50
  v_and_b32 v43, 0xffff0000, v44
  v_and_b32 v49, 0xffff0000, v50
  v_pk_add_f32 v[40:41], v[40:41], v[42:43]
  v_pk_add_f32 v[46:47], v[46:47], v[48:49]
  v_cvt_pk_bf16_f32 v44, v40, v41
  v_cvt_pk_bf16_f32 v50, v46, v47
  v_lshlrev_b32 v40, 16, v44
  v_lshlrev_b32 v46, 16, v50
  v_and_b32 v41, 0xffff0000, v44
  v_and_b32 v47, 0xffff0000, v50
  v_pk_add_f32 v[40:41], v[40:41], s[72:73]
  v_pk_add_f32 v[46:47], v[46:47], s[72:73]
  v_cvt_pk_bf16_f32 v35, v40, v41
  v_cvt_pk_bf16_f32 v36, v46, v47
  ds_write_b128 v2, v[16:19] offset:0
  ds_write_b128 v2, v[20:23] offset:16
  ds_write_b32 v2, v24 offset:32
  ds_write_b128 v2, v[28:31] offset:29696
  ds_write_b128 v2, v[32:35] offset:29712
  ds_write_b32 v2, v36 offset:29728
  v_mul_u32_u24 v3, 464, v12
  v_add_u32 v3, v3, v13
  s_sub_u32 s51, s51, s60
  s_sub_u32 s51, s51, s60
  v_add_u32 v3, s51, v3
  ds_read_b64_tr_b16 v[64:65], v3 offset:144
  ds_read_b64_tr_b16 v[66:67], v3 offset:2000
  ds_read_b64_tr_b16 v[80:81], v3 offset:0
  ds_read_b64_tr_b16 v[82:83], v3 offset:1856
  ds_read_b64_tr_b16 v[68:69], v3 offset:7568
  ds_read_b64_tr_b16 v[70:71], v3 offset:9424
  ds_read_b64_tr_b16 v[84:85], v3 offset:7424
  ds_read_b64_tr_b16 v[86:87], v3 offset:9280
  s_waitcnt lgkmcnt(7)
  v_cndmask_b32 v64, v64, v63, s[74:75]
  v_cndmask_b32 v65, v65, v63, s[74:75]
  s_waitcnt lgkmcnt(6)
  v_cndmask_b32 v66, v66, v63, s[74:75]
  v_cndmask_b32 v67, v67, v63, s[74:75]
  s_waitcnt lgkmcnt(4)
  s_nop 0
  v_mfma_f32_32x32x16_bf16 v[96:111], v[64:67], v[80:83], 0
  ds_read_b64_tr_b16 v[64:65], v3 offset:14992
  ds_read_b64_tr_b16 v[66:67], v3 offset:16848
  ds_read_b64_tr_b16 v[80:81], v3 offset:14848
  ds_read_b64_tr_b16 v[82:83], v3 offset:16704
  s_waitcnt lgkmcnt(7)
  v_cndmask_b32 v68, v68, v63, s[74:75]
  v_cndmask_b32 v69, v69, v63, s[74:75]
  s_waitcnt lgkmcnt(6)
  v_cndmask_b32 v70, v70, v63, s[74:75]
  v_cndmask_b32 v71, v71, v63, s[74:75]
  s_waitcnt lgkmcnt(4)
  s_nop 0
  v_mfma_f32_32x32x16_bf16 v[96:111], v[68:71], v[84:87], v[96:111]
  ds_read_b64_tr_b16 v[68:69], v3 offset:22416
  ds_read_b64_tr_b16 v[70:71], v3 offset:24272
  ds_read_b64_tr_b16 v[84:85], v3 offset:22272
  ds_read_b64_tr_b16 v[86:87], v3 offset:24128
  s_waitcnt lgkmcnt(7)
  v_cndmask_b32 v64, v64, v63, s[74:75]
  v_cndmask_b32 v65, v65, v63, s[74:75]
  s_waitcnt lgkmcnt(6)
  v_cndmask_b32 v66, v66, v63, s[74:75]
  v_cndmask_b32 v67, v67, v63, s[74:75]
  s_waitcnt lgkmcnt(4)
  s_nop 0
  v_mfma_f32_32x32x16_bf16 v[96:111], v[64:67], v[80:83], v[96:111]
  ds_read_b64_tr_b16 v[64:65], v3 offset:29840
  ds_read_b64_tr_b16 v[66:67], v3 offset:31696
  ds_read_b64_tr_b16 v[80:81], v3 offset:29696
  ds_read_b64_tr_b16 v[82:83], v3 offset:31552
  s_waitcnt lgkmcnt(7)
  v_cndmask_b32 v68, v68, v63, s[74:75]
  v_cndmask_b32 v69, v69, v63, s[74:75]
  s_waitcnt lgkmcnt(6)
  v_cndmask_b32 v70, v70, v63, s[74:75]
  v_cndmask_b32 v71, v71, v63, s[74:75]
  s_waitcnt lgkmcnt(4)
  s_nop 0
  v_mfma_f32_32x32x16_bf16 v[96:111], v[68:71], v[84:87], v[96:111]
  ds_read_b64_tr_b16 v[68:69], v3 offset:37264
  ds_read_b64_tr_b16 v[70:71], v3 offset:39120
  ds_read_b64_tr_b16 v[84:85], v3 offset:37120
  ds_read_b64_tr_b16 v[86:87], v3 offset:38976
  s_waitcnt lgkmcnt(7)
  v_cndmask_b32 v64, v64, v63, s[74:75]
  v_cndmask_b32 v65, v65, v63, s[74:75]
  s_waitcnt lgkmcnt(6)
  v_cndmask_b32 v66, v66, v63, s[74:75]
  v_cndmask_b32 v67, v67, v63, s[74:75]
  s_waitcnt lgkmcnt(4)
  s_nop 0
  v_mfma_f32_32x32x16_bf16 v[96:111], v[64:67], v[80:83], v[96:111]
  ds_read_b64_tr_b16 v[64:65], v3 offset:44688
  ds_read_b64_tr_b16 v[66:67], v3 offset:46544
  ds_read_b64_tr_b16 v[80:81], v3 offset:44544
  ds_read_b64_tr_b16 v[82:83], v3 offset:46400
  s_waitcnt lgkmcnt(7)
  v_cndmask_b32 v68, v68, v63, s[74:75]
  v_cndmask_b32 v69, v69, v63, s[74:75]
  s_waitcnt lgkmcnt(6)
  v_cndmask_b32 v70, v70, v63, s[74:75]
  v_cndmask_b32 v71, v71, v63, s[74:75]
  s_waitcnt lgkmcnt(4)
  s_nop 0
  v_mfma_f32_32x32x16_bf16 v[96:111], v[68:71], v[84:87], v[96:111]
  ds_read_b64_tr_b16 v[68:69], v3 offset:52112
  ds_read_b64_tr_b16 v[70:71], v3 offset:53968
  ds_read_b64_tr_b16 v[84:85], v3 offset:51968
  ds_read_b64_tr_b16 v[86:87], v3 offset:53824
  s_waitcnt lgkmcnt(7)
  v_cndmask_b32 v64, v64, v63, s[74:75]
  v_cndmask_b32 v65, v65, v63, s[74:75]
  s_waitcnt lgkmcnt(6)
  v_cndmask_b32 v66, v66, v63, s[74:75]
  v_cndmask_b32 v67, v67, v63, s[74:75]
  s_waitcnt lgkmcnt(4)
  s_nop 0
  v_mfma_f32_32x32x16_bf16 v[96:111], v[64:67], v[80:83], v[96:111]
  s_waitcnt lgkmcnt(3)
  v_cndmask_b32 v68, v68, v63, s[74:75]
  v_cndmask_b32 v69, v69, v63, s[74:75]
  s_waitcnt lgkmcnt(2)
  v_cndmask_b32 v70, v70, v63, s[74:75]
  v_cndmask_b32 v71, v71, v63, s[74:75]
  s_waitcnt lgkmcnt(0)
  s_nop 0
  v_mfma_f32_32x32x16_bf16 v[96:111], v[68:71], v[84:87], v[96:111]
  v_mul_u32_u24 v4, 320, v9
  v_lshl_add_u32 v4, v8, 2, v4
  s_lshl_b32 s51, 0x3ffff, s60
  s_mov_b32 s76, s51
  s_mov_b32 s77, s51
  s_mov_b32 s78, s51
  s_mov_b32 s79, 0
  s_mov_b32 s80, 0
  s_mov_b32 s81, s51
  s_cmp_eq_u32 s60, 0
  s_cselect_b32 s82, s51, 0
  s_mov_b32 s83, s51
  s_mul_i32 s52, s50, 1536
  s_add_u32 s52, s52, 7077888
  s_lshl_b32 s53, s60, 2
  s_sub_u32 s53, s52, s53
  s_mul_i32 s54, s60, 84
  s_sub_u32 s52, s52, s54
  s_waitcnt vmcnt(0)
  v_readfirstlane_b32 s62, v62
  s_nop 4
K1_PA_POLL_LOOP:
  s_cmp_lg_u32 s62, 0
  s_cbranch_scc1 K1_PA_POLL_OK
  buffer_load_dword v62, off, s[20:23], s61 sc0 sc1
  s_waitcnt vmcnt(0)
  v_readfirstlane_b32 s62, v62
  s_nop 4
  s_branch K1_PA_POLL_LOOP
K1_PA_POLL_OK:
  s_mov_b64 exec, s[82:83]
  buffer_atomic_add_f32 v96, v4, s[16:19], s52 offen offset:0
  buffer_atomic_add_f32 v97, v4, s[16:19], s52 offen offset:80
  s_mov_b64 exec, s[76:77]
  buffer_atomic_add_f32 v98, v4, s[16:19], s52 offen offset:160
  buffer_atomic_add_f32 v99, v4, s[16:19], s52 offen offset:240
  buffer_atomic_add_f32 v100, v4, s[16:19], s52 offen offset:640
  buffer_atomic_add_f32 v101, v4, s[16:19], s52 offen offset:720
  buffer_atomic_add_f32 v102, v4, s[16:19], s52 offen offset:800
  buffer_atomic_add_f32 v103, v4, s[16:19], s52 offen offset:880
  s_mov_b64 exec, s[78:79]
  buffer_atomic_add_f32 v104, v4, s[16:19], s52 offen offset:1280
  buffer_atomic_add_f32 v105, v4, s[16:19], s52 offen offset:1360
  s_cmp_eq_u32 s60, 0
  s_cbranch_scc1 K1_PA_AT
  buffer_atomic_add_f32 v106, v4, s[16:19], s52 offen offset:1440
  buffer_atomic_add_f32 v107, v4, s[16:19], s52 offen offset:1520
K1_PA_AT:
  s_mov_b64 exec, s[80:81]
  buffer_atomic_add_f32 v110, v4, s[16:19], s53 offen offset:1120
  s_mov_b64 exec, -1
  s_waitcnt vmcnt(0)
  s_branch K1_END
K1_PA_Q:
  s_sub_u32 s51, s48, 4
  s_lshl_b32 s52, s51, 5
  v_add_u32 v2, s52, v8
  v_mul_u32_u24 v2, 464, v2
  v_lshl_add_u32 v3, v9, 4, v2
  v_mul_u32_u24 v4, 72, v9
  v_add_u32 v4, v4, v2
  ds_read_b128 v[16:19], v3 offset:0
  ds_read_b128 v[20:23], v3 offset:36
  ds_read_b128 v[24:27], v3 offset:72
  ds_read_b128 v[28:31], v3 offset:108
  ds_read_b32 v32, v4 offset:32
  ds_read_b32 v33, v4 offset:68
  s_waitcnt lgkmcnt(5)
  v_pk_max_i16 v44, v16, 0
  v_pk_max_i16 v50, v17, 0
  v_pk_min_i16 v45, v16, 0
  v_pk_min_i16 v51, v17, 0
  v_lshlrev_b32 v40, 16, v45
  v_lshlrev_b32 v46, 16, v51
  v_and_b32 v41, 0xffff0000, v45
  v_and_b32 v47, 0xffff0000, v51
  v_pk_mul_f32 v[40:41], v[40:41], s[70:71]
  v_pk_mul_f32 v[46:47], v[46:47], s[70:71]
  v_exp_f32 v40, v40
  v_exp_f32 v46, v46
  v_exp_f32 v41, v41
  v_exp_f32 v47, v47
  v_lshlrev_b32 v42, 16, v44
  v_lshlrev_b32 v48, 16, v50
  v_and_b32 v43, 0xffff0000, v44
  v_and_b32 v49, 0xffff0000, v50
  v_pk_add_f32 v[40:41], v[40:41], v[42:43]
  v_pk_add_f32 v[46:47], v[46:47], v[48:49]
  v_cvt_pk_bf16_f32 v44, v40, v41
  v_cvt_pk_bf16_f32 v50, v46, v47
  v_lshlrev_b32 v40, 16, v44
  v_lshlrev_b32 v46, 16, v50
  v_and_b32 v41, 0xffff0000, v44
  v_and_b32 v47, 0xffff0000, v50
  v_pk_add_f32 v[40:41], v[40:41], s[72:73]
  v_pk_add_f32 v[46:47], v[46:47], s[72:73]
  v_cvt_pk_bf16_f32 v16, v40, v41
  v_cvt_pk_bf16_f32 v17, v46, v47
  v_pk_max_i16 v44, v18, 0
  v_pk_max_i16 v50, v19, 0
  v_pk_min_i16 v45, v18, 0
  v_pk_min_i16 v51, v19, 0
  v_lshlrev_b32 v40, 16, v45
  v_lshlrev_b32 v46, 16, v51
  v_and_b32 v41, 0xffff0000, v45
  v_and_b32 v47, 0xffff0000, v51
  v_pk_mul_f32 v[40:41], v[40:41], s[70:71]
  v_pk_mul_f32 v[46:47], v[46:47], s[70:71]
  v_exp_f32 v40, v40
  v_exp_f32 v46, v46
  v_exp_f32 v41, v41
  v_exp_f32 v47, v47
  v_lshlrev_b32 v42, 16, v44
  v_lshlrev_b32 v48, 16, v50
  v_and_b32 v43, 0xffff0000, v44
  v_and_b32 v49, 0xffff0000, v50
  v_pk_add_f32 v[40:41], v[40:41], v[42:43]
  v_pk_add_f32 v[46:47], v[46:47], v[48:49]
  v_cvt_pk_bf16_f32 v44, v40, v41
  v_cvt_pk_bf16_f32 v50, v46, v47
  v_lshlrev_b32 v40, 16, v44
  v_lshlrev_b32 v46, 16, v50
  v_and_b32 v41, 0xffff0000, v44
  v_and_b32 v47, 0xffff0000, v50
  v_pk_add_f32 v[40:41], v[40:41], s[72:73]
  v_pk_add_f32 v[46:47], v[46:47], s[72:73]
  v_cvt_pk_bf16_f32 v18, v40, v41
  v_cvt_pk_bf16_f32 v19, v46, v47
  s_waitcnt lgkmcnt(4)
  v_pk_max_i16 v44, v20, 0
  v_pk_max_i16 v50, v21, 0
  v_pk_min_i16 v45, v20, 0
  v_pk_min_i16 v51, v21, 0
  v_lshlrev_b32 v40, 16, v45
  v_lshlrev_b32 v46, 16, v51
  v_and_b32 v41, 0xffff0000, v45
  v_and_b32 v47, 0xffff0000, v51
  v_pk_mul_f32 v[40:41], v[40:41], s[70:71]
  v_pk_mul_f32 v[46:47], v[46:47], s[70:71]
  v_exp_f32 v40, v40
  v_exp_f32 v46, v46
  v_exp_f32 v41, v41
  v_exp_f32 v47, v47
  v_lshlrev_b32 v42, 16, v44
  v_lshlrev_b32 v48, 16, v50
  v_and_b32 v43, 0xffff0000, v44
  v_and_b32 v49, 0xffff0000, v50
  v_pk_add_f32 v[40:41], v[40:41], v[42:43]
  v_pk_add_f32 v[46:47], v[46:47], v[48:49]
  v_cvt_pk_bf16_f32 v44, v40, v41
  v_cvt_pk_bf16_f32 v50, v46, v47
  v_lshlrev_b32 v40, 16, v44
  v_lshlrev_b32 v46, 16, v50
  v_and_b32 v41, 0xffff0000, v44
  v_and_b32 v47, 0xffff0000, v50
  v_pk_add_f32 v[40:41], v[40:41], s[72:73]
  v_pk_add_f32 v[46:47], v[46:47], s[72:73]
  v_cvt_pk_bf16_f32 v20, v40, v41
  v_cvt_pk_bf16_f32 v21, v46, v47
  v_pk_max_i16 v44, v22, 0
  v_pk_max_i16 v50, v23, 0
  v_pk_min_i16 v45, v22, 0
  v_pk_min_i16 v51, v23, 0
  v_lshlrev_b32 v40, 16, v45
  v_lshlrev_b32 v46, 16, v51
  v_and_b32 v41, 0xffff0000, v45
  v_and_b32 v47, 0xffff0000, v51
  v_pk_mul_f32 v[40:41], v[40:41], s[70:71]
  v_pk_mul_f32 v[46:47], v[46:47], s[70:71]
  v_exp_f32 v40, v40
  v_exp_f32 v46, v46
  v_exp_f32 v41, v41
  v_exp_f32 v47, v47
  v_lshlrev_b32 v42, 16, v44
  v_lshlrev_b32 v48, 16, v50
  v_and_b32 v43, 0xffff0000, v44
  v_and_b32 v49, 0xffff0000, v50
  v_pk_add_f32 v[40:41], v[40:41], v[42:43]
  v_pk_add_f32 v[46:47], v[46:47], v[48:49]
  v_cvt_pk_bf16_f32 v44, v40, v41
  v_cvt_pk_bf16_f32 v50, v46, v47
  v_lshlrev_b32 v40, 16, v44
  v_lshlrev_b32 v46, 16, v50
  v_and_b32 v41, 0xffff0000, v44
  v_and_b32 v47, 0xffff0000, v50
  v_pk_add_f32 v[40:41], v[40:41], s[72:73]
  v_pk_add_f32 v[46:47], v[46:47], s[72:73]
  v_cvt_pk_bf16_f32 v22, v40, v41
  v_cvt_pk_bf16_f32 v23, v46, v47
  s_waitcnt lgkmcnt(3)
  v_pk_max_i16 v44, v24, 0
  v_pk_max_i16 v50, v25, 0
  v_pk_min_i16 v45, v24, 0
  v_pk_min_i16 v51, v25, 0
  v_lshlrev_b32 v40, 16, v45
  v_lshlrev_b32 v46, 16, v51
  v_and_b32 v41, 0xffff0000, v45
  v_and_b32 v47, 0xffff0000, v51
  v_pk_mul_f32 v[40:41], v[40:41], s[70:71]
  v_pk_mul_f32 v[46:47], v[46:47], s[70:71]
  v_exp_f32 v40, v40
  v_exp_f32 v46, v46
  v_exp_f32 v41, v41
  v_exp_f32 v47, v47
  v_lshlrev_b32 v42, 16, v44
  v_lshlrev_b32 v48, 16, v50
  v_and_b32 v43, 0xffff0000, v44
  v_and_b32 v49, 0xffff0000, v50
  v_pk_add_f32 v[40:41], v[40:41], v[42:43]
  v_pk_add_f32 v[46:47], v[46:47], v[48:49]
  v_cvt_pk_bf16_f32 v44, v40, v41
  v_cvt_pk_bf16_f32 v50, v46, v47
  v_lshlrev_b32 v40, 16, v44
  v_lshlrev_b32 v46, 16, v50
  v_and_b32 v41, 0xffff0000, v44
  v_and_b32 v47, 0xffff0000, v50
  v_pk_add_f32 v[40:41], v[40:41], s[72:73]
  v_pk_add_f32 v[46:47], v[46:47], s[72:73]
  v_cvt_pk_bf16_f32 v24, v40, v41
  v_cvt_pk_bf16_f32 v25, v46, v47
  v_pk_max_i16 v44, v26, 0
  v_pk_max_i16 v50, v27, 0
  v_pk_min_i16 v45, v26, 0
  v_pk_min_i16 v51, v27, 0
  v_lshlrev_b32 v40, 16, v45
  v_lshlrev_b32 v46, 16, v51
  v_and_b32 v41, 0xffff0000, v45
  v_and_b32 v47, 0xffff0000, v51
  v_pk_mul_f32 v[40:41], v[40:41], s[70:71]
  v_pk_mul_f32 v[46:47], v[46:47], s[70:71]
  v_exp_f32 v40, v40
  v_exp_f32 v46, v46
  v_exp_f32 v41, v41
  v_exp_f32 v47, v47
  v_lshlrev_b32 v42, 16, v44
  v_lshlrev_b32 v48, 16, v50
  v_and_b32 v43, 0xffff0000, v44
  v_and_b32 v49, 0xffff0000, v50
  v_pk_add_f32 v[40:41], v[40:41], v[42:43]
  v_pk_add_f32 v[46:47], v[46:47], v[48:49]
  v_cvt_pk_bf16_f32 v44, v40, v41
  v_cvt_pk_bf16_f32 v50, v46, v47
  v_lshlrev_b32 v40, 16, v44
  v_lshlrev_b32 v46, 16, v50
  v_and_b32 v41, 0xffff0000, v44
  v_and_b32 v47, 0xffff0000, v50
  v_pk_add_f32 v[40:41], v[40:41], s[72:73]
  v_pk_add_f32 v[46:47], v[46:47], s[72:73]
  v_cvt_pk_bf16_f32 v26, v40, v41
  v_cvt_pk_bf16_f32 v27, v46, v47
  s_waitcnt lgkmcnt(2)
  v_pk_max_i16 v44, v28, 0
  v_pk_max_i16 v50, v29, 0
  v_pk_min_i16 v45, v28, 0
  v_pk_min_i16 v51, v29, 0
  v_lshlrev_b32 v40, 16, v45
  v_lshlrev_b32 v46, 16, v51
  v_and_b32 v41, 0xffff0000, v45
  v_and_b32 v47, 0xffff0000, v51
  v_pk_mul_f32 v[40:41], v[40:41], s[70:71]
  v_pk_mul_f32 v[46:47], v[46:47], s[70:71]
  v_exp_f32 v40, v40
  v_exp_f32 v46, v46
  v_exp_f32 v41, v41
  v_exp_f32 v47, v47
  v_lshlrev_b32 v42, 16, v44
  v_lshlrev_b32 v48, 16, v50
  v_and_b32 v43, 0xffff0000, v44
  v_and_b32 v49, 0xffff0000, v50
  v_pk_add_f32 v[40:41], v[40:41], v[42:43]
  v_pk_add_f32 v[46:47], v[46:47], v[48:49]
  v_cvt_pk_bf16_f32 v44, v40, v41
  v_cvt_pk_bf16_f32 v50, v46, v47
  v_lshlrev_b32 v40, 16, v44
  v_lshlrev_b32 v46, 16, v50
  v_and_b32 v41, 0xffff0000, v44
  v_and_b32 v47, 0xffff0000, v50
  v_pk_add_f32 v[40:41], v[40:41], s[72:73]
  v_pk_add_f32 v[46:47], v[46:47], s[72:73]
  v_cvt_pk_bf16_f32 v28, v40, v41
  v_cvt_pk_bf16_f32 v29, v46, v47
  v_pk_max_i16 v44, v30, 0
  v_pk_max_i16 v50, v31, 0
  v_pk_min_i16 v45, v30, 0
  v_pk_min_i16 v51, v31, 0
  v_lshlrev_b32 v40, 16, v45
  v_lshlrev_b32 v46, 16, v51
  v_and_b32 v41, 0xffff0000, v45
  v_and_b32 v47, 0xffff0000, v51
  v_pk_mul_f32 v[40:41], v[40:41], s[70:71]
  v_pk_mul_f32 v[46:47], v[46:47], s[70:71]
  v_exp_f32 v40, v40
  v_exp_f32 v46, v46
  v_exp_f32 v41, v41
  v_exp_f32 v47, v47
  v_lshlrev_b32 v42, 16, v44
  v_lshlrev_b32 v48, 16, v50
  v_and_b32 v43, 0xffff0000, v44
  v_and_b32 v49, 0xffff0000, v50
  v_pk_add_f32 v[40:41], v[40:41], v[42:43]
  v_pk_add_f32 v[46:47], v[46:47], v[48:49]
  v_cvt_pk_bf16_f32 v44, v40, v41
  v_cvt_pk_bf16_f32 v50, v46, v47
  v_lshlrev_b32 v40, 16, v44
  v_lshlrev_b32 v46, 16, v50
  v_and_b32 v41, 0xffff0000, v44
  v_and_b32 v47, 0xffff0000, v50
  v_pk_add_f32 v[40:41], v[40:41], s[72:73]
  v_pk_add_f32 v[46:47], v[46:47], s[72:73]
  v_cvt_pk_bf16_f32 v30, v40, v41
  v_cvt_pk_bf16_f32 v31, v46, v47
  s_waitcnt lgkmcnt(1)
  v_pk_max_i16 v44, v32, 0
  s_waitcnt lgkmcnt(0)
  v_pk_max_i16 v50, v33, 0
  v_pk_min_i16 v45, v32, 0
  v_pk_min_i16 v51, v33, 0
  v_lshlrev_b32 v40, 16, v45
  v_lshlrev_b32 v46, 16, v51
  v_and_b32 v41, 0xffff0000, v45
  v_and_b32 v47, 0xffff0000, v51
  v_pk_mul_f32 v[40:41], v[40:41], s[70:71]
  v_pk_mul_f32 v[46:47], v[46:47], s[70:71]
  v_exp_f32 v40, v40
  v_exp_f32 v46, v46
  v_exp_f32 v41, v41
  v_exp_f32 v47, v47
  v_lshlrev_b32 v42, 16, v44
  v_lshlrev_b32 v48, 16, v50
  v_and_b32 v43, 0xffff0000, v44
  v_and_b32 v49, 0xffff0000, v50
  v_pk_add_f32 v[40:41], v[40:41], v[42:43]
  v_pk_add_f32 v[46:47], v[46:47], v[48:49]
  v_cvt_pk_bf16_f32 v44, v40, v41
  v_cvt_pk_bf16_f32 v50, v46, v47
  v_lshlrev_b32 v40, 16, v44
  v_lshlrev_b32 v46, 16, v50
  v_and_b32 v41, 0xffff0000, v44
  v_and_b32 v47, 0xffff0000, v50
  v_pk_add_f32 v[40:41], v[40:41], s[72:73]
  v_pk_add_f32 v[46:47], v[46:47], s[72:73]
  v_cvt_pk_bf16_f32 v32, v40, v41
  v_cvt_pk_bf16_f32 v33, v46, v47
  s_lshl_b32 s52, s44, 2
  s_add_u32 s52, s52, s51
  s_lshl_b32 s53, s52, 5
  s_lshl_b32 s54, s47, 2
  s_add_u32 s53, s53, s54
  s_lshl_b32 s53, s53, 10
  s_add_u32 s53, s53, 0
  v_lshlrev_b32 v5, 4, v1
  buffer_store_dwordx4 v[16:19], v5, s[16:19], s53 offen offset:0
  buffer_store_dwordx4 v[20:23], v5, s[16:19], s53 offen offset:1024
  buffer_store_dwordx4 v[24:27], v5, s[16:19], s53 offen offset:2048
  buffer_store_dwordx4 v[28:31], v5, s[16:19], s53 offen offset:3072
  s_lshl_b32 s52, s52, 2
  s_lshr_b32 s54, s47, 1
  s_add_u32 s52, s52, s54
  s_lshl_b32 s52, s52, 10
  s_and_b32 s54, s47, 1
  s_lshl_b32 s54, s54, 9
  s_add_u32 s52, s52, s54
  s_add_u32 s52, s52, 2097152
  v_lshlrev_b32 v6, 4, v8
  v_lshl_add_u32 v6, v9, 3, v6
  buffer_store_dwordx2 v[32:33], v6, s[16:19], s52 offen
  s_waitcnt vmcnt(0)
  s_branch K1_END
K1_POST_B:
  v_lshl_or_b32 v226, v234, 16, v226
  v_lshl_or_b32 v227, v235, 16, v227
  v_lshl_or_b32 v228, v236, 16, v228
  v_lshl_or_b32 v229, v237, 16, v229
  v_lshl_or_b32 v230, v238, 16, v230
  s_lshr_b32 s51, s48, 2
  s_lshl_b32 s52, s51, 6
  v_add_u32 v2, s52, v8
  v_mul_u32_u24 v5, 400, v2
  v_mul_u32_u24 v2, 464, v2
  s_mul_i32 s52, s49, 36
  v_lshl_add_u32 v2, v9, 4, v2
  v_add_u32 v2, s52, v2
  s_mul_i32 s52, s49, 80
  s_add_u32 s52, s52, 59392
  v_lshl_add_u32 v5, v9, 4, v5
  v_add_u32 v5, s52, v5
  ds_read_b128 v[64:67], v2 offset:144
  ds_read_b128 v[68:71], v2 offset:176
  s_waitcnt lgkmcnt(1)
  v_mfma_f32_32x32x16_bf16 v[96:111], v[226:229], v[64:67], 0
  s_waitcnt lgkmcnt(0)
  v_mfma_f32_32x32x16_bf16 v[96:111], v[230:233], v[68:71], v[96:111]
  s_nop 11
  v_cvt_pk_bf16_f32 v50, v96, v97
  v_cvt_pk_bf16_f32 v51, v98, v99
  v_cvt_pk_bf16_f32 v52, v100, v101
  v_cvt_pk_bf16_f32 v53, v102, v103
  v_cvt_pk_bf16_f32 v54, v104, v105
  v_lshlrev_b32 v96, 16, v50
  v_and_b32 v97, 0xffff0000, v50
  v_lshlrev_b32 v98, 16, v51
  v_and_b32 v99, 0xffff0000, v51
  v_lshlrev_b32 v100, 16, v52
  v_and_b32 v101, 0xffff0000, v52
  v_lshlrev_b32 v102, 16, v53
  v_and_b32 v103, 0xffff0000, v53
  v_lshlrev_b32 v104, 16, v54
  v_and_b32 v105, 0xffff0000, v54
  v_max3_f32 v56, v96, v97, v98
  v_min3_f32 v57, v96, v97, v98
  v_max3_f32 v56, v56, v99, v100
  v_min3_f32 v57, v57, v99, v100
  v_max3_f32 v56, v56, v101, v102
  v_min3_f32 v57, v57, v101, v102
  v_max_f32 v56, v56, v103
  v_min_f32 v57, v57, v103
  s_mov_b64 exec, s[86:87]
  v_max3_f32 v56, v56, v104, v105
  v_min3_f32 v57, v57, v104, v105
  s_mov_b64 exec, -1
  v_mov_b32 v58, v56
  v_mov_b32 v59, v57
  s_nop 0
  v_permlane32_swap_b32 v56, v58
  v_permlane32_swap_b32 v57, v59
  v_max_f32 v56, v56, v58
  v_min_f32 v57, v57, v59
  v_mul_f32 v88, s84, v56
  v_mul_f32 v90, s70, v57
  v_mov_b32 v89, v88
  v_mov_b32 v91, v90
  v_pk_fma_f32 v[16:17], v[96:97], s[70:71], v[88:89]
  v_pk_fma_f32 v[28:29], v[96:97], s[84:85], v[90:91]
  v_pk_fma_f32 v[18:19], v[98:99], s[70:71], v[88:89]
  v_pk_fma_f32 v[30:31], v[98:99], s[84:85], v[90:91]
  v_pk_fma_f32 v[20:21], v[100:101], s[70:71], v[88:89]
  v_pk_fma_f32 v[32:33], v[100:101], s[84:85], v[90:91]
  v_pk_fma_f32 v[22:23], v[102:103], s[70:71], v[88:89]
  v_pk_fma_f32 v[34:35], v[102:103], s[84:85], v[90:91]
  v_pk_fma_f32 v[24:25], v[104:105], s[70:71], v[88:89]
  v_pk_fma_f32 v[36:37], v[104:105], s[84:85], v[90:91]
  v_exp_f32 v16, v16
  v_exp_f32 v28, v28
  v_exp_f32 v17, v17
  v_exp_f32 v29, v29
  v_exp_f32 v18, v18
  v_exp_f32 v30, v30
  v_exp_f32 v19, v19
  v_exp_f32 v31, v31
  v_exp_f32 v20, v20
  v_exp_f32 v32, v32
  v_exp_f32 v21, v21
  v_exp_f32 v33, v33
  v_exp_f32 v22, v22
  v_exp_f32 v34, v34
  v_exp_f32 v23, v23
  v_exp_f32 v35, v35
  v_exp_f32 v24, v24
  v_exp_f32 v36, v36
  v_exp_f32 v25, v25
  v_exp_f32 v37, v37
  v_pk_add_f32 v[52:53], v[16:17], v[18:19]
  v_pk_add_f32 v[56:57], v[28:29], v[30:31]
  v_pk_add_f32 v[54:55], v[20:21], v[22:23]
  v_pk_add_f32 v[58:59], v[32:33], v[34:35]
  v_pk_add_f32 v[52:53], v[52:53], v[54:55]
  v_pk_add_f32 v[56:57], v[56:57], v[58:59]
  v_add_f32 v52, v52, v53
  v_add_f32 v56, v56, v57
  s_mov_b64 exec, s[86:87]
  v_add_f32 v52, v52, v24
  v_add_f32 v56, v56, v36
  v_add_f32 v52, v52, v25
  v_add_f32 v56, v56, v37
  s_mov_b64 exec, -1
  v_mov_b32 v53, v52
  v_mov_b32 v57, v56
  s_nop 0
  v_permlane32_swap_b32 v52, v53
  v_permlane32_swap_b32 v56, v57
  v_add_f32 v52, v52, v53
  v_add_f32 v56, v56, v57
  v_rcp_f32 v52, v52
  v_rcp_f32 v56, v56
  v_mov_b32 v53, v52
  v_mov_b32 v57, v56
  v_pk_mul_f32 v[16:17], v[16:17], v[52:53]
  v_pk_mul_f32 v[28:29], v[28:29], v[56:57]
  v_pk_mul_f32 v[18:19], v[18:19], v[52:53]
  v_pk_mul_f32 v[30:31], v[30:31], v[56:57]
  v_pk_mul_f32 v[20:21], v[20:21], v[52:53]
  v_pk_mul_f32 v[32:33], v[32:33], v[56:57]
  v_pk_mul_f32 v[22:23], v[22:23], v[52:53]
  v_pk_mul_f32 v[34:35], v[34:35], v[56:57]
  v_pk_mul_f32 v[24:25], v[24:25], v[52:53]
  v_pk_mul_f32 v[36:37], v[36:37], v[56:57]
  v_cvt_pk_bf16_f32 v40, v16, v17
  v_cvt_pk_bf16_f32 v46, v28, v29
  v_cvt_pk_bf16_f32 v41, v18, v19
  v_cvt_pk_bf16_f32 v47, v30, v31
  v_cvt_pk_bf16_f32 v42, v20, v21
  v_cvt_pk_bf16_f32 v48, v32, v33
  v_cvt_pk_bf16_f32 v43, v22, v23
  v_cvt_pk_bf16_f32 v49, v34, v35
  v_cvt_pk_bf16_f32 v44, v24, v25
  v_cvt_pk_bf16_f32 v45, v36, v37
  ds_write_b128 v5, v[40:43] offset:0
  ds_write_b128 v5, v[46:49] offset:32
  s_mov_b64 exec, s[86:87]
  ds_write_b64 v5, v[44:45] offset:64
  s_mov_b64 exec, -1
  ds_read_b128 v[64:67], v2 offset:14992
  ds_read_b128 v[68:71], v2 offset:15024
  s_waitcnt lgkmcnt(1)
  v_mfma_f32_32x32x16_bf16 v[96:111], v[226:229], v[64:67], 0
  s_waitcnt lgkmcnt(0)
  v_mfma_f32_32x32x16_bf16 v[96:111], v[230:233], v[68:71], v[96:111]
  s_nop 11
  v_cvt_pk_bf16_f32 v50, v96, v97
  v_cvt_pk_bf16_f32 v51, v98, v99
  v_cvt_pk_bf16_f32 v52, v100, v101
  v_cvt_pk_bf16_f32 v53, v102, v103
  v_cvt_pk_bf16_f32 v54, v104, v105
  v_lshlrev_b32 v96, 16, v50
  v_and_b32 v97, 0xffff0000, v50
  v_lshlrev_b32 v98, 16, v51
  v_and_b32 v99, 0xffff0000, v51
  v_lshlrev_b32 v100, 16, v52
  v_and_b32 v101, 0xffff0000, v52
  v_lshlrev_b32 v102, 16, v53
  v_and_b32 v103, 0xffff0000, v53
  v_lshlrev_b32 v104, 16, v54
  v_and_b32 v105, 0xffff0000, v54
  v_max3_f32 v56, v96, v97, v98
  v_min3_f32 v57, v96, v97, v98
  v_max3_f32 v56, v56, v99, v100
  v_min3_f32 v57, v57, v99, v100
  v_max3_f32 v56, v56, v101, v102
  v_min3_f32 v57, v57, v101, v102
  v_max_f32 v56, v56, v103
  v_min_f32 v57, v57, v103
  s_mov_b64 exec, s[86:87]
  v_max3_f32 v56, v56, v104, v105
  v_min3_f32 v57, v57, v104, v105
  s_mov_b64 exec, -1
  v_mov_b32 v58, v56
  v_mov_b32 v59, v57
  s_nop 0
  v_permlane32_swap_b32 v56, v58
  v_permlane32_swap_b32 v57, v59
  v_max_f32 v56, v56, v58
  v_min_f32 v57, v57, v59
  v_mul_f32 v88, s84, v56
  v_mul_f32 v90, s70, v57
  v_mov_b32 v89, v88
  v_mov_b32 v91, v90
  v_pk_fma_f32 v[16:17], v[96:97], s[70:71], v[88:89]
  v_pk_fma_f32 v[28:29], v[96:97], s[84:85], v[90:91]
  v_pk_fma_f32 v[18:19], v[98:99], s[70:71], v[88:89]
  v_pk_fma_f32 v[30:31], v[98:99], s[84:85], v[90:91]
  v_pk_fma_f32 v[20:21], v[100:101], s[70:71], v[88:89]
  v_pk_fma_f32 v[32:33], v[100:101], s[84:85], v[90:91]
  v_pk_fma_f32 v[22:23], v[102:103], s[70:71], v[88:89]
  v_pk_fma_f32 v[34:35], v[102:103], s[84:85], v[90:91]
  v_pk_fma_f32 v[24:25], v[104:105], s[70:71], v[88:89]
  v_pk_fma_f32 v[36:37], v[104:105], s[84:85], v[90:91]
  v_exp_f32 v16, v16
  v_exp_f32 v28, v28
  v_exp_f32 v17, v17
  v_exp_f32 v29, v29
  v_exp_f32 v18, v18
  v_exp_f32 v30, v30
  v_exp_f32 v19, v19
  v_exp_f32 v31, v31
  v_exp_f32 v20, v20
  v_exp_f32 v32, v32
  v_exp_f32 v21, v21
  v_exp_f32 v33, v33
  v_exp_f32 v22, v22
  v_exp_f32 v34, v34
  v_exp_f32 v23, v23
  v_exp_f32 v35, v35
  v_exp_f32 v24, v24
  v_exp_f32 v36, v36
  v_exp_f32 v25, v25
  v_exp_f32 v37, v37
  v_pk_add_f32 v[52:53], v[16:17], v[18:19]
  v_pk_add_f32 v[56:57], v[28:29], v[30:31]
  v_pk_add_f32 v[54:55], v[20:21], v[22:23]
  v_pk_add_f32 v[58:59], v[32:33], v[34:35]
  v_pk_add_f32 v[52:53], v[52:53], v[54:55]
  v_pk_add_f32 v[56:57], v[56:57], v[58:59]
  v_add_f32 v52, v52, v53
  v_add_f32 v56, v56, v57
  s_mov_b64 exec, s[86:87]
  v_add_f32 v52, v52, v24
  v_add_f32 v56, v56, v36
  v_add_f32 v52, v52, v25
  v_add_f32 v56, v56, v37
  s_mov_b64 exec, -1
  v_mov_b32 v53, v52
  v_mov_b32 v57, v56
  s_nop 0
  v_permlane32_swap_b32 v52, v53
  v_permlane32_swap_b32 v56, v57
  v_add_f32 v52, v52, v53
  v_add_f32 v56, v56, v57
  v_rcp_f32 v52, v52
  v_rcp_f32 v56, v56
  v_mov_b32 v53, v52
  v_mov_b32 v57, v56
  v_pk_mul_f32 v[16:17], v[16:17], v[52:53]
  v_pk_mul_f32 v[28:29], v[28:29], v[56:57]
  v_pk_mul_f32 v[18:19], v[18:19], v[52:53]
  v_pk_mul_f32 v[30:31], v[30:31], v[56:57]
  v_pk_mul_f32 v[20:21], v[20:21], v[52:53]
  v_pk_mul_f32 v[32:33], v[32:33], v[56:57]
  v_pk_mul_f32 v[22:23], v[22:23], v[52:53]
  v_pk_mul_f32 v[34:35], v[34:35], v[56:57]
  v_pk_mul_f32 v[24:25], v[24:25], v[52:53]
  v_pk_mul_f32 v[36:37], v[36:37], v[56:57]
  v_cvt_pk_bf16_f32 v40, v16, v17
  v_cvt_pk_bf16_f32 v46, v28, v29
  v_cvt_pk_bf16_f32 v41, v18, v19
  v_cvt_pk_bf16_f32 v47, v30, v31
  v_cvt_pk_bf16_f32 v42, v20, v21
  v_cvt_pk_bf16_f32 v48, v32, v33
  v_cvt_pk_bf16_f32 v43, v22, v23
  v_cvt_pk_bf16_f32 v49, v34, v35
  v_cvt_pk_bf16_f32 v44, v24, v25
  v_cvt_pk_bf16_f32 v45, v36, v37
  ds_write_b128 v5, v[40:43] offset:12800
  ds_write_b128 v5, v[46:49] offset:12832
  s_mov_b64 exec, s[86:87]
  ds_write_b64 v5, v[44:45] offset:12864
  s_mov_b64 exec, -1
  s_waitcnt lgkmcnt(0)
  s_barrier
  v_mul_u32_u24 v3, 464, v12
  v_add_u32 v3, v3, v13
  s_mul_i32 s52, s49, 36
  s_sub_u32 s52, s52, s60
  s_sub_u32 s52, s52, s60
  v_add_u32 v3, s52, v3
  v_mul_u32_u24 v4, 400, v12
  v_add_u32 v4, v4, v13
  s_mul_i32 s52, s49, 80
  s_lshl_b32 s53, s51, 6
  s_add_u32 s52, s52, s53
  s_add_u32 s52, s52, 59392
  v_add_u32 v4, s52, v4
  ds_read_b64_tr_b16 v[64:65], v3 offset:288
  ds_read_b64_tr_b16 v[66:67], v3 offset:2144
  ds_read_b64_tr_b16 v[80:81], v4 offset:0
  ds_read_b64_tr_b16 v[82:83], v4 offset:1600
  ds_read_b64_tr_b16 v[68:69], v3 offset:7712
  ds_read_b64_tr_b16 v[70:71], v3 offset:9568
  ds_read_b64_tr_b16 v[84:85], v4 offset:6400
  ds_read_b64_tr_b16 v[86:87], v4 offset:8000
  s_waitcnt lgkmcnt(7)
  v_cndmask_b32 v64, v64, v63, s[74:75]
  v_cndmask_b32 v65, v65, v63, s[74:75]
  s_waitcnt lgkmcnt(6)
  v_cndmask_b32 v66, v66, v63, s[74:75]
  v_cndmask_b32 v67, v67, v63, s[74:75]
  s_waitcnt lgkmcnt(4)
  s_nop 0
  v_mfma_f32_32x32x16_bf16 v[96:111], v[64:67], v[80:83], 0
  ds_read_b64_tr_b16 v[64:65], v3 offset:15136
  ds_read_b64_tr_b16 v[66:67], v3 offset:16992
  ds_read_b64_tr_b16 v[80:81], v4 offset:12800
  ds_read_b64_tr_b16 v[82:83], v4 offset:14400
  s_waitcnt lgkmcnt(7)
  v_cndmask_b32 v68, v68, v63, s[74:75]
  v_cndmask_b32 v69, v69, v63, s[74:75]
  s_waitcnt lgkmcnt(6)
  v_cndmask_b32 v70, v70, v63, s[74:75]
  v_cndmask_b32 v71, v71, v63, s[74:75]
  s_waitcnt lgkmcnt(4)
  s_nop 0
  v_mfma_f32_32x32x16_bf16 v[96:111], v[68:71], v[84:87], v[96:111]
  ds_read_b64_tr_b16 v[68:69], v3 offset:22560
  ds_read_b64_tr_b16 v[70:71], v3 offset:24416
  ds_read_b64_tr_b16 v[84:85], v4 offset:19200
  ds_read_b64_tr_b16 v[86:87], v4 offset:20800
  s_waitcnt lgkmcnt(7)
  v_cndmask_b32 v64, v64, v63, s[74:75]
  v_cndmask_b32 v65, v65, v63, s[74:75]
  s_waitcnt lgkmcnt(6)
  v_cndmask_b32 v66, v66, v63, s[74:75]
  v_cndmask_b32 v67, v67, v63, s[74:75]
  s_waitcnt lgkmcnt(4)
  s_nop 0
  v_mfma_f32_32x32x16_bf16 v[96:111], v[64:67], v[80:83], v[96:111]
  ds_read_b64_tr_b16 v[64:65], v3 offset:29984
  ds_read_b64_tr_b16 v[66:67], v3 offset:31840
  ds_read_b64_tr_b16 v[80:81], v4 offset:25600
  ds_read_b64_tr_b16 v[82:83], v4 offset:27200
  s_waitcnt lgkmcnt(7)
  v_cndmask_b32 v68, v68, v63, s[74:75]
  v_cndmask_b32 v69, v69, v63, s[74:75]
  s_waitcnt lgkmcnt(6)
  v_cndmask_b32 v70, v70, v63, s[74:75]
  v_cndmask_b32 v71, v71, v63, s[74:75]
  s_waitcnt lgkmcnt(4)
  s_nop 0
  v_mfma_f32_32x32x16_bf16 v[96:111], v[68:71], v[84:87], v[96:111]
  ds_read_b64_tr_b16 v[68:69], v3 offset:37408
  ds_read_b64_tr_b16 v[70:71], v3 offset:39264
  ds_read_b64_tr_b16 v[84:85], v4 offset:32000
  ds_read_b64_tr_b16 v[86:87], v4 offset:33600
  s_waitcnt lgkmcnt(7)
  v_cndmask_b32 v64, v64, v63, s[74:75]
  v_cndmask_b32 v65, v65, v63, s[74:75]
  s_waitcnt lgkmcnt(6)
  v_cndmask_b32 v66, v66, v63, s[74:75]
  v_cndmask_b32 v67, v67, v63, s[74:75]
  s_waitcnt lgkmcnt(4)
  s_nop 0
  v_mfma_f32_32x32x16_bf16 v[96:111], v[64:67], v[80:83], v[96:111]
  ds_read_b64_tr_b16 v[64:65], v3 offset:44832
  ds_read_b64_tr_b16 v[66:67], v3 offset:46688
  ds_read_b64_tr_b16 v[80:81], v4 offset:38400
  ds_read_b64_tr_b16 v[82:83], v4 offset:40000
  s_waitcnt lgkmcnt(7)
  v_cndmask_b32 v68, v68, v63, s[74:75]
  v_cndmask_b32 v69, v69, v63, s[74:75]
  s_waitcnt lgkmcnt(6)
  v_cndmask_b32 v70, v70, v63, s[74:75]
  v_cndmask_b32 v71, v71, v63, s[74:75]
  s_waitcnt lgkmcnt(4)
  s_nop 0
  v_mfma_f32_32x32x16_bf16 v[96:111], v[68:71], v[84:87], v[96:111]
  ds_read_b64_tr_b16 v[68:69], v3 offset:52256
  ds_read_b64_tr_b16 v[70:71], v3 offset:54112
  ds_read_b64_tr_b16 v[84:85], v4 offset:44800
  ds_read_b64_tr_b16 v[86:87], v4 offset:46400
  s_waitcnt lgkmcnt(7)
  v_cndmask_b32 v64, v64, v63, s[74:75]
  v_cndmask_b32 v65, v65, v63, s[74:75]
  s_waitcnt lgkmcnt(6)
  v_cndmask_b32 v66, v66, v63, s[74:75]
  v_cndmask_b32 v67, v67, v63, s[74:75]
  s_waitcnt lgkmcnt(4)
  s_nop 0
  v_mfma_f32_32x32x16_bf16 v[96:111], v[64:67], v[80:83], v[96:111]
  s_waitcnt lgkmcnt(3)
  v_cndmask_b32 v68, v68, v63, s[74:75]
  v_cndmask_b32 v69, v69, v63, s[74:75]
  s_waitcnt lgkmcnt(2)
  v_cndmask_b32 v70, v70, v63, s[74:75]
  v_cndmask_b32 v71, v71, v63, s[74:75]
  s_waitcnt lgkmcnt(0)
  s_nop 0
  v_mfma_f32_32x32x16_bf16 v[96:111], v[68:71], v[84:87], v[96:111]
  v_mul_u32_u24 v4, 576, v9
  v_lshl_add_u32 v4, v8, 2, v4
  s_cmp_eq_u32 s51, 0
  s_cselect_b32 s52, -1, 0xf
  s_mov_b32 s76, s52
  s_mov_b32 s77, s52
  s_mov_b32 s78, s52
  s_mov_b32 s79, 0
  s_mov_b32 s80, 0
  s_mov_b32 s81, s52
  s_cmp_eq_u32 s60, 0
  s_cselect_b32 s82, s52, 0
  s_mov_b32 s83, s52
  s_mul_i32 s52, s50, 2816
  s_add_u32 s52, s52, 7143424
  s_lshl_b32 s53, s51, 7
  s_add_u32 s53, s52, s53
  s_mul_i32 s54, s60, 144
  s_sub_u32 s52, s53, s54
  s_waitcnt vmcnt(0)
  v_readfirstlane_b32 s62, v62
  s_nop 4
K1_PB_POLL_LOOP:
  s_cmp_lg_u32 s62, 0
  s_cbranch_scc1 K1_PB_POLL_OK
  buffer_load_dword v62, off, s[20:23], s61 sc0 sc1
  s_waitcnt vmcnt(0)
  v_readfirstlane_b32 s62, v62
  s_nop 4
  s_branch K1_PB_POLL_LOOP
K1_PB_POLL_OK:
  s_mov_b64 exec, s[82:83]
  buffer_atomic_add_f32 v96, v4, s[16:19], s52 offen offset:0
  buffer_atomic_add_f32 v97, v4, s[16:19], s52 offen offset:144
  s_mov_b64 exec, s[76:77]
  buffer_atomic_add_f32 v98, v4, s[16:19], s52 offen offset:288
  buffer_atomic_add_f32 v99, v4, s[16:19], s52 offen offset:432
  buffer_atomic_add_f32 v100, v4, s[16:19], s52 offen offset:1152
  buffer_atomic_add_f32 v101, v4, s[16:19], s52 offen offset:1296
  buffer_atomic_add_f32 v102, v4, s[16:19], s52 offen offset:1440
  buffer_atomic_add_f32 v103, v4, s[16:19], s52 offen offset:1584
  s_mov_b64 exec, s[78:79]
  buffer_atomic_add_f32 v104, v4, s[16:19], s52 offen offset:2304
  buffer_atomic_add_f32 v105, v4, s[16:19], s52 offen offset:2448
  s_cmp_eq_u32 s60, 0
  s_cbranch_scc1 K1_PB_AT
  buffer_atomic_add_f32 v106, v4, s[16:19], s52 offen offset:2592
  buffer_atomic_add_f32 v107, v4, s[16:19], s52 offen offset:2736
K1_PB_AT:
  s_mov_b64 exec, s[80:81]
  buffer_atomic_add_f32 v110, v4, s[16:19], s53 offen offset:2016
  s_mov_b64 exec, -1
  v_lshlrev_b32 v6, 4, v1
  s_lshr_b32 s52, s49, 1
  s_lshl_b32 s52, s52, 9
  s_and_b32 s53, s49, 1
  s_lshl_b32 s53, s53, 3
  s_add_u32 s52, s52, s53
  v_lshl_add_u32 v7, v8, 4, s52
  ds_read_b128 v[64:67], v2 offset:0
  ds_read_b128 v[68:71], v2 offset:32
  s_waitcnt lgkmcnt(1)
  v_mfma_f32_32x32x16_bf16 v[96:111], v[226:229], v[64:67], 0
  s_waitcnt lgkmcnt(0)
  v_mfma_f32_32x32x16_bf16 v[96:111], v[230:233], v[68:71], v[96:111]
  s_nop 11
  v_cvt_pk_bf16_f32 v50, v96, v97
  v_cvt_pk_bf16_f32 v51, v98, v99
  v_cvt_pk_bf16_f32 v52, v100, v101
  v_cvt_pk_bf16_f32 v53, v102, v103
  v_cvt_pk_bf16_f32 v54, v104, v105
  v_lshlrev_b32 v96, 16, v50
  v_and_b32 v97, 0xffff0000, v50
  v_lshlrev_b32 v98, 16, v51
  v_and_b32 v99, 0xffff0000, v51
  v_lshlrev_b32 v100, 16, v52
  v_and_b32 v101, 0xffff0000, v52
  v_lshlrev_b32 v102, 16, v53
  v_and_b32 v103, 0xffff0000, v53
  v_lshlrev_b32 v104, 16, v54
  v_and_b32 v105, 0xffff0000, v54
  v_max3_f32 v56, v96, v97, v98
  v_min3_f32 v57, v96, v97, v98
  v_max3_f32 v56, v56, v99, v100
  v_min3_f32 v57, v57, v99, v100
  v_max3_f32 v56, v56, v101, v102
  v_min3_f32 v57, v57, v101, v102
  v_max_f32 v56, v56, v103
  v_min_f32 v57, v57, v103
  s_mov_b64 exec, s[86:87]
  v_max3_f32 v56, v56, v104, v105
  v_min3_f32 v57, v57, v104, v105
  s_mov_b64 exec, -1
  v_mov_b32 v58, v56
  v_mov_b32 v59, v57
  s_nop 0
  v_permlane32_swap_b32 v56, v58
  v_permlane32_swap_b32 v57, v59
  v_max_f32 v56, v56, v58
  v_min_f32 v57, v57, v59
  v_mul_f32 v88, s84, v56
  v_mul_f32 v90, s70, v57
  v_mov_b32 v89, v88
  v_mov_b32 v91, v90
  v_pk_fma_f32 v[16:17], v[96:97], s[70:71], v[88:89]
  v_pk_fma_f32 v[28:29], v[96:97], s[84:85], v[90:91]
  v_pk_fma_f32 v[18:19], v[98:99], s[70:71], v[88:89]
  v_pk_fma_f32 v[30:31], v[98:99], s[84:85], v[90:91]
  v_pk_fma_f32 v[20:21], v[100:101], s[70:71], v[88:89]
  v_pk_fma_f32 v[32:33], v[100:101], s[84:85], v[90:91]
  v_pk_fma_f32 v[22:23], v[102:103], s[70:71], v[88:89]
  v_pk_fma_f32 v[34:35], v[102:103], s[84:85], v[90:91]
  v_pk_fma_f32 v[24:25], v[104:105], s[70:71], v[88:89]
  v_pk_fma_f32 v[36:37], v[104:105], s[84:85], v[90:91]
  v_exp_f32 v16, v16
  v_exp_f32 v28, v28
  v_exp_f32 v17, v17
  v_exp_f32 v29, v29
  v_exp_f32 v18, v18
  v_exp_f32 v30, v30
  v_exp_f32 v19, v19
  v_exp_f32 v31, v31
  v_exp_f32 v20, v20
  v_exp_f32 v32, v32
  v_exp_f32 v21, v21
  v_exp_f32 v33, v33
  v_exp_f32 v22, v22
  v_exp_f32 v34, v34
  v_exp_f32 v23, v23
  v_exp_f32 v35, v35
  v_exp_f32 v24, v24
  v_exp_f32 v36, v36
  v_exp_f32 v25, v25
  v_exp_f32 v37, v37
  v_pk_add_f32 v[52:53], v[16:17], v[18:19]
  v_pk_add_f32 v[56:57], v[28:29], v[30:31]
  v_pk_add_f32 v[54:55], v[20:21], v[22:23]
  v_pk_add_f32 v[58:59], v[32:33], v[34:35]
  v_pk_add_f32 v[52:53], v[52:53], v[54:55]
  v_pk_add_f32 v[56:57], v[56:57], v[58:59]
  v_add_f32 v52, v52, v53
  v_add_f32 v56, v56, v57
  s_mov_b64 exec, s[86:87]
  v_add_f32 v52, v52, v24
  v_add_f32 v56, v56, v36
  v_add_f32 v52, v52, v25
  v_add_f32 v56, v56, v37
  s_mov_b64 exec, -1
  v_mov_b32 v53, v52
  v_mov_b32 v57, v56
  s_nop 0
  v_permlane32_swap_b32 v52, v53
  v_permlane32_swap_b32 v56, v57
  v_add_f32 v52, v52, v53
  v_add_f32 v56, v56, v57
  v_rcp_f32 v52, v52
  v_rcp_f32 v56, v56
  v_mov_b32 v53, v52
  v_mov_b32 v57, v56
  v_pk_mul_f32 v[16:17], v[16:17], v[52:53]
  v_pk_mul_f32 v[28:29], v[28:29], v[56:57]
  v_pk_mul_f32 v[18:19], v[18:19], v[52:53]
  v_pk_mul_f32 v[30:31], v[30:31], v[56:57]
  v_pk_mul_f32 v[20:21], v[20:21], v[52:53]
  v_pk_mul_f32 v[32:33], v[32:33], v[56:57]
  v_pk_mul_f32 v[22:23], v[22:23], v[52:53]
  v_pk_mul_f32 v[34:35], v[34:35], v[56:57]
  v_pk_mul_f32 v[24:25], v[24:25], v[52:53]
  v_pk_mul_f32 v[36:37], v[36:37], v[56:57]
  v_cvt_pk_bf16_f32 v40, v16, v17
  v_cvt_pk_bf16_f32 v46, v28, v29
  v_cvt_pk_bf16_f32 v41, v18, v19
  v_cvt_pk_bf16_f32 v47, v30, v31
  v_cvt_pk_bf16_f32 v42, v20, v21
  v_cvt_pk_bf16_f32 v48, v32, v33
  v_cvt_pk_bf16_f32 v43, v22, v23
  v_cvt_pk_bf16_f32 v49, v34, v35
  v_cvt_pk_bf16_f32 v44, v24, v25
  v_cvt_pk_bf16_f32 v45, v36, v37
  s_lshl_b32 s52, s44, 2
  s_lshl_b32 s53, s51, 1
  s_add_u32 s52, s52, s53
  s_add_u32 s52, s52, 0
  s_lshl_b32 s53, s52, 5
  s_add_u32 s53, s53, s50
  s_lshl_b32 s53, s53, 11
  s_add_u32 s53, s53, 2359296
  buffer_store_dwordx4 v[40:43], v6, s[16:19], s53 offen
  buffer_store_dwordx4 v[46:49], v6, s[16:19], s53 offen offset:1024
  s_lshl_b32 s52, s52, 3
  s_add_u32 s52, s52, s47
  s_lshl_b32 s52, s52, 10
  s_add_u32 s52, s52, 6553600
  s_mov_b64 exec, s[86:87]
  buffer_store_dwordx2 v[44:45], v7, s[16:19], s52 offen
  s_mov_b64 exec, -1
  ds_read_b128 v[64:67], v2 offset:14848
  ds_read_b128 v[68:71], v2 offset:14880
  s_waitcnt lgkmcnt(1)
  v_mfma_f32_32x32x16_bf16 v[96:111], v[226:229], v[64:67], 0
  s_waitcnt lgkmcnt(0)
  v_mfma_f32_32x32x16_bf16 v[96:111], v[230:233], v[68:71], v[96:111]
  s_nop 11
  v_cvt_pk_bf16_f32 v50, v96, v97
  v_cvt_pk_bf16_f32 v51, v98, v99
  v_cvt_pk_bf16_f32 v52, v100, v101
  v_cvt_pk_bf16_f32 v53, v102, v103
  v_cvt_pk_bf16_f32 v54, v104, v105
  v_lshlrev_b32 v96, 16, v50
  v_and_b32 v97, 0xffff0000, v50
  v_lshlrev_b32 v98, 16, v51
  v_and_b32 v99, 0xffff0000, v51
  v_lshlrev_b32 v100, 16, v52
  v_and_b32 v101, 0xffff0000, v52
  v_lshlrev_b32 v102, 16, v53
  v_and_b32 v103, 0xffff0000, v53
  v_lshlrev_b32 v104, 16, v54
  v_and_b32 v105, 0xffff0000, v54
  v_max3_f32 v56, v96, v97, v98
  v_min3_f32 v57, v96, v97, v98
  v_max3_f32 v56, v56, v99, v100
  v_min3_f32 v57, v57, v99, v100
  v_max3_f32 v56, v56, v101, v102
  v_min3_f32 v57, v57, v101, v102
  v_max_f32 v56, v56, v103
  v_min_f32 v57, v57, v103
  s_mov_b64 exec, s[86:87]
  v_max3_f32 v56, v56, v104, v105
  v_min3_f32 v57, v57, v104, v105
  s_mov_b64 exec, -1
  v_mov_b32 v58, v56
  v_mov_b32 v59, v57
  s_nop 0
  v_permlane32_swap_b32 v56, v58
  v_permlane32_swap_b32 v57, v59
  v_max_f32 v56, v56, v58
  v_min_f32 v57, v57, v59
  v_mul_f32 v88, s84, v56
  v_mul_f32 v90, s70, v57
  v_mov_b32 v89, v88
  v_mov_b32 v91, v90
  v_pk_fma_f32 v[16:17], v[96:97], s[70:71], v[88:89]
  v_pk_fma_f32 v[28:29], v[96:97], s[84:85], v[90:91]
  v_pk_fma_f32 v[18:19], v[98:99], s[70:71], v[88:89]
  v_pk_fma_f32 v[30:31], v[98:99], s[84:85], v[90:91]
  v_pk_fma_f32 v[20:21], v[100:101], s[70:71], v[88:89]
  v_pk_fma_f32 v[32:33], v[100:101], s[84:85], v[90:91]
  v_pk_fma_f32 v[22:23], v[102:103], s[70:71], v[88:89]
  v_pk_fma_f32 v[34:35], v[102:103], s[84:85], v[90:91]
  v_pk_fma_f32 v[24:25], v[104:105], s[70:71], v[88:89]
  v_pk_fma_f32 v[36:37], v[104:105], s[84:85], v[90:91]
  v_exp_f32 v16, v16
  v_exp_f32 v28, v28
  v_exp_f32 v17, v17
  v_exp_f32 v29, v29
  v_exp_f32 v18, v18
  v_exp_f32 v30, v30
  v_exp_f32 v19, v19
  v_exp_f32 v31, v31
  v_exp_f32 v20, v20
  v_exp_f32 v32, v32
  v_exp_f32 v21, v21
  v_exp_f32 v33, v33
  v_exp_f32 v22, v22
  v_exp_f32 v34, v34
  v_exp_f32 v23, v23
  v_exp_f32 v35, v35
  v_exp_f32 v24, v24
  v_exp_f32 v36, v36
  v_exp_f32 v25, v25
  v_exp_f32 v37, v37
  v_pk_add_f32 v[52:53], v[16:17], v[18:19]
  v_pk_add_f32 v[56:57], v[28:29], v[30:31]
  v_pk_add_f32 v[54:55], v[20:21], v[22:23]
  v_pk_add_f32 v[58:59], v[32:33], v[34:35]
  v_pk_add_f32 v[52:53], v[52:53], v[54:55]
  v_pk_add_f32 v[56:57], v[56:57], v[58:59]
  v_add_f32 v52, v52, v53
  v_add_f32 v56, v56, v57
  s_mov_b64 exec, s[86:87]
  v_add_f32 v52, v52, v24
  v_add_f32 v56, v56, v36
  v_add_f32 v52, v52, v25
  v_add_f32 v56, v56, v37
  s_mov_b64 exec, -1
  v_mov_b32 v53, v52
  v_mov_b32 v57, v56
  s_nop 0
  v_permlane32_swap_b32 v52, v53
  v_permlane32_swap_b32 v56, v57
  v_add_f32 v52, v52, v53
  v_add_f32 v56, v56, v57
  v_rcp_f32 v52, v52
  v_rcp_f32 v56, v56
  v_mov_b32 v53, v52
  v_mov_b32 v57, v56
  v_pk_mul_f32 v[16:17], v[16:17], v[52:53]
  v_pk_mul_f32 v[28:29], v[28:29], v[56:57]
  v_pk_mul_f32 v[18:19], v[18:19], v[52:53]
  v_pk_mul_f32 v[30:31], v[30:31], v[56:57]
  v_pk_mul_f32 v[20:21], v[20:21], v[52:53]
  v_pk_mul_f32 v[32:33], v[32:33], v[56:57]
  v_pk_mul_f32 v[22:23], v[22:23], v[52:53]
  v_pk_mul_f32 v[34:35], v[34:35], v[56:57]
  v_pk_mul_f32 v[24:25], v[24:25], v[52:53]
  v_pk_mul_f32 v[36:37], v[36:37], v[56:57]
  v_cvt_pk_bf16_f32 v40, v16, v17
  v_cvt_pk_bf16_f32 v46, v28, v29
  v_cvt_pk_bf16_f32 v41, v18, v19
  v_cvt_pk_bf16_f32 v47, v30, v31
  v_cvt_pk_bf16_f32 v42, v20, v21
  v_cvt_pk_bf16_f32 v48, v32, v33
  v_cvt_pk_bf16_f32 v43, v22, v23
  v_cvt_pk_bf16_f32 v49, v34, v35
  v_cvt_pk_bf16_f32 v44, v24, v25
  v_cvt_pk_bf16_f32 v45, v36, v37
  s_lshl_b32 s52, s44, 2
  s_lshl_b32 s53, s51, 1
  s_add_u32 s52, s52, s53
  s_add_u32 s52, s52, 1
  s_lshl_b32 s53, s52, 5
  s_add_u32 s53, s53, s50
  s_lshl_b32 s53, s53, 11
  s_add_u32 s53, s53, 2359296
  buffer_store_dwordx4 v[40:43], v6, s[16:19], s53 offen
  buffer_store_dwordx4 v[46:49], v6, s[16:19], s53 offen offset:1024
  s_lshl_b32 s52, s52, 3
  s_add_u32 s52, s52, s47
  s_lshl_b32 s52, s52, 10
  s_add_u32 s52, s52, 6553600
  s_mov_b64 exec, s[86:87]
  buffer_store_dwordx2 v[44:45], v7, s[16:19], s52 offen
  s_mov_b64 exec, -1
K1_END:
  s_endpgm

.globl k2_kernel
.p2align 8
.type k2_kernel,@function
k2_kernel:
  s_cmp_ge_u32 s2, 192
  s_cbranch_scc1 K2_END
  s_load_dwordx2 s[4:5], s[0:1], 64
  s_load_dwordx2 s[6:7], s[0:1], 80
  v_lshrrev_b32 v2, 6, v0
  s_nop 0
  v_readfirstlane_b32 s46, v2
  v_and_b32 v1, 63, v0
  s_and_b32 s48, s2, 7
  s_lshr_b32 s49, s2, 3
  s_mul_i32 s50, s49, 43
  s_lshr_b32 s50, s50, 8
  s_mul_i32 s51, s50, 6
  s_sub_u32 s45, s49, s51
  s_lshl_b32 s50, s50, 3
  s_add_u32 s50, s50, s48
  s_lshl_b32 s44, s50, 1
  s_lshl_b32 s47, s50, 6
  s_mov_b32 s76, -1
  s_mov_b32 s77, 0
  s_mov_b32 s80, 0
  s_mov_b32 s81, -1
  s_and_b32 s51, s46, 1
  s_cmp_eq_u32 s51, 0
  s_cselect_b32 s78, -1, 0
  s_cselect_b32 s79, 0, -1
  s_mov_b32 s72, 0x358637bd
  s_waitcnt lgkmcnt(0)
  s_mov_b32 s8, s4
  s_mov_b32 s9, s5
  s_mov_b32 s10, 2359296
  s_mov_b32 s11, 0x00020000
  s_mov_b32 s16, s6
  s_mov_b32 s17, s7
  s_mov_b32 s18, 268435456
  s_mov_b32 s19, 0x00020000
  v_and_b32 v9, 31, v1
  v_lshrrev_b32 v10, 5, v1
  v_mov_b32 v11, 0x40000000
  v_cmp_gt_u32 vcc, 19, v9
  v_mul_u32_u24 v2, 80, v9
  v_add_u32 v3, 64, v2
  v_lshl_add_u32 v2, v10, 5, v2
  v_cndmask_b32 v2, v11, v2, vcc
  v_cndmask_b32 v3, v11, v3, vcc
  v_mul_u32_u24 v4, 144, v9
  v_add_u32 v5, 128, v4
  v_lshl_add_u32 v4, v10, 5, v4
  v_cndmask_b32 v4, v11, v4, vcc
  v_cndmask_b32 v5, v11, v5, vcc
  v_lshlrev_b32 v6, 4, v1
  v_mul_u32_u24 v7, 1168, v9
  v_lshl_add_u32 v7, v10, 3, v7
  s_mul_i32 s51, s46, 144
  v_add_u32 v7, s51, v7
  v_and_b32 v12, 15, v1
  v_lshrrev_b32 v13, 4, v1
  v_mul_u32_u24 v8, 1168, v12
  v_lshl_add_u32 v8, v13, 4, v8
  s_and_b32 s51, s46, 1
  s_mul_i32 s52, s51, 37376
  v_add_u32 v14, s52, v8
  s_sub_u32 s52, 37376, s52
  v_add_u32 v15, s52, v8
  s_lshl_b32 s52, s46, 2
  s_add_u32 s52, s52, 0
  s_mul_i32 s52, s52, 1536
  s_add_u32 s52, s52, 7077888
  buffer_load_dwordx4 v[16:19], v2, s[16:19], s52 offen
  buffer_load_dwordx4 v[20:23], v2, s[16:19], s52 offen offset:16
  buffer_load_dwordx2 v[24:25], v3, s[16:19], s52 offen
  s_lshl_b32 s52, s46, 2
  s_add_u32 s52, s52, 1
  s_mul_i32 s52, s52, 1536
  s_add_u32 s52, s52, 7077888
  buffer_load_dwordx4 v[26:29], v2, s[16:19], s52 offen
  buffer_load_dwordx4 v[30:33], v2, s[16:19], s52 offen offset:16
  buffer_load_dwordx2 v[34:35], v3, s[16:19], s52 offen
  s_lshl_b32 s52, s46, 2
  s_add_u32 s52, s52, 2
  s_mul_i32 s52, s52, 1536
  s_add_u32 s52, s52, 7077888
  buffer_load_dwordx4 v[36:39], v2, s[16:19], s52 offen
  buffer_load_dwordx4 v[40:43], v2, s[16:19], s52 offen offset:16
  buffer_load_dwordx2 v[44:45], v3, s[16:19], s52 offen
  s_lshl_b32 s52, s46, 2
  s_add_u32 s52, s52, 3
  s_mul_i32 s52, s52, 1536
  s_add_u32 s52, s52, 7077888
  buffer_load_dwordx4 v[46:49], v2, s[16:19], s52 offen
  buffer_load_dwordx4 v[50:53], v2, s[16:19], s52 offen offset:16
  buffer_load_dwordx2 v[54:55], v3, s[16:19], s52 offen
  s_add_u32 s52, s44, 0
  s_lshl_b32 s53, s52, 5
  s_lshl_b32 s54, s46, 2
  s_add_u32 s53, s53, s54
  s_lshl_b32 s53, s53, 10
  s_add_u32 s53, s53, 0
  buffer_load_dwordx4 v[56:59], v6, s[16:19], s53 offen offset:0
  buffer_load_dwordx4 v[60:63], v6, s[16:19], s53 offen offset:1024
  buffer_load_dwordx4 v[64:67], v6, s[16:19], s53 offen offset:2048
  buffer_load_dwordx4 v[68:71], v6, s[16:19], s53 offen offset:3072
  s_lshl_b32 s53, s52, 2
  s_lshr_b32 s54, s46, 1
  s_add_u32 s53, s53, s54
  s_lshl_b32 s53, s53, 10
  s_add_u32 s53, s53, 2097152
  buffer_load_dwordx4 v[72:75], v6, s[16:19], s53 offen
  s_add_u32 s52, s44, 1
  s_lshl_b32 s53, s52, 5
  s_lshl_b32 s54, s46, 2
  s_add_u32 s53, s53, s54
  s_lshl_b32 s53, s53, 10
  s_add_u32 s53, s53, 0
  buffer_load_dwordx4 v[76:79], v6, s[16:19], s53 offen offset:0
  buffer_load_dwordx4 v[80:83], v6, s[16:19], s53 offen offset:1024
  buffer_load_dwordx4 v[84:87], v6, s[16:19], s53 offen offset:2048
  buffer_load_dwordx4 v[88:91], v6, s[16:19], s53 offen offset:3072
  s_lshl_b32 s53, s52, 2
  s_lshr_b32 s54, s46, 1
  s_add_u32 s53, s53, s54
  s_lshl_b32 s53, s53, 10
  s_add_u32 s53, s53, 2097152
  buffer_load_dwordx4 v[92:95], v6, s[16:19], s53 offen
  s_lshl_b32 s52, s46, 2
  s_add_u32 s52, s52, 0
  s_mul_i32 s52, s52, 2816
  s_add_u32 s52, s52, 7143424
  buffer_load_dwordx4 v[96:99], v4, s[16:19], s52 offen
  buffer_load_dwordx4 v[100:103], v4, s[16:19], s52 offen offset:16
  buffer_load_dwordx4 v[104:107], v4, s[16:19], s52 offen offset:64
  buffer_load_dwordx4 v[108:111], v4, s[16:19], s52 offen offset:80
  buffer_load_dwordx4 v[112:115], v5, s[16:19], s52 offen
  s_lshl_b32 s52, s46, 2
  s_add_u32 s52, s52, 1
  s_mul_i32 s52, s52, 2816
  s_add_u32 s52, s52, 7143424
  buffer_load_dwordx4 v[116:119], v4, s[16:19], s52 offen
  buffer_load_dwordx4 v[120:123], v4, s[16:19], s52 offen offset:16
  buffer_load_dwordx4 v[124:127], v4, s[16:19], s52 offen offset:64
  buffer_load_dwordx4 v[128:131], v4, s[16:19], s52 offen offset:80
  buffer_load_dwordx4 v[132:135], v5, s[16:19], s52 offen
  s_lshl_b32 s52, s46, 2
  s_add_u32 s52, s52, 2
  s_mul_i32 s52, s52, 2816
  s_add_u32 s52, s52, 7143424
  buffer_load_dwordx4 v[136:139], v4, s[16:19], s52 offen
  buffer_load_dwordx4 v[140:143], v4, s[16:19], s52 offen offset:16
  buffer_load_dwordx4 v[144:147], v4, s[16:19], s52 offen offset:64
  buffer_load_dwordx4 v[148:151], v4, s[16:19], s52 offen offset:80
  buffer_load_dwordx4 v[152:155], v5, s[16:19], s52 offen
  s_lshl_b32 s52, s46, 2
  s_add_u32 s52, s52, 3
  s_mul_i32 s52, s52, 2816
  s_add_u32 s52, s52, 7143424
  buffer_load_dwordx4 v[156:159], v4, s[16:19], s52 offen
  buffer_load_dwordx4 v[160:163], v4, s[16:19], s52 offen offset:16
  buffer_load_dwordx4 v[164:167], v4, s[16:19], s52 offen offset:64
  buffer_load_dwordx4 v[168:171], v4, s[16:19], s52 offen offset:80
  buffer_load_dwordx4 v[172:175], v5, s[16:19], s52 offen
  s_waitcnt vmcnt(41)
  v_cvt_pk_bf16_f32 v16, v16, v17
  v_cvt_pk_bf16_f32 v17, v18, v19
  s_waitcnt vmcnt(40)
  v_cvt_pk_bf16_f32 v18, v20, v21
  v_cvt_pk_bf16_f32 v19, v22, v23
  s_waitcnt vmcnt(39)
  v_cvt_pk_bf16_f32 v24, v24, v25
  v_cndmask_b32 v20, 0, v24, s[78:79]
  v_mov_b32 v21, 0
  v_mov_b32 v22, 0
  v_mov_b32 v23, 0
  s_waitcnt vmcnt(38)
  v_cvt_pk_bf16_f32 v26, v26, v27
  v_cvt_pk_bf16_f32 v27, v28, v29
  s_waitcnt vmcnt(37)
  v_cvt_pk_bf16_f32 v28, v30, v31
  v_cvt_pk_bf16_f32 v29, v32, v33
  s_waitcnt vmcnt(36)
  v_cvt_pk_bf16_f32 v34, v34, v35
  v_mov_b32 v30, 0
  v_cndmask_b32 v31, 0, v34, s[78:79]
  v_mov_b32 v32, 0
  v_mov_b32 v33, 0
  s_waitcnt vmcnt(35)
  v_cvt_pk_bf16_f32 v36, v36, v37
  v_cvt_pk_bf16_f32 v37, v38, v39
  s_waitcnt vmcnt(34)
  v_cvt_pk_bf16_f32 v38, v40, v41
  v_cvt_pk_bf16_f32 v39, v42, v43
  s_waitcnt vmcnt(33)
  v_cvt_pk_bf16_f32 v44, v44, v45
  v_mov_b32 v40, 0
  v_mov_b32 v41, 0
  v_cndmask_b32 v42, 0, v44, s[78:79]
  v_mov_b32 v43, 0
  s_waitcnt vmcnt(32)
  v_cvt_pk_bf16_f32 v46, v46, v47
  v_cvt_pk_bf16_f32 v47, v48, v49
  s_waitcnt vmcnt(31)
  v_cvt_pk_bf16_f32 v48, v50, v51
  v_cvt_pk_bf16_f32 v49, v52, v53
  s_waitcnt vmcnt(30)
  v_cvt_pk_bf16_f32 v54, v54, v55
  v_mov_b32 v50, 0
  v_mov_b32 v51, 0
  v_mov_b32 v52, 0
  v_cndmask_b32 v53, 0, v54, s[78:79]
  s_waitcnt vmcnt(29)
  v_mfma_f32_32x32x16_bf16 v[176:191], v[16:19], v[56:59], 0
  s_waitcnt vmcnt(25)
  v_mfma_f32_32x32x16_bf16 v[176:191], v[20:23], v[72:75], v[176:191]
  v_mfma_f32_32x32x16_bf16 v[192:207], v[26:29], v[60:63], 0
  v_mfma_f32_32x32x16_bf16 v[192:207], v[30:33], v[72:75], v[192:207]
  s_nop 9
  v_cvt_pk_bf16_f32 v208, v186, v186
  v_lshlrev_b32 v208, 16, v208
  v_add_f32 v208, s72, v208
  v_cvt_pk_bf16_f32 v208, v208, v208
  v_lshlrev_b32 v208, 16, v208
  v_mov_b32 v209, v208
  s_nop 1
  v_permlane32_swap_b32 v208, v209
  v_rcp_f32 v208, v208
  v_cvt_pk_bf16_f32 v210, v176, v177
  v_cvt_pk_bf16_f32 v211, v178, v179
  v_cvt_pk_bf16_f32 v212, v180, v181
  v_cvt_pk_bf16_f32 v213, v182, v183
  v_cvt_pk_bf16_f32 v214, v184, v185
  v_mov_b32 v209, v208
  v_lshlrev_b32 v176, 16, v210
  v_and_b32 v177, 0xffff0000, v210
  v_lshlrev_b32 v178, 16, v211
  v_and_b32 v179, 0xffff0000, v211
  v_lshlrev_b32 v180, 16, v212
  v_and_b32 v181, 0xffff0000, v212
  v_lshlrev_b32 v182, 16, v213
  v_and_b32 v183, 0xffff0000, v213
  v_lshlrev_b32 v184, 16, v214
  v_and_b32 v185, 0xffff0000, v214
  v_pk_mul_f32 v[176:177], v[176:177], v[208:209]
  v_pk_mul_f32 v[178:179], v[178:179], v[208:209]
  v_pk_mul_f32 v[180:181], v[180:181], v[208:209]
  v_pk_mul_f32 v[182:183], v[182:183], v[208:209]
  v_pk_mul_f32 v[184:185], v[184:185], v[208:209]
  v_cvt_pk_bf16_f32 v210, v176, v177
  v_cvt_pk_bf16_f32 v211, v178, v179
  v_cvt_pk_bf16_f32 v212, v180, v181
  v_cvt_pk_bf16_f32 v213, v182, v183
  v_cvt_pk_bf16_f32 v214, v184, v185
  ds_write_b64 v7, v[210:211] offset:0
  ds_write_b64 v7, v[212:213] offset:16
  s_mov_b64 exec, s[76:77]
  ds_write_b32 v7, v214 offset:32
  s_mov_b64 exec, -1
  v_mfma_f32_32x32x16_bf16 v[176:191], v[36:39], v[64:67], 0
  v_mfma_f32_32x32x16_bf16 v[176:191], v[40:43], v[72:75], v[176:191]
  v_cvt_pk_bf16_f32 v208, v202, v202
  v_lshlrev_b32 v208, 16, v208
  v_add_f32 v208, s72, v208
  v_cvt_pk_bf16_f32 v208, v208, v208
  v_lshlrev_b32 v208, 16, v208
  v_mov_b32 v209, v208
  s_nop 1
  v_permlane32_swap_b32 v208, v209
  v_rcp_f32 v208, v208
  v_cvt_pk_bf16_f32 v210, v192, v193
  v_cvt_pk_bf16_f32 v211, v194, v195
  v_cvt_pk_bf16_f32 v212, v196, v197
  v_cvt_pk_bf16_f32 v213, v198, v199
  v_cvt_pk_bf16_f32 v214, v200, v201
  v_mov_b32 v209, v208
  v_lshlrev_b32 v192, 16, v210
  v_and_b32 v193, 0xffff0000, v210
  v_lshlrev_b32 v194, 16, v211
  v_and_b32 v195, 0xffff0000, v211
  v_lshlrev_b32 v196, 16, v212
  v_and_b32 v197, 0xffff0000, v212
  v_lshlrev_b32 v198, 16, v213
  v_and_b32 v199, 0xffff0000, v213
  v_lshlrev_b32 v200, 16, v214
  v_and_b32 v201, 0xffff0000, v214
  v_pk_mul_f32 v[192:193], v[192:193], v[208:209]
  v_pk_mul_f32 v[194:195], v[194:195], v[208:209]
  v_pk_mul_f32 v[196:197], v[196:197], v[208:209]
  v_pk_mul_f32 v[198:199], v[198:199], v[208:209]
  v_pk_mul_f32 v[200:201], v[200:201], v[208:209]
  v_cvt_pk_bf16_f32 v210, v192, v193
  v_cvt_pk_bf16_f32 v211, v194, v195
  v_cvt_pk_bf16_f32 v212, v196, v197
  v_cvt_pk_bf16_f32 v213, v198, v199
  v_cvt_pk_bf16_f32 v214, v200, v201
  ds_write_b64 v7, v[210:211] offset:36
  ds_write_b64 v7, v[212:213] offset:52
  s_mov_b64 exec, s[76:77]
  ds_write_b32 v7, v214 offset:68
  s_mov_b64 exec, -1
  v_mfma_f32_32x32x16_bf16 v[192:207], v[46:49], v[68:71], 0
  v_mfma_f32_32x32x16_bf16 v[192:207], v[50:53], v[72:75], v[192:207]
  v_cvt_pk_bf16_f32 v208, v186, v186
  v_lshlrev_b32 v208, 16, v208
  v_add_f32 v208, s72, v208
  v_cvt_pk_bf16_f32 v208, v208, v208
  v_lshlrev_b32 v208, 16, v208
  v_mov_b32 v209, v208
  s_nop 1
  v_permlane32_swap_b32 v208, v209
  v_rcp_f32 v208, v208
  v_cvt_pk_bf16_f32 v210, v176, v177
  v_cvt_pk_bf16_f32 v211, v178, v179
  v_cvt_pk_bf16_f32 v212, v180, v181
  v_cvt_pk_bf16_f32 v213, v182, v183
  v_cvt_pk_bf16_f32 v214, v184, v185
  v_mov_b32 v209, v208
  v_lshlrev_b32 v176, 16, v210
  v_and_b32 v177, 0xffff0000, v210
  v_lshlrev_b32 v178, 16, v211
  v_and_b32 v179, 0xffff0000, v211
  v_lshlrev_b32 v180, 16, v212
  v_and_b32 v181, 0xffff0000, v212
  v_lshlrev_b32 v182, 16, v213
  v_and_b32 v183, 0xffff0000, v213
  v_lshlrev_b32 v184, 16, v214
  v_and_b32 v185, 0xffff0000, v214
  v_pk_mul_f32 v[176:177], v[176:177], v[208:209]
  v_pk_mul_f32 v[178:179], v[178:179], v[208:209]
  v_pk_mul_f32 v[180:181], v[180:181], v[208:209]
  v_pk_mul_f32 v[182:183], v[182:183], v[208:209]
  v_pk_mul_f32 v[184:185], v[184:185], v[208:209]
  v_cvt_pk_bf16_f32 v210, v176, v177
  v_cvt_pk_bf16_f32 v211, v178, v179
  v_cvt_pk_bf16_f32 v212, v180, v181
  v_cvt_pk_bf16_f32 v213, v182, v183
  v_cvt_pk_bf16_f32 v214, v184, v185
  ds_write_b64 v7, v[210:211] offset:72
  ds_write_b64 v7, v[212:213] offset:88
  s_mov_b64 exec, s[76:77]
  ds_write_b32 v7, v214 offset:104
  s_mov_b64 exec, -1
  s_waitcnt vmcnt(24)
  v_mfma_f32_32x32x16_bf16 v[176:191], v[16:19], v[76:79], 0
  s_waitcnt vmcnt(20)
  v_mfma_f32_32x32x16_bf16 v[176:191], v[20:23], v[92:95], v[176:191]
  v_cvt_pk_bf16_f32 v208, v202, v202
  v_lshlrev_b32 v208, 16, v208
  v_add_f32 v208, s72, v208
  v_cvt_pk_bf16_f32 v208, v208, v208
  v_lshlrev_b32 v208, 16, v208
  v_mov_b32 v209, v208
  s_nop 1
  v_permlane32_swap_b32 v208, v209
  v_rcp_f32 v208, v208
  v_cvt_pk_bf16_f32 v210, v192, v193
  v_cvt_pk_bf16_f32 v211, v194, v195
  v_cvt_pk_bf16_f32 v212, v196, v197
  v_cvt_pk_bf16_f32 v213, v198, v199
  v_cvt_pk_bf16_f32 v214, v200, v201
  v_mov_b32 v209, v208
  v_lshlrev_b32 v192, 16, v210
  v_and_b32 v193, 0xffff0000, v210
  v_lshlrev_b32 v194, 16, v211
  v_and_b32 v195, 0xffff0000, v211
  v_lshlrev_b32 v196, 16, v212
  v_and_b32 v197, 0xffff0000, v212
  v_lshlrev_b32 v198, 16, v213
  v_and_b32 v199, 0xffff0000, v213
  v_lshlrev_b32 v200, 16, v214
  v_and_b32 v201, 0xffff0000, v214
  v_pk_mul_f32 v[192:193], v[192:193], v[208:209]
  v_pk_mul_f32 v[194:195], v[194:195], v[208:209]
  v_pk_mul_f32 v[196:197], v[196:197], v[208:209]
  v_pk_mul_f32 v[198:199], v[198:199], v[208:209]
  v_pk_mul_f32 v[200:201], v[200:201], v[208:209]
  v_cvt_pk_bf16_f32 v210, v192, v193
  v_cvt_pk_bf16_f32 v211, v194, v195
  v_cvt_pk_bf16_f32 v212, v196, v197
  v_cvt_pk_bf16_f32 v213, v198, v199
  v_cvt_pk_bf16_f32 v214, v200, v201
  ds_write_b64 v7, v[210:211] offset:108
  ds_write_b64 v7, v[212:213] offset:124
  s_mov_b64 exec, s[76:77]
  ds_write_b32 v7, v214 offset:140
  s_mov_b64 exec, -1
  v_mfma_f32_32x32x16_bf16 v[192:207], v[26:29], v[80:83], 0
  v_mfma_f32_32x32x16_bf16 v[192:207], v[30:33], v[92:95], v[192:207]
  v_cvt_pk_bf16_f32 v208, v186, v186
  v_lshlrev_b32 v208, 16, v208
  v_add_f32 v208, s72, v208
  v_cvt_pk_bf16_f32 v208, v208, v208
  v_lshlrev_b32 v208, 16, v208
  v_mov_b32 v209, v208
  s_nop 1
  v_permlane32_swap_b32 v208, v209
  v_rcp_f32 v208, v208
  v_cvt_pk_bf16_f32 v210, v176, v177
  v_cvt_pk_bf16_f32 v211, v178, v179
  v_cvt_pk_bf16_f32 v212, v180, v181
  v_cvt_pk_bf16_f32 v213, v182, v183
  v_cvt_pk_bf16_f32 v214, v184, v185
  v_mov_b32 v209, v208
  v_lshlrev_b32 v176, 16, v210
  v_and_b32 v177, 0xffff0000, v210
  v_lshlrev_b32 v178, 16, v211
  v_and_b32 v179, 0xffff0000, v211
  v_lshlrev_b32 v180, 16, v212
  v_and_b32 v181, 0xffff0000, v212
  v_lshlrev_b32 v182, 16, v213
  v_and_b32 v183, 0xffff0000, v213
  v_lshlrev_b32 v184, 16, v214
  v_and_b32 v185, 0xffff0000, v214
  v_pk_mul_f32 v[176:177], v[176:177], v[208:209]
  v_pk_mul_f32 v[178:179], v[178:179], v[208:209]
  v_pk_mul_f32 v[180:181], v[180:181], v[208:209]
  v_pk_mul_f32 v[182:183], v[182:183], v[208:209]
  v_pk_mul_f32 v[184:185], v[184:185], v[208:209]
  v_cvt_pk_bf16_f32 v210, v176, v177
  v_cvt_pk_bf16_f32 v211, v178, v179
  v_cvt_pk_bf16_f32 v212, v180, v181
  v_cvt_pk_bf16_f32 v213, v182, v183
  v_cvt_pk_bf16_f32 v214, v184, v185
  ds_write_b64 v7, v[210:211] offset:37376
  ds_write_b64 v7, v[212:213] offset:37392
  s_mov_b64 exec, s[76:77]
  ds_write_b32 v7, v214 offset:37408
  s_mov_b64 exec, -1
  v_mfma_f32_32x32x16_bf16 v[176:191], v[36:39], v[84:87], 0
  v_mfma_f32_32x32x16_bf16 v[176:191], v[40:43], v[92:95], v[176:191]
  v_cvt_pk_bf16_f32 v208, v202, v202
  v_lshlrev_b32 v208, 16, v208
  v_add_f32 v208, s72, v208
  v_cvt_pk_bf16_f32 v208, v208, v208
  v_lshlrev_b32 v208, 16, v208
  v_mov_b32 v209, v208
  s_nop 1
  v_permlane32_swap_b32 v208, v209
  v_rcp_f32 v208, v208
  v_cvt_pk_bf16_f32 v210, v192, v193
  v_cvt_pk_bf16_f32 v211, v194, v195
  v_cvt_pk_bf16_f32 v212, v196, v197
  v_cvt_pk_bf16_f32 v213, v198, v199
  v_cvt_pk_bf16_f32 v214, v200, v201
  v_mov_b32 v209, v208
  v_lshlrev_b32 v192, 16, v210
  v_and_b32 v193, 0xffff0000, v210
  v_lshlrev_b32 v194, 16, v211
  v_and_b32 v195, 0xffff0000, v211
  v_lshlrev_b32 v196, 16, v212
  v_and_b32 v197, 0xffff0000, v212
  v_lshlrev_b32 v198, 16, v213
  v_and_b32 v199, 0xffff0000, v213
  v_lshlrev_b32 v200, 16, v214
  v_and_b32 v201, 0xffff0000, v214
  v_pk_mul_f32 v[192:193], v[192:193], v[208:209]
  v_pk_mul_f32 v[194:195], v[194:195], v[208:209]
  v_pk_mul_f32 v[196:197], v[196:197], v[208:209]
  v_pk_mul_f32 v[198:199], v[198:199], v[208:209]
  v_pk_mul_f32 v[200:201], v[200:201], v[208:209]
  v_cvt_pk_bf16_f32 v210, v192, v193
  v_cvt_pk_bf16_f32 v211, v194, v195
  v_cvt_pk_bf16_f32 v212, v196, v197
  v_cvt_pk_bf16_f32 v213, v198, v199
  v_cvt_pk_bf16_f32 v214, v200, v201
  ds_write_b64 v7, v[210:211] offset:37412
  ds_write_b64 v7, v[212:213] offset:37428
  s_mov_b64 exec, s[76:77]
  ds_write_b32 v7, v214 offset:37444
  s_mov_b64 exec, -1
  v_mfma_f32_32x32x16_bf16 v[192:207], v[46:49], v[88:91], 0
  v_mfma_f32_32x32x16_bf16 v[192:207], v[50:53], v[92:95], v[192:207]
  v_cvt_pk_bf16_f32 v208, v186, v186
  v_lshlrev_b32 v208, 16, v208
  v_add_f32 v208, s72, v208
  v_cvt_pk_bf16_f32 v208, v208, v208
  v_lshlrev_b32 v208, 16, v208
  v_mov_b32 v209, v208
  s_nop 1
  v_permlane32_swap_b32 v208, v209
  v_rcp_f32 v208, v208
  v_cvt_pk_bf16_f32 v210, v176, v177
  v_cvt_pk_bf16_f32 v211, v178, v179
  v_cvt_pk_bf16_f32 v212, v180, v181
  v_cvt_pk_bf16_f32 v213, v182, v183
  v_cvt_pk_bf16_f32 v214, v184, v185
  v_mov_b32 v209, v208
  v_lshlrev_b32 v176, 16, v210
  v_and_b32 v177, 0xffff0000, v210
  v_lshlrev_b32 v178, 16, v211
  v_and_b32 v179, 0xffff0000, v211
  v_lshlrev_b32 v180, 16, v212
  v_and_b32 v181, 0xffff0000, v212
  v_lshlrev_b32 v182, 16, v213
  v_and_b32 v183, 0xffff0000, v213
  v_lshlrev_b32 v184, 16, v214
  v_and_b32 v185, 0xffff0000, v214
  v_pk_mul_f32 v[176:177], v[176:177], v[208:209]
  v_pk_mul_f32 v[178:179], v[178:179], v[208:209]
  v_pk_mul_f32 v[180:181], v[180:181], v[208:209]
  v_pk_mul_f32 v[182:183], v[182:183], v[208:209]
  v_pk_mul_f32 v[184:185], v[184:185], v[208:209]
  v_cvt_pk_bf16_f32 v210, v176, v177
  v_cvt_pk_bf16_f32 v211, v178, v179
  v_cvt_pk_bf16_f32 v212, v180, v181
  v_cvt_pk_bf16_f32 v213, v182, v183
  v_cvt_pk_bf16_f32 v214, v184, v185
  ds_write_b64 v7, v[210:211] offset:37448
  ds_write_b64 v7, v[212:213] offset:37464
  s_mov_b64 exec, s[76:77]
  ds_write_b32 v7, v214 offset:37480
  s_mov_b64 exec, -1
  v_cvt_pk_bf16_f32 v208, v202, v202
  v_lshlrev_b32 v208, 16, v208
  v_add_f32 v208, s72, v208
  v_cvt_pk_bf16_f32 v208, v208, v208
  v_lshlrev_b32 v208, 16, v208
  v_mov_b32 v209, v208
  s_nop 1
  v_permlane32_swap_b32 v208, v209
  v_rcp_f32 v208, v208
  v_cvt_pk_bf16_f32 v210, v192, v193
  v_cvt_pk_bf16_f32 v211, v194, v195
  v_cvt_pk_bf16_f32 v212, v196, v197
  v_cvt_pk_bf16_f32 v213, v198, v199
  v_cvt_pk_bf16_f32 v214, v200, v201
  v_mov_b32 v209, v208
  v_lshlrev_b32 v192, 16, v210
  v_and_b32 v193, 0xffff0000, v210
  v_lshlrev_b32 v194, 16, v211
  v_and_b32 v195, 0xffff0000, v211
  v_lshlrev_b32 v196, 16, v212
  v_and_b32 v197, 0xffff0000, v212
  v_lshlrev_b32 v198, 16, v213
  v_and_b32 v199, 0xffff0000, v213
  v_lshlrev_b32 v200, 16, v214
  v_and_b32 v201, 0xffff0000, v214
  v_pk_mul_f32 v[192:193], v[192:193], v[208:209]
  v_pk_mul_f32 v[194:195], v[194:195], v[208:209]
  v_pk_mul_f32 v[196:197], v[196:197], v[208:209]
  v_pk_mul_f32 v[198:199], v[198:199], v[208:209]
  v_pk_mul_f32 v[200:201], v[200:201], v[208:209]
  v_cvt_pk_bf16_f32 v210, v192, v193
  v_cvt_pk_bf16_f32 v211, v194, v195
  v_cvt_pk_bf16_f32 v212, v196, v197
  v_cvt_pk_bf16_f32 v213, v198, v199
  v_cvt_pk_bf16_f32 v214, v200, v201
  ds_write_b64 v7, v[210:211] offset:37484
  ds_write_b64 v7, v[212:213] offset:37500
  s_mov_b64 exec, s[76:77]
  ds_write_b32 v7, v214 offset:37516
  s_mov_b64 exec, -1
  s_waitcnt vmcnt(19)
  v_cvt_pk_bf16_f32 v96, v96, v97
  v_cvt_pk_bf16_f32 v97, v98, v99
  s_waitcnt vmcnt(18)
  v_cvt_pk_bf16_f32 v98, v100, v101
  v_cvt_pk_bf16_f32 v99, v102, v103
  s_waitcnt vmcnt(17)
  v_cvt_pk_bf16_f32 v100, v104, v105
  v_cvt_pk_bf16_f32 v101, v106, v107
  s_waitcnt vmcnt(16)
  v_cvt_pk_bf16_f32 v102, v108, v109
  v_cvt_pk_bf16_f32 v103, v110, v111
  s_waitcnt vmcnt(15)
  v_cvt_pk_bf16_f32 v112, v112, v113
  v_cvt_pk_bf16_f32 v113, v114, v115
  v_cndmask_b32 v104, 0, v112, s[76:77]
  v_cndmask_b32 v105, 0, v113, s[76:77]
  v_mov_b32 v106, 0
  v_mov_b32 v107, 0
  s_waitcnt vmcnt(14)
  v_cvt_pk_bf16_f32 v108, v116, v117
  v_cvt_pk_bf16_f32 v109, v118, v119
  s_waitcnt vmcnt(13)
  v_cvt_pk_bf16_f32 v110, v120, v121
  v_cvt_pk_bf16_f32 v111, v122, v123
  s_waitcnt vmcnt(12)
  v_cvt_pk_bf16_f32 v112, v124, v125
  v_cvt_pk_bf16_f32 v113, v126, v127
  s_waitcnt vmcnt(11)
  v_cvt_pk_bf16_f32 v114, v128, v129
  v_cvt_pk_bf16_f32 v115, v130, v131
  s_waitcnt vmcnt(10)
  v_cvt_pk_bf16_f32 v132, v132, v133
  v_cvt_pk_bf16_f32 v133, v134, v135
  v_mov_b32 v116, 0
  v_mov_b32 v117, 0
  v_cndmask_b32 v118, 0, v132, s[76:77]
  v_cndmask_b32 v119, 0, v133, s[76:77]
  s_waitcnt vmcnt(9)
  v_cvt_pk_bf16_f32 v120, v136, v137
  v_cvt_pk_bf16_f32 v121, v138, v139
  s_waitcnt vmcnt(8)
  v_cvt_pk_bf16_f32 v122, v140, v141
  v_cvt_pk_bf16_f32 v123, v142, v143
  s_waitcnt vmcnt(7)
  v_cvt_pk_bf16_f32 v124, v144, v145
  v_cvt_pk_bf16_f32 v125, v146, v147
  s_waitcnt vmcnt(6)
  v_cvt_pk_bf16_f32 v126, v148, v149
  v_cvt_pk_bf16_f32 v127, v150, v151
  s_waitcnt vmcnt(5)
  v_cvt_pk_bf16_f32 v152, v152, v153
  v_cvt_pk_bf16_f32 v153, v154, v155
  v_cndmask_b32 v128, 0, v152, s[80:81]
  v_cndmask_b32 v129, 0, v153, s[80:81]
  v_mov_b32 v130, 0
  v_mov_b32 v131, 0
  s_waitcnt vmcnt(4)
  v_cvt_pk_bf16_f32 v132, v156, v157
  v_cvt_pk_bf16_f32 v133, v158, v159
  s_waitcnt vmcnt(3)
  v_cvt_pk_bf16_f32 v134, v160, v161
  v_cvt_pk_bf16_f32 v135, v162, v163
  s_waitcnt vmcnt(2)
  v_cvt_pk_bf16_f32 v136, v164, v165
  v_cvt_pk_bf16_f32 v137, v166, v167
  s_waitcnt vmcnt(1)
  v_cvt_pk_bf16_f32 v138, v168, v169
  v_cvt_pk_bf16_f32 v139, v170, v171
  s_waitcnt vmcnt(0)
  v_cvt_pk_bf16_f32 v172, v172, v173
  v_cvt_pk_bf16_f32 v173, v174, v175
  v_mov_b32 v140, 0
  v_mov_b32 v141, 0
  v_cndmask_b32 v142, 0, v172, s[80:81]
  v_cndmask_b32 v143, 0, v173, s[80:81]
  s_cmp_ge_u32 s46, 4
  s_nop 0
  s_cbranch_scc1 K2_IDLE_A
  s_and_b32 s53, s46, 1
  s_mul_i32 s53, s53, 576
  v_add_u32 v14, s53, v14
  v_add_u32 v15, s53, v15
  s_lshr_b32 s52, s46, 1
  s_mul_i32 s52, s52, 3
  s_mul_i32 s53, s45, 6
  s_add_u32 s52, s52, s53
  s_add_u32 s52, s52, 0
  s_mul_i32 s55, s52, 18432
  s_and_b32 s53, s46, 1
  s_mul_i32 s54, s53, 9216
  s_add_u32 s55, s55, s54
  s_add_u32 s55, s55, 7340032
  s_mul_i32 s57, s53, 576
  s_add_u32 s56, s55, 0
  buffer_load_dwordx4 v[176:179], v6, s[16:19], s56 offen
  s_add_u32 s56, s55, 18432
  buffer_load_dwordx4 v[180:183], v6, s[16:19], s56 offen
  s_add_u32 s56, s55, 36864
  buffer_load_dwordx4 v[184:187], v6, s[16:19], s56 offen
  s_add_u32 s56, s55, 1024
  buffer_load_dwordx4 v[188:191], v6, s[16:19], s56 offen
  s_add_u32 s56, s55, 19456
  buffer_load_dwordx4 v[192:195], v6, s[16:19], s56 offen
  s_add_u32 s56, s55, 37888
  buffer_load_dwordx4 v[196:199], v6, s[16:19], s56 offen
  s_add_u32 s56, s55, 2048
  buffer_load_dwordx4 v[200:203], v6, s[16:19], s56 offen
  s_add_u32 s56, s55, 20480
  buffer_load_dwordx4 v[204:207], v6, s[16:19], s56 offen
  s_add_u32 s56, s55, 38912
  buffer_load_dwordx4 v[208:211], v6, s[16:19], s56 offen
  s_waitcnt lgkmcnt(0)
  s_barrier
  ds_read_b128 v[64:67], v14 offset:0
  ds_read_b128 v[68:71], v14 offset:18688
  ds_read_b128 v[72:75], v15 offset:0
  ds_read_b128 v[76:79], v15 offset:18688
  s_add_u32 s56, s55, 3072
  buffer_load_dwordx4 v[212:215], v6, s[16:19], s56 offen
  s_add_u32 s56, s55, 21504
  buffer_load_dwordx4 v[216:219], v6, s[16:19], s56 offen
  s_add_u32 s56, s55, 39936
  buffer_load_dwordx4 v[220:223], v6, s[16:19], s56 offen
  ds_read_b128 v[80:83], v14 offset:64
  ds_read_b128 v[84:87], v14 offset:18752
  ds_read_b128 v[88:91], v15 offset:64
  ds_read_b128 v[92:95], v15 offset:18752
  s_waitcnt vmcnt(11) lgkmcnt(7)
  v_mfma_f32_16x16x32_bf16 v[16:19], v[176:179], v[64:67], 0
  s_waitcnt vmcnt(10)
  v_mfma_f32_16x16x32_bf16 v[20:23], v[180:183], v[64:67], 0
  s_waitcnt vmcnt(9)
  v_mfma_f32_16x16x32_bf16 v[24:27], v[184:187], v[64:67], 0
  s_waitcnt lgkmcnt(6)
  v_mfma_f32_16x16x32_bf16 v[28:31], v[176:179], v[68:71], 0
  v_mfma_f32_16x16x32_bf16 v[32:35], v[180:183], v[68:71], 0
  v_mfma_f32_16x16x32_bf16 v[36:39], v[184:187], v[68:71], 0
  s_waitcnt lgkmcnt(5)
  v_mfma_f32_16x16x32_bf16 v[40:43], v[176:179], v[72:75], 0
  v_mfma_f32_16x16x32_bf16 v[44:47], v[180:183], v[72:75], 0
  v_mfma_f32_16x16x32_bf16 v[48:51], v[184:187], v[72:75], 0
  s_waitcnt lgkmcnt(4)
  v_mfma_f32_16x16x32_bf16 v[52:55], v[176:179], v[76:79], 0
  v_mfma_f32_16x16x32_bf16 v[56:59], v[180:183], v[76:79], 0
  v_mfma_f32_16x16x32_bf16 v[60:63], v[184:187], v[76:79], 0
  s_add_u32 s56, s55, 4096
  buffer_load_dwordx4 v[176:179], v6, s[16:19], s56 offen
  s_add_u32 s56, s55, 22528
  buffer_load_dwordx4 v[180:183], v6, s[16:19], s56 offen
  s_add_u32 s56, s55, 40960
  buffer_load_dwordx4 v[184:187], v6, s[16:19], s56 offen
  ds_read_b128 v[64:67], v14 offset:128
  ds_read_b128 v[68:71], v14 offset:18816
  ds_read_b128 v[72:75], v15 offset:128
  ds_read_b128 v[76:79], v15 offset:18816
  s_waitcnt vmcnt(11) lgkmcnt(7)
  v_mfma_f32_16x16x32_bf16 v[16:19], v[188:191], v[80:83], v[16:19]
  s_waitcnt vmcnt(10)
  v_mfma_f32_16x16x32_bf16 v[20:23], v[192:195], v[80:83], v[20:23]
  s_waitcnt vmcnt(9)
  v_mfma_f32_16x16x32_bf16 v[24:27], v[196:199], v[80:83], v[24:27]
  s_waitcnt lgkmcnt(6)
  v_mfma_f32_16x16x32_bf16 v[28:31], v[188:191], v[84:87], v[28:31]
  v_mfma_f32_16x16x32_bf16 v[32:35], v[192:195], v[84:87], v[32:35]
  v_mfma_f32_16x16x32_bf16 v[36:39], v[196:199], v[84:87], v[36:39]
  s_waitcnt lgkmcnt(5)
  v_mfma_f32_16x16x32_bf16 v[40:43], v[188:191], v[88:91], v[40:43]
  v_mfma_f32_16x16x32_bf16 v[44:47], v[192:195], v[88:91], v[44:47]
  v_mfma_f32_16x16x32_bf16 v[48:51], v[196:199], v[88:91], v[48:51]
  s_waitcnt lgkmcnt(4)
  v_mfma_f32_16x16x32_bf16 v[52:55], v[188:191], v[92:95], v[52:55]
  v_mfma_f32_16x16x32_bf16 v[56:59], v[192:195], v[92:95], v[56:59]
  v_mfma_f32_16x16x32_bf16 v[60:63], v[196:199], v[92:95], v[60:63]
  s_add_u32 s56, s55, 5120
  buffer_load_dwordx4 v[188:191], v6, s[16:19], s56 offen
  s_add_u32 s56, s55, 23552
  buffer_load_dwordx4 v[192:195], v6, s[16:19], s56 offen
  s_add_u32 s56, s55, 41984
  buffer_load_dwordx4 v[196:199], v6, s[16:19], s56 offen
  ds_read_b128 v[80:83], v14 offset:192
  ds_read_b128 v[84:87], v14 offset:18880
  ds_read_b128 v[88:91], v15 offset:192
  ds_read_b128 v[92:95], v15 offset:18880
  s_waitcnt vmcnt(11) lgkmcnt(7)
  v_mfma_f32_16x16x32_bf16 v[16:19], v[200:203], v[64:67], v[16:19]
  s_waitcnt vmcnt(10)
  v_mfma_f32_16x16x32_bf16 v[20:23], v[204:207], v[64:67], v[20:23]
  s_waitcnt vmcnt(9)
  v_mfma_f32_16x16x32_bf16 v[24:27], v[208:211], v[64:67], v[24:27]
  s_waitcnt lgkmcnt(6)
  v_mfma_f32_16x16x32_bf16 v[28:31], v[200:203], v[68:71], v[28:31]
  v_mfma_f32_16x16x32_bf16 v[32:35], v[204:207], v[68:71], v[32:35]
  v_mfma_f32_16x16x32_bf16 v[36:39], v[208:211], v[68:71], v[36:39]
  s_waitcnt lgkmcnt(5)
  v_mfma_f32_16x16x32_bf16 v[40:43], v[200:203], v[72:75], v[40:43]
  v_mfma_f32_16x16x32_bf16 v[44:47], v[204:207], v[72:75], v[44:47]
  v_mfma_f32_16x16x32_bf16 v[48:51], v[208:211], v[72:75], v[48:51]
  s_waitcnt lgkmcnt(4)
  v_mfma_f32_16x16x32_bf16 v[52:55], v[200:203], v[76:79], v[52:55]
  v_mfma_f32_16x16x32_bf16 v[56:59], v[204:207], v[76:79], v[56:59]
  v_mfma_f32_16x16x32_bf16 v[60:63], v[208:211], v[76:79], v[60:63]
  s_add_u32 s56, s55, 6144
  buffer_load_dwordx4 v[200:203], v6, s[16:19], s56 offen
  s_add_u32 s56, s55, 24576
  buffer_load_dwordx4 v[204:207], v6, s[16:19], s56 offen
  s_add_u32 s56, s55, 43008
  buffer_load_dwordx4 v[208:211], v6, s[16:19], s56 offen
  ds_read_b128 v[64:67], v14 offset:256
  ds_read_b128 v[68:71], v14 offset:18944
  ds_read_b128 v[72:75], v15 offset:256
  ds_read_b128 v[76:79], v15 offset:18944
  s_waitcnt vmcnt(11) lgkmcnt(7)
  v_mfma_f32_16x16x32_bf16 v[16:19], v[212:215], v[80:83], v[16:19]
  s_waitcnt vmcnt(10)
  v_mfma_f32_16x16x32_bf16 v[20:23], v[216:219], v[80:83], v[20:23]
  s_waitcnt vmcnt(9)
  v_mfma_f32_16x16x32_bf16 v[24:27], v[220:223], v[80:83], v[24:27]
  s_waitcnt lgkmcnt(6)
  v_mfma_f32_16x16x32_bf16 v[28:31], v[212:215], v[84:87], v[28:31]
  v_mfma_f32_16x16x32_bf16 v[32:35], v[216:219], v[84:87], v[32:35]
  v_mfma_f32_16x16x32_bf16 v[36:39], v[220:223], v[84:87], v[36:39]
  s_waitcnt lgkmcnt(5)
  v_mfma_f32_16x16x32_bf16 v[40:43], v[212:215], v[88:91], v[40:43]
  v_mfma_f32_16x16x32_bf16 v[44:47], v[216:219], v[88:91], v[44:47]
  v_mfma_f32_16x16x32_bf16 v[48:51], v[220:223], v[88:91], v[48:51]
  s_waitcnt lgkmcnt(4)
  v_mfma_f32_16x16x32_bf16 v[52:55], v[212:215], v[92:95], v[52:55]
  v_mfma_f32_16x16x32_bf16 v[56:59], v[216:219], v[92:95], v[56:59]
  v_mfma_f32_16x16x32_bf16 v[60:63], v[220:223], v[92:95], v[60:63]
  s_add_u32 s56, s55, 7168
  buffer_load_dwordx4 v[212:215], v6, s[16:19], s56 offen
  s_add_u32 s56, s55, 25600
  buffer_load_dwordx4 v[216:219], v6, s[16:19], s56 offen
  s_add_u32 s56, s55, 44032
  buffer_load_dwordx4 v[220:223], v6, s[16:19], s56 offen
  ds_read_b128 v[80:83], v14 offset:320
  ds_read_b128 v[84:87], v14 offset:19008
  ds_read_b128 v[88:91], v15 offset:320
  ds_read_b128 v[92:95], v15 offset:19008
  s_waitcnt vmcnt(11) lgkmcnt(7)
  v_mfma_f32_16x16x32_bf16 v[16:19], v[176:179], v[64:67], v[16:19]
  s_waitcnt vmcnt(10)
  v_mfma_f32_16x16x32_bf16 v[20:23], v[180:183], v[64:67], v[20:23]
  s_waitcnt vmcnt(9)
  v_mfma_f32_16x16x32_bf16 v[24:27], v[184:187], v[64:67], v[24:27]
  s_waitcnt lgkmcnt(6)
  v_mfma_f32_16x16x32_bf16 v[28:31], v[176:179], v[68:71], v[28:31]
  v_mfma_f32_16x16x32_bf16 v[32:35], v[180:183], v[68:71], v[32:35]
  v_mfma_f32_16x16x32_bf16 v[36:39], v[184:187], v[68:71], v[36:39]
  s_waitcnt lgkmcnt(5)
  v_mfma_f32_16x16x32_bf16 v[40:43], v[176:179], v[72:75], v[40:43]
  v_mfma_f32_16x16x32_bf16 v[44:47], v[180:183], v[72:75], v[44:47]
  v_mfma_f32_16x16x32_bf16 v[48:51], v[184:187], v[72:75], v[48:51]
  s_waitcnt lgkmcnt(4)
  v_mfma_f32_16x16x32_bf16 v[52:55], v[176:179], v[76:79], v[52:55]
  v_mfma_f32_16x16x32_bf16 v[56:59], v[180:183], v[76:79], v[56:59]
  v_mfma_f32_16x16x32_bf16 v[60:63], v[184:187], v[76:79], v[60:63]
  s_add_u32 s56, s55, 8192
  buffer_load_dwordx4 v[176:179], v6, s[16:19], s56 offen
  s_add_u32 s56, s55, 26624
  buffer_load_dwordx4 v[180:183], v6, s[16:19], s56 offen
  s_add_u32 s56, s55, 45056
  buffer_load_dwordx4 v[184:187], v6, s[16:19], s56 offen
  ds_read_b128 v[64:67], v14 offset:384
  ds_read_b128 v[68:71], v14 offset:19072
  ds_read_b128 v[72:75], v15 offset:384
  ds_read_b128 v[76:79], v15 offset:19072
  s_waitcnt vmcnt(11) lgkmcnt(7)
  v_mfma_f32_16x16x32_bf16 v[16:19], v[188:191], v[80:83], v[16:19]
  s_waitcnt vmcnt(10)
  v_mfma_f32_16x16x32_bf16 v[20:23], v[192:195], v[80:83], v[20:23]
  s_waitcnt vmcnt(9)
  v_mfma_f32_16x16x32_bf16 v[24:27], v[196:199], v[80:83], v[24:27]
  s_waitcnt lgkmcnt(6)
  v_mfma_f32_16x16x32_bf16 v[28:31], v[188:191], v[84:87], v[28:31]
  v_mfma_f32_16x16x32_bf16 v[32:35], v[192:195], v[84:87], v[32:35]
  v_mfma_f32_16x16x32_bf16 v[36:39], v[196:199], v[84:87], v[36:39]
  s_waitcnt lgkmcnt(5)
  v_mfma_f32_16x16x32_bf16 v[40:43], v[188:191], v[88:91], v[40:43]
  v_mfma_f32_16x16x32_bf16 v[44:47], v[192:195], v[88:91], v[44:47]
  v_mfma_f32_16x16x32_bf16 v[48:51], v[196:199], v[88:91], v[48:51]
  s_waitcnt lgkmcnt(4)
  v_mfma_f32_16x16x32_bf16 v[52:55], v[188:191], v[92:95], v[52:55]
  v_mfma_f32_16x16x32_bf16 v[56:59], v[192:195], v[92:95], v[56:59]
  v_mfma_f32_16x16x32_bf16 v[60:63], v[196:199], v[92:95], v[60:63]
  ds_read_b128 v[80:83], v14 offset:448
  ds_read_b128 v[84:87], v14 offset:19136
  ds_read_b128 v[88:91], v15 offset:448
  ds_read_b128 v[92:95], v15 offset:19136
  s_waitcnt vmcnt(8) lgkmcnt(7)
  v_mfma_f32_16x16x32_bf16 v[16:19], v[200:203], v[64:67], v[16:19]
  s_waitcnt vmcnt(7)
  v_mfma_f32_16x16x32_bf16 v[20:23], v[204:207], v[64:67], v[20:23]
  s_waitcnt vmcnt(6)
  v_mfma_f32_16x16x32_bf16 v[24:27], v[208:211], v[64:67], v[24:27]
  s_waitcnt lgkmcnt(6)
  v_mfma_f32_16x16x32_bf16 v[28:31], v[200:203], v[68:71], v[28:31]
  v_mfma_f32_16x16x32_bf16 v[32:35], v[204:207], v[68:71], v[32:35]
  v_mfma_f32_16x16x32_bf16 v[36:39], v[208:211], v[68:71], v[36:39]
  s_waitcnt lgkmcnt(5)
  v_mfma_f32_16x16x32_bf16 v[40:43], v[200:203], v[72:75], v[40:43]
  v_mfma_f32_16x16x32_bf16 v[44:47], v[204:207], v[72:75], v[44:47]
  v_mfma_f32_16x16x32_bf16 v[48:51], v[208:211], v[72:75], v[48:51]
  s_waitcnt lgkmcnt(4)
  v_mfma_f32_16x16x32_bf16 v[52:55], v[200:203], v[76:79], v[52:55]
  v_mfma_f32_16x16x32_bf16 v[56:59], v[204:207], v[76:79], v[56:59]
  v_mfma_f32_16x16x32_bf16 v[60:63], v[208:211], v[76:79], v[60:63]
  ds_read_b128 v[64:67], v14 offset:512
  ds_read_b128 v[68:71], v14 offset:19200
  ds_read_b128 v[72:75], v15 offset:512
  ds_read_b128 v[76:79], v15 offset:19200
  s_waitcnt vmcnt(5) lgkmcnt(7)
  v_mfma_f32_16x16x32_bf16 v[16:19], v[212:215], v[80:83], v[16:19]
  s_waitcnt vmcnt(4)
  v_mfma_f32_16x16x32_bf16 v[20:23], v[216:219], v[80:83], v[20:23]
  s_waitcnt vmcnt(3)
  v_mfma_f32_16x16x32_bf16 v[24:27], v[220:223], v[80:83], v[24:27]
  s_waitcnt lgkmcnt(6)
  v_mfma_f32_16x16x32_bf16 v[28:31], v[212:215], v[84:87], v[28:31]
  v_mfma_f32_16x16x32_bf16 v[32:35], v[216:219], v[84:87], v[32:35]
  v_mfma_f32_16x16x32_bf16 v[36:39], v[220:223], v[84:87], v[36:39]
  s_waitcnt lgkmcnt(5)
  v_mfma_f32_16x16x32_bf16 v[40:43], v[212:215], v[88:91], v[40:43]
  v_mfma_f32_16x16x32_bf16 v[44:47], v[216:219], v[88:91], v[44:47]
  v_mfma_f32_16x16x32_bf16 v[48:51], v[220:223], v[88:91], v[48:51]
  s_waitcnt lgkmcnt(4)
  v_mfma_f32_16x16x32_bf16 v[52:55], v[212:215], v[92:95], v[52:55]
  v_mfma_f32_16x16x32_bf16 v[56:59], v[216:219], v[92:95], v[56:59]
  v_mfma_f32_16x16x32_bf16 v[60:63], v[220:223], v[92:95], v[60:63]
  s_waitcnt vmcnt(2) lgkmcnt(3)
  v_mfma_f32_16x16x32_bf16 v[16:19], v[176:179], v[64:67], v[16:19]
  s_waitcnt vmcnt(1)
  v_mfma_f32_16x16x32_bf16 v[20:23], v[180:183], v[64:67], v[20:23]
  s_waitcnt vmcnt(0)
  v_mfma_f32_16x16x32_bf16 v[24:27], v[184:187], v[64:67], v[24:27]
  s_waitcnt lgkmcnt(2)
  v_mfma_f32_16x16x32_bf16 v[28:31], v[176:179], v[68:71], v[28:31]
  v_mfma_f32_16x16x32_bf16 v[32:35], v[180:183], v[68:71], v[32:35]
  v_mfma_f32_16x16x32_bf16 v[36:39], v[184:187], v[68:71], v[36:39]
  s_waitcnt lgkmcnt(1)
  v_mfma_f32_16x16x32_bf16 v[40:43], v[176:179], v[72:75], v[40:43]
  v_mfma_f32_16x16x32_bf16 v[44:47], v[180:183], v[72:75], v[44:47]
  v_mfma_f32_16x16x32_bf16 v[48:51], v[184:187], v[72:75], v[48:51]
  s_waitcnt lgkmcnt(0)
  v_mfma_f32_16x16x32_bf16 v[52:55], v[176:179], v[76:79], v[52:55]
  v_mfma_f32_16x16x32_bf16 v[56:59], v[180:183], v[76:79], v[56:59]
  v_mfma_f32_16x16x32_bf16 v[60:63], v[184:187], v[76:79], v[60:63]
  s_add_u32 s52, s44, 0
  s_lshl_b32 s53, s52, 5
  s_lshl_b32 s54, s46, 2
  s_add_u32 s53, s53, s54
  s_lshl_b32 s53, s53, 11
  s_add_u32 s53, s53, 2359296
  buffer_load_dwordx4 v[176:179], v6, s[16:19], s53 offen offset:0
  buffer_load_dwordx4 v[180:183], v6, s[16:19], s53 offen offset:1024
  buffer_load_dwordx4 v[184:187], v6, s[16:19], s53 offen offset:2048
  buffer_load_dwordx4 v[188:191], v6, s[16:19], s53 offen offset:3072
  s_add_u32 s53, s53, 4096
  buffer_load_dwordx4 v[192:195], v6, s[16:19], s53 offen offset:0
  buffer_load_dwordx4 v[196:199], v6, s[16:19], s53 offen offset:1024
  buffer_load_dwordx4 v[200:203], v6, s[16:19], s53 offen offset:2048
  buffer_load_dwordx4 v[204:207], v6, s[16:19], s53 offen offset:3072
  s_lshl_b32 s53, s52, 3
  s_add_u32 s53, s53, s46
  s_lshl_b32 s53, s53, 10
  s_add_u32 s53, s53, 6553600
  buffer_load_dwordx4 v[208:211], v6, s[16:19], s53 offen
  s_add_u32 s52, s44, 1
  s_lshl_b32 s53, s52, 5
  s_lshl_b32 s54, s46, 2
  s_add_u32 s53, s53, s54
  s_lshl_b32 s53, s53, 11
  s_add_u32 s53, s53, 2359296
  buffer_load_dwordx4 v[212:215], v6, s[16:19], s53 offen offset:0
  buffer_load_dwordx4 v[216:219], v6, s[16:19], s53 offen offset:1024
  buffer_load_dwordx4 v[220:223], v6, s[16:19], s53 offen offset:2048
  buffer_load_dwordx4 v[224:227], v6, s[16:19], s53 offen offset:3072
  s_add_u32 s53, s53, 4096
  buffer_load_dwordx4 v[228:231], v6, s[16:19], s53 offen offset:0
  buffer_load_dwordx4 v[232:235], v6, s[16:19], s53 offen offset:1024
  buffer_load_dwordx4 v[236:239], v6, s[16:19], s53 offen offset:2048
  buffer_load_dwordx4 v[240:243], v6, s[16:19], s53 offen offset:3072
  s_lshl_b32 s53, s52, 3
  s_add_u32 s53, s53, s46
  s_lshl_b32 s53, s53, 10
  s_add_u32 s53, s53, 6553600
  buffer_load_dwordx4 v[244:247], v6, s[16:19], s53 offen
  s_mul_i32 s52, s46, 6144
  s_add_u32 s52, s52, 74752
  v_add_u32 v9, s52, v6
  ds_write_b128 v9, v[40:43] offset:0
  ds_write_b128 v9, v[44:47] offset:1024
  ds_write_b128 v9, v[48:51] offset:2048
  ds_write_b128 v9, v[52:55] offset:3072
  ds_write_b128 v9, v[56:59] offset:4096
  ds_write_b128 v9, v[60:63] offset:5120
  s_waitcnt lgkmcnt(0)
  s_barrier
  s_xor_b32 s52, s46, 1
  s_mul_i32 s52, s52, 6144
  s_add_u32 s52, s52, 74752
  v_add_u32 v9, s52, v6
  ds_read_b128 v[64:67], v9 offset:0
  ds_read_b128 v[68:71], v9 offset:1024
  ds_read_b128 v[72:75], v9 offset:2048
  ds_read_b128 v[76:79], v9 offset:3072
  ds_read_b128 v[80:83], v9 offset:4096
  ds_read_b128 v[84:87], v9 offset:5120
  s_waitcnt lgkmcnt(5)
  v_add_f32 v16, v16, v64
  v_add_f32 v17, v17, v65
  v_add_f32 v18, v18, v66
  v_add_f32 v19, v19, v67
  s_waitcnt lgkmcnt(4)
  v_add_f32 v20, v20, v68
  v_add_f32 v21, v21, v69
  v_add_f32 v22, v22, v70
  v_add_f32 v23, v23, v71
  s_waitcnt lgkmcnt(3)
  v_add_f32 v24, v24, v72
  v_add_f32 v25, v25, v73
  v_add_f32 v26, v26, v74
  v_add_f32 v27, v27, v75
  s_waitcnt lgkmcnt(2)
  v_add_f32 v28, v28, v76
  v_add_f32 v29, v29, v77
  v_add_f32 v30, v30, v78
  v_add_f32 v31, v31, v79
  s_waitcnt lgkmcnt(1)
  v_add_f32 v32, v32, v80
  v_add_f32 v33, v33, v81
  v_add_f32 v34, v34, v82
  v_add_f32 v35, v35, v83
  s_waitcnt lgkmcnt(0)
  v_add_f32 v36, v36, v84
  v_add_f32 v37, v37, v85
  v_add_f32 v38, v38, v86
  v_add_f32 v39, v39, v87
  v_cvt_pk_bf16_f32 v144, v16, v17
  v_cvt_pk_bf16_f32 v145, v18, v19
  v_cvt_pk_bf16_f32 v146, v20, v21
  v_cvt_pk_bf16_f32 v147, v22, v23
  v_cvt_pk_bf16_f32 v148, v24, v25
  v_cvt_pk_bf16_f32 v149, v26, v27
  v_cvt_pk_bf16_f32 v150, v28, v29
  v_cvt_pk_bf16_f32 v151, v30, v31
  v_cvt_pk_bf16_f32 v152, v32, v33
  v_cvt_pk_bf16_f32 v153, v34, v35
  v_cvt_pk_bf16_f32 v154, v36, v37
  v_cvt_pk_bf16_f32 v155, v38, v39
  s_nop 1
  s_branch K2_JOIN_B
K2_IDLE_A:
  s_add_u32 s52, s44, 0
  s_lshl_b32 s53, s52, 5
  s_lshl_b32 s54, s46, 2
  s_add_u32 s53, s53, s54
  s_lshl_b32 s53, s53, 11
  s_add_u32 s53, s53, 2359296
  buffer_load_dwordx4 v[176:179], v6, s[16:19], s53 offen offset:0
  buffer_load_dwordx4 v[180:183], v6, s[16:19], s53 offen offset:1024
  buffer_load_dwordx4 v[184:187], v6, s[16:19], s53 offen offset:2048
  buffer_load_dwordx4 v[188:191], v6, s[16:19], s53 offen offset:3072
  s_add_u32 s53, s53, 4096
  buffer_load_dwordx4 v[192:195], v6, s[16:19], s53 offen offset:0
  buffer_load_dwordx4 v[196:199], v6, s[16:19], s53 offen offset:1024
  buffer_load_dwordx4 v[200:203], v6, s[16:19], s53 offen offset:2048
  buffer_load_dwordx4 v[204:207], v6, s[16:19], s53 offen offset:3072
  s_lshl_b32 s53, s52, 3
  s_add_u32 s53, s53, s46
  s_lshl_b32 s53, s53, 10
  s_add_u32 s53, s53, 6553600
  buffer_load_dwordx4 v[208:211], v6, s[16:19], s53 offen
  s_add_u32 s52, s44, 1
  s_lshl_b32 s53, s52, 5
  s_lshl_b32 s54, s46, 2
  s_add_u32 s53, s53, s54
  s_lshl_b32 s53, s53, 11
  s_add_u32 s53, s53, 2359296
  buffer_load_dwordx4 v[212:215], v6, s[16:19], s53 offen offset:0
  buffer_load_dwordx4 v[216:219], v6, s[16:19], s53 offen offset:1024
  buffer_load_dwordx4 v[220:223], v6, s[16:19], s53 offen offset:2048
  buffer_load_dwordx4 v[224:227], v6, s[16:19], s53 offen offset:3072
  s_add_u32 s53, s53, 4096
  buffer_load_dwordx4 v[228:231], v6, s[16:19], s53 offen offset:0
  buffer_load_dwordx4 v[232:235], v6, s[16:19], s53 offen offset:1024
  buffer_load_dwordx4 v[236:239], v6, s[16:19], s53 offen offset:2048
  buffer_load_dwordx4 v[240:243], v6, s[16:19], s53 offen offset:3072
  s_lshl_b32 s53, s52, 3
  s_add_u32 s53, s53, s46
  s_lshl_b32 s53, s53, 10
  s_add_u32 s53, s53, 6553600
  buffer_load_dwordx4 v[244:247], v6, s[16:19], s53 offen
  s_barrier
  s_barrier
K2_JOIN_B:
  s_waitcnt vmcnt(17)
  v_mfma_f32_32x32x16_bf16 v[16:31], v[96:99], v[176:179], 0
  s_waitcnt vmcnt(16)
  v_mfma_f32_32x32x16_bf16 v[16:31], v[100:103], v[180:183], v[16:31]
  s_waitcnt vmcnt(9)
  v_mfma_f32_32x32x16_bf16 v[16:31], v[104:107], v[208:211], v[16:31]
  v_mfma_f32_32x32x16_bf16 v[32:47], v[108:111], v[184:187], 0
  v_mfma_f32_32x32x16_bf16 v[32:47], v[112:115], v[188:191], v[32:47]
  v_mfma_f32_32x32x16_bf16 v[32:47], v[116:119], v[208:211], v[32:47]
  s_nop 8
  v_cvt_pk_bf16_f32 v48, v26, v26
  v_lshlrev_b32 v48, 16, v48
  v_add_f32 v48, s72, v48
  v_cvt_pk_bf16_f32 v48, v48, v48
  v_lshlrev_b32 v48, 16, v48
  v_mov_b32 v49, v48
  s_nop 1
  v_permlane32_swap_b32 v48, v49
  v_rcp_f32 v48, v48
  v_cvt_pk_bf16_f32 v50, v16, v17
  v_cvt_pk_bf16_f32 v51, v18, v19
  v_cvt_pk_bf16_f32 v52, v20, v21
  v_cvt_pk_bf16_f32 v53, v22, v23
  v_cvt_pk_bf16_f32 v54, v24, v25
  v_mov_b32 v49, v48
  v_lshlrev_b32 v16, 16, v50
  v_and_b32 v17, 0xffff0000, v50
  v_lshlrev_b32 v18, 16, v51
  v_and_b32 v19, 0xffff0000, v51
  v_lshlrev_b32 v20, 16, v52
  v_and_b32 v21, 0xffff0000, v52
  v_lshlrev_b32 v22, 16, v53
  v_and_b32 v23, 0xffff0000, v53
  v_lshlrev_b32 v24, 16, v54
  v_and_b32 v25, 0xffff0000, v54
  v_pk_mul_f32 v[16:17], v[16:17], v[48:49]
  v_pk_mul_f32 v[18:19], v[18:19], v[48:49]
  v_pk_mul_f32 v[20:21], v[20:21], v[48:49]
  v_pk_mul_f32 v[22:23], v[22:23], v[48:49]
  v_pk_mul_f32 v[24:25], v[24:25], v[48:49]
  v_cvt_pk_bf16_f32 v50, v16, v17
  v_cvt_pk_bf16_f32 v51, v18, v19
  v_cvt_pk_bf16_f32 v52, v20, v21
  v_cvt_pk_bf16_f32 v53, v22, v23
  v_cvt_pk_bf16_f32 v54, v24, v25
  ds_write_b64 v7, v[50:51] offset:0
  ds_write_b64 v7, v[52:53] offset:16
  s_mov_b64 exec, s[76:77]
  ds_write_b32 v7, v54 offset:32
  s_mov_b64 exec, -1
  v_mfma_f32_32x32x16_bf16 v[16:31], v[120:123], v[192:195], 0
  v_mfma_f32_32x32x16_bf16 v[16:31], v[124:127], v[196:199], v[16:31]
  v_mfma_f32_32x32x16_bf16 v[16:31], v[128:131], v[208:211], v[16:31]
  v_cvt_pk_bf16_f32 v48, v42, v42
  v_lshlrev_b32 v48, 16, v48
  v_add_f32 v48, s72, v48
  v_cvt_pk_bf16_f32 v48, v48, v48
  v_lshlrev_b32 v48, 16, v48
  v_mov_b32 v49, v48
  s_nop 1
  v_permlane32_swap_b32 v48, v49
  v_rcp_f32 v48, v48
  v_cvt_pk_bf16_f32 v50, v32, v33
  v_cvt_pk_bf16_f32 v51, v34, v35
  v_cvt_pk_bf16_f32 v52, v36, v37
  v_cvt_pk_bf16_f32 v53, v38, v39
  v_cvt_pk_bf16_f32 v54, v40, v41
  v_mov_b32 v49, v48
  v_lshlrev_b32 v32, 16, v50
  v_and_b32 v33, 0xffff0000, v50
  v_lshlrev_b32 v34, 16, v51
  v_and_b32 v35, 0xffff0000, v51
  v_lshlrev_b32 v36, 16, v52
  v_and_b32 v37, 0xffff0000, v52
  v_lshlrev_b32 v38, 16, v53
  v_and_b32 v39, 0xffff0000, v53
  v_lshlrev_b32 v40, 16, v54
  v_and_b32 v41, 0xffff0000, v54
  v_pk_mul_f32 v[32:33], v[32:33], v[48:49]
  v_pk_mul_f32 v[34:35], v[34:35], v[48:49]
  v_pk_mul_f32 v[36:37], v[36:37], v[48:49]
  v_pk_mul_f32 v[38:39], v[38:39], v[48:49]
  v_pk_mul_f32 v[40:41], v[40:41], v[48:49]
  v_cvt_pk_bf16_f32 v50, v32, v33
  v_cvt_pk_bf16_f32 v51, v34, v35
  v_cvt_pk_bf16_f32 v52, v36, v37
  v_cvt_pk_bf16_f32 v53, v38, v39
  v_cvt_pk_bf16_f32 v54, v40, v41
  ds_write_b64 v7, v[50:51] offset:36
  ds_write_b64 v7, v[52:53] offset:52
  s_mov_b64 exec, s[76:77]
  ds_write_b32 v7, v54 offset:68
  s_mov_b64 exec, -1
  v_mfma_f32_32x32x16_bf16 v[32:47], v[132:135], v[200:203], 0
  v_mfma_f32_32x32x16_bf16 v[32:47], v[136:139], v[204:207], v[32:47]
  v_mfma_f32_32x32x16_bf16 v[32:47], v[140:143], v[208:211], v[32:47]
  v_cvt_pk_bf16_f32 v48, v26, v26
  v_lshlrev_b32 v48, 16, v48
  v_add_f32 v48, s72, v48
  v_cvt_pk_bf16_f32 v48, v48, v48
  v_lshlrev_b32 v48, 16, v48
  v_mov_b32 v49, v48
  s_nop 1
  v_permlane32_swap_b32 v48, v49
  v_rcp_f32 v48, v48
  v_cvt_pk_bf16_f32 v50, v16, v17
  v_cvt_pk_bf16_f32 v51, v18, v19
  v_cvt_pk_bf16_f32 v52, v20, v21
  v_cvt_pk_bf16_f32 v53, v22, v23
  v_cvt_pk_bf16_f32 v54, v24, v25
  v_mov_b32 v49, v48
  v_lshlrev_b32 v16, 16, v50
  v_and_b32 v17, 0xffff0000, v50
  v_lshlrev_b32 v18, 16, v51
  v_and_b32 v19, 0xffff0000, v51
  v_lshlrev_b32 v20, 16, v52
  v_and_b32 v21, 0xffff0000, v52
  v_lshlrev_b32 v22, 16, v53
  v_and_b32 v23, 0xffff0000, v53
  v_lshlrev_b32 v24, 16, v54
  v_and_b32 v25, 0xffff0000, v54
  v_pk_mul_f32 v[16:17], v[16:17], v[48:49]
  v_pk_mul_f32 v[18:19], v[18:19], v[48:49]
  v_pk_mul_f32 v[20:21], v[20:21], v[48:49]
  v_pk_mul_f32 v[22:23], v[22:23], v[48:49]
  v_pk_mul_f32 v[24:25], v[24:25], v[48:49]
  v_cvt_pk_bf16_f32 v50, v16, v17
  v_cvt_pk_bf16_f32 v51, v18, v19
  v_cvt_pk_bf16_f32 v52, v20, v21
  v_cvt_pk_bf16_f32 v53, v22, v23
  v_cvt_pk_bf16_f32 v54, v24, v25
  ds_write_b64 v7, v[50:51] offset:72
  ds_write_b64 v7, v[52:53] offset:88
  s_mov_b64 exec, s[76:77]
  ds_write_b32 v7, v54 offset:104
  s_mov_b64 exec, -1
  s_waitcnt vmcnt(8)
  v_mfma_f32_32x32x16_bf16 v[16:31], v[96:99], v[212:215], 0
  s_waitcnt vmcnt(7)
  v_mfma_f32_32x32x16_bf16 v[16:31], v[100:103], v[216:219], v[16:31]
  s_waitcnt vmcnt(0)
  v_mfma_f32_32x32x16_bf16 v[16:31], v[104:107], v[244:247], v[16:31]
  v_cvt_pk_bf16_f32 v48, v42, v42
  v_lshlrev_b32 v48, 16, v48
  v_add_f32 v48, s72, v48
  v_cvt_pk_bf16_f32 v48, v48, v48
  v_lshlrev_b32 v48, 16, v48
  v_mov_b32 v49, v48
  s_nop 1
  v_permlane32_swap_b32 v48, v49
  v_rcp_f32 v48, v48
  v_cvt_pk_bf16_f32 v50, v32, v33
  v_cvt_pk_bf16_f32 v51, v34, v35
  v_cvt_pk_bf16_f32 v52, v36, v37
  v_cvt_pk_bf16_f32 v53, v38, v39
  v_cvt_pk_bf16_f32 v54, v40, v41
  v_mov_b32 v49, v48
  v_lshlrev_b32 v32, 16, v50
  v_and_b32 v33, 0xffff0000, v50
  v_lshlrev_b32 v34, 16, v51
  v_and_b32 v35, 0xffff0000, v51
  v_lshlrev_b32 v36, 16, v52
  v_and_b32 v37, 0xffff0000, v52
  v_lshlrev_b32 v38, 16, v53
  v_and_b32 v39, 0xffff0000, v53
  v_lshlrev_b32 v40, 16, v54
  v_and_b32 v41, 0xffff0000, v54
  v_pk_mul_f32 v[32:33], v[32:33], v[48:49]
  v_pk_mul_f32 v[34:35], v[34:35], v[48:49]
  v_pk_mul_f32 v[36:37], v[36:37], v[48:49]
  v_pk_mul_f32 v[38:39], v[38:39], v[48:49]
  v_pk_mul_f32 v[40:41], v[40:41], v[48:49]
  v_cvt_pk_bf16_f32 v50, v32, v33
  v_cvt_pk_bf16_f32 v51, v34, v35
  v_cvt_pk_bf16_f32 v52, v36, v37
  v_cvt_pk_bf16_f32 v53, v38, v39
  v_cvt_pk_bf16_f32 v54, v40, v41
  ds_write_b64 v7, v[50:51] offset:108
  ds_write_b64 v7, v[52:53] offset:124
  s_mov_b64 exec, s[76:77]
  ds_write_b32 v7, v54 offset:140
  s_mov_b64 exec, -1
  v_mfma_f32_32x32x16_bf16 v[32:47], v[108:111], v[220:223], 0
  v_mfma_f32_32x32x16_bf16 v[32:47], v[112:115], v[224:227], v[32:47]
  v_mfma_f32_32x32x16_bf16 v[32:47], v[116:119], v[244:247], v[32:47]
  v_cvt_pk_bf16_f32 v48, v26, v26
  v_lshlrev_b32 v48, 16, v48
  v_add_f32 v48, s72, v48
  v_cvt_pk_bf16_f32 v48, v48, v48
  v_lshlrev_b32 v48, 16, v48
  v_mov_b32 v49, v48
  s_nop 1
  v_permlane32_swap_b32 v48, v49
  v_rcp_f32 v48, v48
  v_cvt_pk_bf16_f32 v50, v16, v17
  v_cvt_pk_bf16_f32 v51, v18, v19
  v_cvt_pk_bf16_f32 v52, v20, v21
  v_cvt_pk_bf16_f32 v53, v22, v23
  v_cvt_pk_bf16_f32 v54, v24, v25
  v_mov_b32 v49, v48
  v_lshlrev_b32 v16, 16, v50
  v_and_b32 v17, 0xffff0000, v50
  v_lshlrev_b32 v18, 16, v51
  v_and_b32 v19, 0xffff0000, v51
  v_lshlrev_b32 v20, 16, v52
  v_and_b32 v21, 0xffff0000, v52
  v_lshlrev_b32 v22, 16, v53
  v_and_b32 v23, 0xffff0000, v53
  v_lshlrev_b32 v24, 16, v54
  v_and_b32 v25, 0xffff0000, v54
  v_pk_mul_f32 v[16:17], v[16:17], v[48:49]
  v_pk_mul_f32 v[18:19], v[18:19], v[48:49]
  v_pk_mul_f32 v[20:21], v[20:21], v[48:49]
  v_pk_mul_f32 v[22:23], v[22:23], v[48:49]
  v_pk_mul_f32 v[24:25], v[24:25], v[48:49]
  v_cvt_pk_bf16_f32 v50, v16, v17
  v_cvt_pk_bf16_f32 v51, v18, v19
  v_cvt_pk_bf16_f32 v52, v20, v21
  v_cvt_pk_bf16_f32 v53, v22, v23
  v_cvt_pk_bf16_f32 v54, v24, v25
  ds_write_b64 v7, v[50:51] offset:37376
  ds_write_b64 v7, v[52:53] offset:37392
  s_mov_b64 exec, s[76:77]
  ds_write_b32 v7, v54 offset:37408
  s_mov_b64 exec, -1
  v_mfma_f32_32x32x16_bf16 v[16:31], v[120:123], v[228:231], 0
  v_mfma_f32_32x32x16_bf16 v[16:31], v[124:127], v[232:235], v[16:31]
  v_mfma_f32_32x32x16_bf16 v[16:31], v[128:131], v[244:247], v[16:31]
  v_cvt_pk_bf16_f32 v48, v42, v42
  v_lshlrev_b32 v48, 16, v48
  v_add_f32 v48, s72, v48
  v_cvt_pk_bf16_f32 v48, v48, v48
  v_lshlrev_b32 v48, 16, v48
  v_mov_b32 v49, v48
  s_nop 1
  v_permlane32_swap_b32 v48, v49
  v_rcp_f32 v48, v48
  v_cvt_pk_bf16_f32 v50, v32, v33
  v_cvt_pk_bf16_f32 v51, v34, v35
  v_cvt_pk_bf16_f32 v52, v36, v37
  v_cvt_pk_bf16_f32 v53, v38, v39
  v_cvt_pk_bf16_f32 v54, v40, v41
  v_mov_b32 v49, v48
  v_lshlrev_b32 v32, 16, v50
  v_and_b32 v33, 0xffff0000, v50
  v_lshlrev_b32 v34, 16, v51
  v_and_b32 v35, 0xffff0000, v51
  v_lshlrev_b32 v36, 16, v52
  v_and_b32 v37, 0xffff0000, v52
  v_lshlrev_b32 v38, 16, v53
  v_and_b32 v39, 0xffff0000, v53
  v_lshlrev_b32 v40, 16, v54
  v_and_b32 v41, 0xffff0000, v54
  v_pk_mul_f32 v[32:33], v[32:33], v[48:49]
  v_pk_mul_f32 v[34:35], v[34:35], v[48:49]
  v_pk_mul_f32 v[36:37], v[36:37], v[48:49]
  v_pk_mul_f32 v[38:39], v[38:39], v[48:49]
  v_pk_mul_f32 v[40:41], v[40:41], v[48:49]
  v_cvt_pk_bf16_f32 v50, v32, v33
  v_cvt_pk_bf16_f32 v51, v34, v35
  v_cvt_pk_bf16_f32 v52, v36, v37
  v_cvt_pk_bf16_f32 v53, v38, v39
  v_cvt_pk_bf16_f32 v54, v40, v41
  ds_write_b64 v7, v[50:51] offset:37412
  ds_write_b64 v7, v[52:53] offset:37428
  s_mov_b64 exec, s[76:77]
  ds_write_b32 v7, v54 offset:37444
  s_mov_b64 exec, -1
  v_mfma_f32_32x32x16_bf16 v[32:47], v[132:135], v[236:239], 0
  v_mfma_f32_32x32x16_bf16 v[32:47], v[136:139], v[240:243], v[32:47]
  v_mfma_f32_32x32x16_bf16 v[32:47], v[140:143], v[244:247], v[32:47]
  v_cvt_pk_bf16_f32 v48, v26, v26
  v_lshlrev_b32 v48, 16, v48
  v_add_f32 v48, s72, v48
  v_cvt_pk_bf16_f32 v48, v48, v48
  v_lshlrev_b32 v48, 16, v48
  v_mov_b32 v49, v48
  s_nop 1
  v_permlane32_swap_b32 v48, v49
  v_rcp_f32 v48, v48
  v_cvt_pk_bf16_f32 v50, v16, v17
  v_cvt_pk_bf16_f32 v51, v18, v19
  v_cvt_pk_bf16_f32 v52, v20, v21
  v_cvt_pk_bf16_f32 v53, v22, v23
  v_cvt_pk_bf16_f32 v54, v24, v25
  v_mov_b32 v49, v48
  v_lshlrev_b32 v16, 16, v50
  v_and_b32 v17, 0xffff0000, v50
  v_lshlrev_b32 v18, 16, v51
  v_and_b32 v19, 0xffff0000, v51
  v_lshlrev_b32 v20, 16, v52
  v_and_b32 v21, 0xffff0000, v52
  v_lshlrev_b32 v22, 16, v53
  v_and_b32 v23, 0xffff0000, v53
  v_lshlrev_b32 v24, 16, v54
  v_and_b32 v25, 0xffff0000, v54
  v_pk_mul_f32 v[16:17], v[16:17], v[48:49]
  v_pk_mul_f32 v[18:19], v[18:19], v[48:49]
  v_pk_mul_f32 v[20:21], v[20:21], v[48:49]
  v_pk_mul_f32 v[22:23], v[22:23], v[48:49]
  v_pk_mul_f32 v[24:25], v[24:25], v[48:49]
  v_cvt_pk_bf16_f32 v50, v16, v17
  v_cvt_pk_bf16_f32 v51, v18, v19
  v_cvt_pk_bf16_f32 v52, v20, v21
  v_cvt_pk_bf16_f32 v53, v22, v23
  v_cvt_pk_bf16_f32 v54, v24, v25
  ds_write_b64 v7, v[50:51] offset:37448
  ds_write_b64 v7, v[52:53] offset:37464
  s_mov_b64 exec, s[76:77]
  ds_write_b32 v7, v54 offset:37480
  s_mov_b64 exec, -1
  v_cvt_pk_bf16_f32 v48, v42, v42
  v_lshlrev_b32 v48, 16, v48
  v_add_f32 v48, s72, v48
  v_cvt_pk_bf16_f32 v48, v48, v48
  v_lshlrev_b32 v48, 16, v48
  v_mov_b32 v49, v48
  s_nop 1
  v_permlane32_swap_b32 v48, v49
  v_rcp_f32 v48, v48
  v_cvt_pk_bf16_f32 v50, v32, v33
  v_cvt_pk_bf16_f32 v51, v34, v35
  v_cvt_pk_bf16_f32 v52, v36, v37
  v_cvt_pk_bf16_f32 v53, v38, v39
  v_cvt_pk_bf16_f32 v54, v40, v41
  v_mov_b32 v49, v48
  v_lshlrev_b32 v32, 16, v50
  v_and_b32 v33, 0xffff0000, v50
  v_lshlrev_b32 v34, 16, v51
  v_and_b32 v35, 0xffff0000, v51
  v_lshlrev_b32 v36, 16, v52
  v_and_b32 v37, 0xffff0000, v52
  v_lshlrev_b32 v38, 16, v53
  v_and_b32 v39, 0xffff0000, v53
  v_lshlrev_b32 v40, 16, v54
  v_and_b32 v41, 0xffff0000, v54
  v_pk_mul_f32 v[32:33], v[32:33], v[48:49]
  v_pk_mul_f32 v[34:35], v[34:35], v[48:49]
  v_pk_mul_f32 v[36:37], v[36:37], v[48:49]
  v_pk_mul_f32 v[38:39], v[38:39], v[48:49]
  v_pk_mul_f32 v[40:41], v[40:41], v[48:49]
  v_cvt_pk_bf16_f32 v50, v32, v33
  v_cvt_pk_bf16_f32 v51, v34, v35
  v_cvt_pk_bf16_f32 v52, v36, v37
  v_cvt_pk_bf16_f32 v53, v38, v39
  v_cvt_pk_bf16_f32 v54, v40, v41
  ds_write_b64 v7, v[50:51] offset:37484
  ds_write_b64 v7, v[52:53] offset:37500
  s_mov_b64 exec, s[76:77]
  ds_write_b32 v7, v54 offset:37516
  s_mov_b64 exec, -1
  s_cmp_ge_u32 s46, 4
  s_cbranch_scc1 K2_IDLE_B
  s_lshr_b32 s52, s46, 1
  s_mul_i32 s52, s52, 3
  s_mul_i32 s53, s45, 6
  s_add_u32 s52, s52, s53
  s_add_u32 s52, s52, 36
  s_mul_i32 s55, s52, 18432
  s_and_b32 s53, s46, 1
  s_mul_i32 s54, s53, 9216
  s_add_u32 s55, s55, s54
  s_add_u32 s55, s55, 7340032
  s_mul_i32 s57, s53, 576
  s_add_u32 s56, s55, 0
  buffer_load_dwordx4 v[176:179], v6, s[16:19], s56 offen
  s_add_u32 s56, s55, 18432
  buffer_load_dwordx4 v[180:183], v6, s[16:19], s56 offen
  s_add_u32 s56, s55, 36864
  buffer_load_dwordx4 v[184:187], v6, s[16:19], s56 offen
  s_add_u32 s56, s55, 1024
  buffer_load_dwordx4 v[188:191], v6, s[16:19], s56 offen
  s_add_u32 s56, s55, 19456
  buffer_load_dwordx4 v[192:195], v6, s[16:19], s56 offen
  s_add_u32 s56, s55, 37888
  buffer_load_dwordx4 v[196:199], v6, s[16:19], s56 offen
  s_add_u32 s56, s55, 2048
  buffer_load_dwordx4 v[200:203], v6, s[16:19], s56 offen
  s_add_u32 s56, s55, 20480
  buffer_load_dwordx4 v[204:207], v6, s[16:19], s56 offen
  s_add_u32 s56, s55, 38912
  buffer_load_dwordx4 v[208:211], v6, s[16:19], s56 offen
  s_waitcnt lgkmcnt(0)
  s_barrier
  ds_read_b128 v[64:67], v14 offset:0
  ds_read_b128 v[68:71], v14 offset:18688
  ds_read_b128 v[72:75], v15 offset:0
  ds_read_b128 v[76:79], v15 offset:18688
  s_add_u32 s56, s55, 3072
  buffer_load_dwordx4 v[212:215], v6, s[16:19], s56 offen
  s_add_u32 s56, s55, 21504
  buffer_load_dwordx4 v[216:219], v6, s[16:19], s56 offen
  s_add_u32 s56, s55, 39936
  buffer_load_dwordx4 v[220:223], v6, s[16:19], s56 offen
  ds_read_b128 v[80:83], v14 offset:64
  ds_read_b128 v[84:87], v14 offset:18752
  ds_read_b128 v[88:91], v15 offset:64
  ds_read_b128 v[92:95], v15 offset:18752
  s_waitcnt vmcnt(11) lgkmcnt(7)
  v_mfma_f32_16x16x32_bf16 v[16:19], v[176:179], v[64:67], 0
  s_waitcnt vmcnt(10)
  v_mfma_f32_16x16x32_bf16 v[20:23], v[180:183], v[64:67], 0
  s_waitcnt vmcnt(9)
  v_mfma_f32_16x16x32_bf16 v[24:27], v[184:187], v[64:67], 0
  s_waitcnt lgkmcnt(6)
  v_mfma_f32_16x16x32_bf16 v[28:31], v[176:179], v[68:71], 0
  v_mfma_f32_16x16x32_bf16 v[32:35], v[180:183], v[68:71], 0
  v_mfma_f32_16x16x32_bf16 v[36:39], v[184:187], v[68:71], 0
  s_waitcnt lgkmcnt(5)
  v_mfma_f32_16x16x32_bf16 v[40:43], v[176:179], v[72:75], 0
  v_mfma_f32_16x16x32_bf16 v[44:47], v[180:183], v[72:75], 0
  v_mfma_f32_16x16x32_bf16 v[48:51], v[184:187], v[72:75], 0
  s_waitcnt lgkmcnt(4)
  v_mfma_f32_16x16x32_bf16 v[52:55], v[176:179], v[76:79], 0
  v_mfma_f32_16x16x32_bf16 v[56:59], v[180:183], v[76:79], 0
  v_mfma_f32_16x16x32_bf16 v[60:63], v[184:187], v[76:79], 0
  s_add_u32 s56, s55, 4096
  buffer_load_dwordx4 v[176:179], v6, s[16:19], s56 offen
  s_add_u32 s56, s55, 22528
  buffer_load_dwordx4 v[180:183], v6, s[16:19], s56 offen
  s_add_u32 s56, s55, 40960
  buffer_load_dwordx4 v[184:187], v6, s[16:19], s56 offen
  ds_read_b128 v[64:67], v14 offset:128
  ds_read_b128 v[68:71], v14 offset:18816
  ds_read_b128 v[72:75], v15 offset:128
  ds_read_b128 v[76:79], v15 offset:18816
  s_waitcnt vmcnt(11) lgkmcnt(7)
  v_mfma_f32_16x16x32_bf16 v[16:19], v[188:191], v[80:83], v[16:19]
  s_waitcnt vmcnt(10)
  v_mfma_f32_16x16x32_bf16 v[20:23], v[192:195], v[80:83], v[20:23]
  s_waitcnt vmcnt(9)
  v_mfma_f32_16x16x32_bf16 v[24:27], v[196:199], v[80:83], v[24:27]
  s_waitcnt lgkmcnt(6)
  v_mfma_f32_16x16x32_bf16 v[28:31], v[188:191], v[84:87], v[28:31]
  v_mfma_f32_16x16x32_bf16 v[32:35], v[192:195], v[84:87], v[32:35]
  v_mfma_f32_16x16x32_bf16 v[36:39], v[196:199], v[84:87], v[36:39]
  s_waitcnt lgkmcnt(5)
  v_mfma_f32_16x16x32_bf16 v[40:43], v[188:191], v[88:91], v[40:43]
  v_mfma_f32_16x16x32_bf16 v[44:47], v[192:195], v[88:91], v[44:47]
  v_mfma_f32_16x16x32_bf16 v[48:51], v[196:199], v[88:91], v[48:51]
  s_waitcnt lgkmcnt(4)
  v_mfma_f32_16x16x32_bf16 v[52:55], v[188:191], v[92:95], v[52:55]
  v_mfma_f32_16x16x32_bf16 v[56:59], v[192:195], v[92:95], v[56:59]
  v_mfma_f32_16x16x32_bf16 v[60:63], v[196:199], v[92:95], v[60:63]
  s_add_u32 s56, s55, 5120
  buffer_load_dwordx4 v[188:191], v6, s[16:19], s56 offen
  s_add_u32 s56, s55, 23552
  buffer_load_dwordx4 v[192:195], v6, s[16:19], s56 offen
  s_add_u32 s56, s55, 41984
  buffer_load_dwordx4 v[196:199], v6, s[16:19], s56 offen
  ds_read_b128 v[80:83], v14 offset:192
  ds_read_b128 v[84:87], v14 offset:18880
  ds_read_b128 v[88:91], v15 offset:192
  ds_read_b128 v[92:95], v15 offset:18880
  s_waitcnt vmcnt(11) lgkmcnt(7)
  v_mfma_f32_16x16x32_bf16 v[16:19], v[200:203], v[64:67], v[16:19]
  s_waitcnt vmcnt(10)
  v_mfma_f32_16x16x32_bf16 v[20:23], v[204:207], v[64:67], v[20:23]
  s_waitcnt vmcnt(9)
  v_mfma_f32_16x16x32_bf16 v[24:27], v[208:211], v[64:67], v[24:27]
  s_waitcnt lgkmcnt(6)
  v_mfma_f32_16x16x32_bf16 v[28:31], v[200:203], v[68:71], v[28:31]
  v_mfma_f32_16x16x32_bf16 v[32:35], v[204:207], v[68:71], v[32:35]
  v_mfma_f32_16x16x32_bf16 v[36:39], v[208:211], v[68:71], v[36:39]
  s_waitcnt lgkmcnt(5)
  v_mfma_f32_16x16x32_bf16 v[40:43], v[200:203], v[72:75], v[40:43]
  v_mfma_f32_16x16x32_bf16 v[44:47], v[204:207], v[72:75], v[44:47]
  v_mfma_f32_16x16x32_bf16 v[48:51], v[208:211], v[72:75], v[48:51]
  s_waitcnt lgkmcnt(4)
  v_mfma_f32_16x16x32_bf16 v[52:55], v[200:203], v[76:79], v[52:55]
  v_mfma_f32_16x16x32_bf16 v[56:59], v[204:207], v[76:79], v[56:59]
  v_mfma_f32_16x16x32_bf16 v[60:63], v[208:211], v[76:79], v[60:63]
  s_add_u32 s56, s55, 6144
  buffer_load_dwordx4 v[200:203], v6, s[16:19], s56 offen
  s_add_u32 s56, s55, 24576
  buffer_load_dwordx4 v[204:207], v6, s[16:19], s56 offen
  s_add_u32 s56, s55, 43008
  buffer_load_dwordx4 v[208:211], v6, s[16:19], s56 offen
  ds_read_b128 v[64:67], v14 offset:256
  ds_read_b128 v[68:71], v14 offset:18944
  ds_read_b128 v[72:75], v15 offset:256
  ds_read_b128 v[76:79], v15 offset:18944
  s_waitcnt vmcnt(11) lgkmcnt(7)
  v_mfma_f32_16x16x32_bf16 v[16:19], v[212:215], v[80:83], v[16:19]
  s_waitcnt vmcnt(10)
  v_mfma_f32_16x16x32_bf16 v[20:23], v[216:219], v[80:83], v[20:23]
  s_waitcnt vmcnt(9)
  v_mfma_f32_16x16x32_bf16 v[24:27], v[220:223], v[80:83], v[24:27]
  s_waitcnt lgkmcnt(6)
  v_mfma_f32_16x16x32_bf16 v[28:31], v[212:215], v[84:87], v[28:31]
  v_mfma_f32_16x16x32_bf16 v[32:35], v[216:219], v[84:87], v[32:35]
  v_mfma_f32_16x16x32_bf16 v[36:39], v[220:223], v[84:87], v[36:39]
  s_waitcnt lgkmcnt(5)
  v_mfma_f32_16x16x32_bf16 v[40:43], v[212:215], v[88:91], v[40:43]
  v_mfma_f32_16x16x32_bf16 v[44:47], v[216:219], v[88:91], v[44:47]
  v_mfma_f32_16x16x32_bf16 v[48:51], v[220:223], v[88:91], v[48:51]
  s_waitcnt lgkmcnt(4)
  v_mfma_f32_16x16x32_bf16 v[52:55], v[212:215], v[92:95], v[52:55]
  v_mfma_f32_16x16x32_bf16 v[56:59], v[216:219], v[92:95], v[56:59]
  v_mfma_f32_16x16x32_bf16 v[60:63], v[220:223], v[92:95], v[60:63]
  s_add_u32 s56, s55, 7168
  buffer_load_dwordx4 v[212:215], v6, s[16:19], s56 offen
  s_add_u32 s56, s55, 25600
  buffer_load_dwordx4 v[216:219], v6, s[16:19], s56 offen
  s_add_u32 s56, s55, 44032
  buffer_load_dwordx4 v[220:223], v6, s[16:19], s56 offen
  ds_read_b128 v[80:83], v14 offset:320
  ds_read_b128 v[84:87], v14 offset:19008
  ds_read_b128 v[88:91], v15 offset:320
  ds_read_b128 v[92:95], v15 offset:19008
  s_waitcnt vmcnt(11) lgkmcnt(7)
  v_mfma_f32_16x16x32_bf16 v[16:19], v[176:179], v[64:67], v[16:19]
  s_waitcnt vmcnt(10)
  v_mfma_f32_16x16x32_bf16 v[20:23], v[180:183], v[64:67], v[20:23]
  s_waitcnt vmcnt(9)
  v_mfma_f32_16x16x32_bf16 v[24:27], v[184:187], v[64:67], v[24:27]
  s_waitcnt lgkmcnt(6)
  v_mfma_f32_16x16x32_bf16 v[28:31], v[176:179], v[68:71], v[28:31]
  v_mfma_f32_16x16x32_bf16 v[32:35], v[180:183], v[68:71], v[32:35]
  v_mfma_f32_16x16x32_bf16 v[36:39], v[184:187], v[68:71], v[36:39]
  s_waitcnt lgkmcnt(5)
  v_mfma_f32_16x16x32_bf16 v[40:43], v[176:179], v[72:75], v[40:43]
  v_mfma_f32_16x16x32_bf16 v[44:47], v[180:183], v[72:75], v[44:47]
  v_mfma_f32_16x16x32_bf16 v[48:51], v[184:187], v[72:75], v[48:51]
  s_waitcnt lgkmcnt(4)
  v_mfma_f32_16x16x32_bf16 v[52:55], v[176:179], v[76:79], v[52:55]
  v_mfma_f32_16x16x32_bf16 v[56:59], v[180:183], v[76:79], v[56:59]
  v_mfma_f32_16x16x32_bf16 v[60:63], v[184:187], v[76:79], v[60:63]
  s_add_u32 s56, s55, 8192
  buffer_load_dwordx4 v[176:179], v6, s[16:19], s56 offen
  s_add_u32 s56, s55, 26624
  buffer_load_dwordx4 v[180:183], v6, s[16:19], s56 offen
  s_add_u32 s56, s55, 45056
  buffer_load_dwordx4 v[184:187], v6, s[16:19], s56 offen
  ds_read_b128 v[64:67], v14 offset:384
  ds_read_b128 v[68:71], v14 offset:19072
  ds_read_b128 v[72:75], v15 offset:384
  ds_read_b128 v[76:79], v15 offset:19072
  s_waitcnt vmcnt(11) lgkmcnt(7)
  v_mfma_f32_16x16x32_bf16 v[16:19], v[188:191], v[80:83], v[16:19]
  s_waitcnt vmcnt(10)
  v_mfma_f32_16x16x32_bf16 v[20:23], v[192:195], v[80:83], v[20:23]
  s_waitcnt vmcnt(9)
  v_mfma_f32_16x16x32_bf16 v[24:27], v[196:199], v[80:83], v[24:27]
  s_waitcnt lgkmcnt(6)
  v_mfma_f32_16x16x32_bf16 v[28:31], v[188:191], v[84:87], v[28:31]
  v_mfma_f32_16x16x32_bf16 v[32:35], v[192:195], v[84:87], v[32:35]
  v_mfma_f32_16x16x32_bf16 v[36:39], v[196:199], v[84:87], v[36:39]
  s_waitcnt lgkmcnt(5)
  v_mfma_f32_16x16x32_bf16 v[40:43], v[188:191], v[88:91], v[40:43]
  v_mfma_f32_16x16x32_bf16 v[44:47], v[192:195], v[88:91], v[44:47]
  v_mfma_f32_16x16x32_bf16 v[48:51], v[196:199], v[88:91], v[48:51]
  s_waitcnt lgkmcnt(4)
  v_mfma_f32_16x16x32_bf16 v[52:55], v[188:191], v[92:95], v[52:55]
  v_mfma_f32_16x16x32_bf16 v[56:59], v[192:195], v[92:95], v[56:59]
  v_mfma_f32_16x16x32_bf16 v[60:63], v[196:199], v[92:95], v[60:63]
  ds_read_b128 v[80:83], v14 offset:448
  ds_read_b128 v[84:87], v14 offset:19136
  ds_read_b128 v[88:91], v15 offset:448
  ds_read_b128 v[92:95], v15 offset:19136
  s_waitcnt vmcnt(8) lgkmcnt(7)
  v_mfma_f32_16x16x32_bf16 v[16:19], v[200:203], v[64:67], v[16:19]
  s_waitcnt vmcnt(7)
  v_mfma_f32_16x16x32_bf16 v[20:23], v[204:207], v[64:67], v[20:23]
  s_waitcnt vmcnt(6)
  v_mfma_f32_16x16x32_bf16 v[24:27], v[208:211], v[64:67], v[24:27]
  s_waitcnt lgkmcnt(6)
  v_mfma_f32_16x16x32_bf16 v[28:31], v[200:203], v[68:71], v[28:31]
  v_mfma_f32_16x16x32_bf16 v[32:35], v[204:207], v[68:71], v[32:35]
  v_mfma_f32_16x16x32_bf16 v[36:39], v[208:211], v[68:71], v[36:39]
  s_waitcnt lgkmcnt(5)
  v_mfma_f32_16x16x32_bf16 v[40:43], v[200:203], v[72:75], v[40:43]
  v_mfma_f32_16x16x32_bf16 v[44:47], v[204:207], v[72:75], v[44:47]
  v_mfma_f32_16x16x32_bf16 v[48:51], v[208:211], v[72:75], v[48:51]
  s_waitcnt lgkmcnt(4)
  v_mfma_f32_16x16x32_bf16 v[52:55], v[200:203], v[76:79], v[52:55]
  v_mfma_f32_16x16x32_bf16 v[56:59], v[204:207], v[76:79], v[56:59]
  v_mfma_f32_16x16x32_bf16 v[60:63], v[208:211], v[76:79], v[60:63]
  ds_read_b128 v[64:67], v14 offset:512
  ds_read_b128 v[68:71], v14 offset:19200
  ds_read_b128 v[72:75], v15 offset:512
  ds_read_b128 v[76:79], v15 offset:19200
  s_waitcnt vmcnt(5) lgkmcnt(7)
  v_mfma_f32_16x16x32_bf16 v[16:19], v[212:215], v[80:83], v[16:19]
  s_waitcnt vmcnt(4)
  v_mfma_f32_16x16x32_bf16 v[20:23], v[216:219], v[80:83], v[20:23]
  s_waitcnt vmcnt(3)
  v_mfma_f32_16x16x32_bf16 v[24:27], v[220:223], v[80:83], v[24:27]
  s_waitcnt lgkmcnt(6)
  v_mfma_f32_16x16x32_bf16 v[28:31], v[212:215], v[84:87], v[28:31]
  v_mfma_f32_16x16x32_bf16 v[32:35], v[216:219], v[84:87], v[32:35]
  v_mfma_f32_16x16x32_bf16 v[36:39], v[220:223], v[84:87], v[36:39]
  s_waitcnt lgkmcnt(5)
  v_mfma_f32_16x16x32_bf16 v[40:43], v[212:215], v[88:91], v[40:43]
  v_mfma_f32_16x16x32_bf16 v[44:47], v[216:219], v[88:91], v[44:47]
  v_mfma_f32_16x16x32_bf16 v[48:51], v[220:223], v[88:91], v[48:51]
  s_waitcnt lgkmcnt(4)
  v_mfma_f32_16x16x32_bf16 v[52:55], v[212:215], v[92:95], v[52:55]
  v_mfma_f32_16x16x32_bf16 v[56:59], v[216:219], v[92:95], v[56:59]
  v_mfma_f32_16x16x32_bf16 v[60:63], v[220:223], v[92:95], v[60:63]
  s_waitcnt vmcnt(2) lgkmcnt(3)
  v_mfma_f32_16x16x32_bf16 v[16:19], v[176:179], v[64:67], v[16:19]
  s_waitcnt vmcnt(1)
  v_mfma_f32_16x16x32_bf16 v[20:23], v[180:183], v[64:67], v[20:23]
  s_waitcnt vmcnt(0)
  v_mfma_f32_16x16x32_bf16 v[24:27], v[184:187], v[64:67], v[24:27]
  s_waitcnt lgkmcnt(2)
  v_mfma_f32_16x16x32_bf16 v[28:31], v[176:179], v[68:71], v[28:31]
  v_mfma_f32_16x16x32_bf16 v[32:35], v[180:183], v[68:71], v[32:35]
  v_mfma_f32_16x16x32_bf16 v[36:39], v[184:187], v[68:71], v[36:39]
  s_waitcnt lgkmcnt(1)
  v_mfma_f32_16x16x32_bf16 v[40:43], v[176:179], v[72:75], v[40:43]
  v_mfma_f32_16x16x32_bf16 v[44:47], v[180:183], v[72:75], v[44:47]
  v_mfma_f32_16x16x32_bf16 v[48:51], v[184:187], v[72:75], v[48:51]
  s_waitcnt lgkmcnt(0)
  v_mfma_f32_16x16x32_bf16 v[52:55], v[176:179], v[76:79], v[52:55]
  v_mfma_f32_16x16x32_bf16 v[56:59], v[180:183], v[76:79], v[56:59]
  v_mfma_f32_16x16x32_bf16 v[60:63], v[184:187], v[76:79], v[60:63]
  s_and_b32 s53, s46, 1
  s_lshl_b32 s53, s53, 5
  s_add_u32 s53, s53, s47
  s_lshl_b32 s54, s53, 2
  s_add_u32 s54, s54, 7274496
  v_lshlrev_b32 v10, 2, v12
  buffer_load_dword v224, v10, s[16:19], s54 offen
  buffer_load_dword v226, v10, s[16:19], s54 offen offset:64
  s_mul_i32 s52, s46, 6144
  s_add_u32 s52, s52, 74752
  v_add_u32 v9, s52, v6
  ds_write_b128 v9, v[40:43] offset:0
  ds_write_b128 v9, v[44:47] offset:1024
  ds_write_b128 v9, v[48:51] offset:2048
  ds_write_b128 v9, v[52:55] offset:3072
  ds_write_b128 v9, v[56:59] offset:4096
  ds_write_b128 v9, v[60:63] offset:5120
  s_waitcnt lgkmcnt(0)
  s_barrier
  s_xor_b32 s52, s46, 1
  s_mul_i32 s52, s52, 6144
  s_add_u32 s52, s52, 74752
  v_add_u32 v9, s52, v6
  ds_read_b128 v[64:67], v9 offset:0
  ds_read_b128 v[68:71], v9 offset:1024
  ds_read_b128 v[72:75], v9 offset:2048
  ds_read_b128 v[76:79], v9 offset:3072
  ds_read_b128 v[80:83], v9 offset:4096
  ds_read_b128 v[84:87], v9 offset:5120
  s_waitcnt lgkmcnt(5)
  v_add_f32 v16, v16, v64
  v_add_f32 v17, v17, v65
  v_add_f32 v18, v18, v66
  v_add_f32 v19, v19, v67
  s_waitcnt lgkmcnt(4)
  v_add_f32 v20, v20, v68
  v_add_f32 v21, v21, v69
  v_add_f32 v22, v22, v70
  v_add_f32 v23, v23, v71
  s_waitcnt lgkmcnt(3)
  v_add_f32 v24, v24, v72
  v_add_f32 v25, v25, v73
  v_add_f32 v26, v26, v74
  v_add_f32 v27, v27, v75
  s_waitcnt lgkmcnt(2)
  v_add_f32 v28, v28, v76
  v_add_f32 v29, v29, v77
  v_add_f32 v30, v30, v78
  v_add_f32 v31, v31, v79
  s_waitcnt lgkmcnt(1)
  v_add_f32 v32, v32, v80
  v_add_f32 v33, v33, v81
  v_add_f32 v34, v34, v82
  v_add_f32 v35, v35, v83
  s_waitcnt lgkmcnt(0)
  v_add_f32 v36, v36, v84
  v_add_f32 v37, v37, v85
  v_add_f32 v38, v38, v86
  v_add_f32 v39, v39, v87
  s_waitcnt vmcnt(1)
  v_mov_b32 v225, v224
  v_sub_f32 v228, 1.0, v224
  v_cvt_pk_bf16_f32 v228, v228, v228
  v_lshlrev_b32 v228, 16, v228
  v_mov_b32 v229, v228
  s_waitcnt vmcnt(0)
  v_mov_b32 v227, v226
  v_sub_f32 v230, 1.0, v226
  v_cvt_pk_bf16_f32 v230, v230, v230
  v_lshlrev_b32 v230, 16, v230
  v_mov_b32 v231, v230
  v_mul_u32_u24 v9, 1152, v12
  v_lshl_add_u32 v9, v13, 3, v9
  s_mul_i32 s54, s53, 1152
  s_mul_i32 s52, s45, 192
  s_add_u32 s54, s54, s52
  s_lshr_b32 s52, s46, 1
  s_mul_i32 s52, s52, 96
  s_add_u32 s54, s54, s52
  v_lshlrev_b32 v232, 16, v144
  v_and_b32 v233, 0xffff0000, v144
  v_cvt_pk_bf16_f32 v236, v16, v17
  v_pk_mul_f32 v[232:233], v[232:233], v[224:225]
  v_lshlrev_b32 v234, 16, v236
  v_and_b32 v235, 0xffff0000, v236
  v_cvt_pk_bf16_f32 v236, v232, v233
  v_pk_mul_f32 v[234:235], v[234:235], v[228:229]
  v_lshlrev_b32 v232, 16, v236
  v_and_b32 v233, 0xffff0000, v236
  v_cvt_pk_bf16_f32 v236, v234, v235
  v_lshlrev_b32 v234, 16, v236
  v_and_b32 v235, 0xffff0000, v236
  v_pk_add_f32 v[232:233], v[232:233], v[234:235]
  v_cvt_pk_bf16_f32 v16, v232, v233
  v_lshlrev_b32 v232, 16, v145
  v_and_b32 v233, 0xffff0000, v145
  v_cvt_pk_bf16_f32 v236, v18, v19
  v_pk_mul_f32 v[232:233], v[232:233], v[224:225]
  v_lshlrev_b32 v234, 16, v236
  v_and_b32 v235, 0xffff0000, v236
  v_cvt_pk_bf16_f32 v236, v232, v233
  v_pk_mul_f32 v[234:235], v[234:235], v[228:229]
  v_lshlrev_b32 v232, 16, v236
  v_and_b32 v233, 0xffff0000, v236
  v_cvt_pk_bf16_f32 v236, v234, v235
  v_lshlrev_b32 v234, 16, v236
  v_and_b32 v235, 0xffff0000, v236
  v_pk_add_f32 v[232:233], v[232:233], v[234:235]
  v_cvt_pk_bf16_f32 v17, v232, v233
  buffer_store_dwordx2 v[16:17], v9, s[8:11], s54 offen offset:0
  v_lshlrev_b32 v232, 16, v146
  v_and_b32 v233, 0xffff0000, v146
  v_cvt_pk_bf16_f32 v236, v20, v21
  v_pk_mul_f32 v[232:233], v[232:233], v[224:225]
  v_lshlrev_b32 v234, 16, v236
  v_and_b32 v235, 0xffff0000, v236
  v_cvt_pk_bf16_f32 v236, v232, v233
  v_pk_mul_f32 v[234:235], v[234:235], v[228:229]
  v_lshlrev_b32 v232, 16, v236
  v_and_b32 v233, 0xffff0000, v236
  v_cvt_pk_bf16_f32 v236, v234, v235
  v_lshlrev_b32 v234, 16, v236
  v_and_b32 v235, 0xffff0000, v236
  v_pk_add_f32 v[232:233], v[232:233], v[234:235]
  v_cvt_pk_bf16_f32 v20, v232, v233
  v_lshlrev_b32 v232, 16, v147
  v_and_b32 v233, 0xffff0000, v147
  v_cvt_pk_bf16_f32 v236, v22, v23
  v_pk_mul_f32 v[232:233], v[232:233], v[224:225]
  v_lshlrev_b32 v234, 16, v236
  v_and_b32 v235, 0xffff0000, v236
  v_cvt_pk_bf16_f32 v236, v232, v233
  v_pk_mul_f32 v[234:235], v[234:235], v[228:229]
  v_lshlrev_b32 v232, 16, v236
  v_and_b32 v233, 0xffff0000, v236
  v_cvt_pk_bf16_f32 v236, v234, v235
  v_lshlrev_b32 v234, 16, v236
  v_and_b32 v235, 0xffff0000, v236
  v_pk_add_f32 v[232:233], v[232:233], v[234:235]
  v_cvt_pk_bf16_f32 v21, v232, v233
  buffer_store_dwordx2 v[20:21], v9, s[8:11], s54 offen offset:32
  v_lshlrev_b32 v232, 16, v148
  v_and_b32 v233, 0xffff0000, v148
  v_cvt_pk_bf16_f32 v236, v24, v25
  v_pk_mul_f32 v[232:233], v[232:233], v[224:225]
  v_lshlrev_b32 v234, 16, v236
  v_and_b32 v235, 0xffff0000, v236
  v_cvt_pk_bf16_f32 v236, v232, v233
  v_pk_mul_f32 v[234:235], v[234:235], v[228:229]
  v_lshlrev_b32 v232, 16, v236
  v_and_b32 v233, 0xffff0000, v236
  v_cvt_pk_bf16_f32 v236, v234, v235
  v_lshlrev_b32 v234, 16, v236
  v_and_b32 v235, 0xffff0000, v236
  v_pk_add_f32 v[232:233], v[232:233], v[234:235]
  v_cvt_pk_bf16_f32 v24, v232, v233
  v_lshlrev_b32 v232, 16, v149
  v_and_b32 v233, 0xffff0000, v149
  v_cvt_pk_bf16_f32 v236, v26, v27
  v_pk_mul_f32 v[232:233], v[232:233], v[224:225]
  v_lshlrev_b32 v234, 16, v236
  v_and_b32 v235, 0xffff0000, v236
  v_cvt_pk_bf16_f32 v236, v232, v233
  v_pk_mul_f32 v[234:235], v[234:235], v[228:229]
  v_lshlrev_b32 v232, 16, v236
  v_and_b32 v233, 0xffff0000, v236
  v_cvt_pk_bf16_f32 v236, v234, v235
  v_lshlrev_b32 v234, 16, v236
  v_and_b32 v235, 0xffff0000, v236
  v_pk_add_f32 v[232:233], v[232:233], v[234:235]
  v_cvt_pk_bf16_f32 v25, v232, v233
  buffer_store_dwordx2 v[24:25], v9, s[8:11], s54 offen offset:64
  s_add_u32 s54, s54, 18432
  v_lshlrev_b32 v232, 16, v150
  v_and_b32 v233, 0xffff0000, v150
  v_cvt_pk_bf16_f32 v236, v28, v29
  v_pk_mul_f32 v[232:233], v[232:233], v[226:227]
  v_lshlrev_b32 v234, 16, v236
  v_and_b32 v235, 0xffff0000, v236
  v_cvt_pk_bf16_f32 v236, v232, v233
  v_pk_mul_f32 v[234:235], v[234:235], v[230:231]
  v_lshlrev_b32 v232, 16, v236
  v_and_b32 v233, 0xffff0000, v236
  v_cvt_pk_bf16_f32 v236, v234, v235
  v_lshlrev_b32 v234, 16, v236
  v_and_b32 v235, 0xffff0000, v236
  v_pk_add_f32 v[232:233], v[232:233], v[234:235]
  v_cvt_pk_bf16_f32 v28, v232, v233
  v_lshlrev_b32 v232, 16, v151
  v_and_b32 v233, 0xffff0000, v151
  v_cvt_pk_bf16_f32 v236, v30, v31
  v_pk_mul_f32 v[232:233], v[232:233], v[226:227]
  v_lshlrev_b32 v234, 16, v236
  v_and_b32 v235, 0xffff0000, v236
  v_cvt_pk_bf16_f32 v236, v232, v233
  v_pk_mul_f32 v[234:235], v[234:235], v[230:231]
  v_lshlrev_b32 v232, 16, v236
  v_and_b32 v233, 0xffff0000, v236
  v_cvt_pk_bf16_f32 v236, v234, v235
  v_lshlrev_b32 v234, 16, v236
  v_and_b32 v235, 0xffff0000, v236
  v_pk_add_f32 v[232:233], v[232:233], v[234:235]
  v_cvt_pk_bf16_f32 v29, v232, v233
  buffer_store_dwordx2 v[28:29], v9, s[8:11], s54 offen offset:0
  v_lshlrev_b32 v232, 16, v152
  v_and_b32 v233, 0xffff0000, v152
  v_cvt_pk_bf16_f32 v236, v32, v33
  v_pk_mul_f32 v[232:233], v[232:233], v[226:227]
  v_lshlrev_b32 v234, 16, v236
  v_and_b32 v235, 0xffff0000, v236
  v_cvt_pk_bf16_f32 v236, v232, v233
  v_pk_mul_f32 v[234:235], v[234:235], v[230:231]
  v_lshlrev_b32 v232, 16, v236
  v_and_b32 v233, 0xffff0000, v236
  v_cvt_pk_bf16_f32 v236, v234, v235
  v_lshlrev_b32 v234, 16, v236
  v_and_b32 v235, 0xffff0000, v236
  v_pk_add_f32 v[232:233], v[232:233], v[234:235]
  v_cvt_pk_bf16_f32 v32, v232, v233
  v_lshlrev_b32 v232, 16, v153
  v_and_b32 v233, 0xffff0000, v153
  v_cvt_pk_bf16_f32 v236, v34, v35
  v_pk_mul_f32 v[232:233], v[232:233], v[226:227]
  v_lshlrev_b32 v234, 16, v236
  v_and_b32 v235, 0xffff0000, v236
  v_cvt_pk_bf16_f32 v236, v232, v233
  v_pk_mul_f32 v[234:235], v[234:235], v[230:231]
  v_lshlrev_b32 v232, 16, v236
  v_and_b32 v233, 0xffff0000, v236
  v_cvt_pk_bf16_f32 v236, v234, v235
  v_lshlrev_b32 v234, 16, v236
  v_and_b32 v235, 0xffff0000, v236
  v_pk_add_f32 v[232:233], v[232:233], v[234:235]
  v_cvt_pk_bf16_f32 v33, v232, v233
  buffer_store_dwordx2 v[32:33], v9, s[8:11], s54 offen offset:32
  v_lshlrev_b32 v232, 16, v154
  v_and_b32 v233, 0xffff0000, v154
  v_cvt_pk_bf16_f32 v236, v36, v37
  v_pk_mul_f32 v[232:233], v[232:233], v[226:227]
  v_lshlrev_b32 v234, 16, v236
  v_and_b32 v235, 0xffff0000, v236
  v_cvt_pk_bf16_f32 v236, v232, v233
  v_pk_mul_f32 v[234:235], v[234:235], v[230:231]
  v_lshlrev_b32 v232, 16, v236
  v_and_b32 v233, 0xffff0000, v236
  v_cvt_pk_bf16_f32 v236, v234, v235
  v_lshlrev_b32 v234, 16, v236
  v_and_b32 v235, 0xffff0000, v236
  v_pk_add_f32 v[232:233], v[232:233], v[234:235]
  v_cvt_pk_bf16_f32 v36, v232, v233
  v_lshlrev_b32 v232, 16, v155
  v_and_b32 v233, 0xffff0000, v155
  v_cvt_pk_bf16_f32 v236, v38, v39
  v_pk_mul_f32 v[232:233], v[232:233], v[226:227]
  v_lshlrev_b32 v234, 16, v236
  v_and_b32 v235, 0xffff0000, v236
  v_cvt_pk_bf16_f32 v236, v232, v233
  v_pk_mul_f32 v[234:235], v[234:235], v[230:231]
  v_lshlrev_b32 v232, 16, v236
  v_and_b32 v233, 0xffff0000, v236
  v_cvt_pk_bf16_f32 v236, v234, v235
  v_lshlrev_b32 v234, 16, v236
  v_and_b32 v235, 0xffff0000, v236
  v_pk_add_f32 v[232:233], v[232:233], v[234:235]
  v_cvt_pk_bf16_f32 v37, v232, v233
  buffer_store_dwordx2 v[36:37], v9, s[8:11], s54 offen offset:64
  s_nop 0
  s_branch K2_END
K2_IDLE_B:
  s_barrier
  s_barrier
K2_END:
  s_endpgm

.section .rodata,"a"
.p2align 6
.amdhsa_kernel k1_kernel
  .amdhsa_next_free_vgpr 256
  .amdhsa_next_free_sgpr 102
  .amdhsa_accum_offset 256
  .amdhsa_group_segment_fixed_size 0
  .amdhsa_kernarg_size 88
  .amdhsa_user_sgpr_count 2
  .amdhsa_user_sgpr_kernarg_segment_ptr 1
  .amdhsa_system_sgpr_workgroup_id_x 1
.end_amdhsa_kernel

.p2align 6
.amdhsa_kernel k2_kernel
  .amdhsa_next_free_vgpr 256
  .amdhsa_next_free_sgpr 102
  .amdhsa_accum_offset 256
  .amdhsa_group_segment_fixed_size 0
  .amdhsa_kernarg_size 88
  .amdhsa_user_sgpr_count 2
  .amdhsa_user_sgpr_kernarg_segment_ptr 1
  .amdhsa_system_sgpr_workgroup_id_x 1
.end_amdhsa_kernel
```
